```python
import torch

def _softmax(x, axis=-1):
    return torch.softmax(x, dim=axis)
def _gelu(x):
    return torch.nn.functional.gelu(x, approximate="tanh")
def _silu(x):
    return torch.nn.functional.silu(x)
def _sigmoid(x):
    return torch.sigmoid(x)
def _layernorm(x, axis=-1, eps=1e-5):
    m = x.mean(dim=axis, keepdim=True)
    v = x.var(dim=axis, keepdim=True, unbiased=False)
    return (x - m) / torch.sqrt(v + eps)
def _scatter_add(tgt, idx, src, axis=0):
    return tgt.clone().index_add_(axis, idx, src)
def _segment_sum(src, seg, n):
    out = torch.zeros((n,) + src.shape[1:], dtype=src.dtype)
    return out.index_add_(0, seg, src)
def _pad(x, pw):
    flat = tuple(v for pair in reversed(pw) for v in pair)
    return torch.nn.functional.pad(x, flat)

kernel_name = 'gated_mix__ssm_conv_h3__swiglu_ffn__prompt'

def setup_inputs():

    _w = (lambda a: (lambda t: t.to(torch.bfloat16) if t.is_floating_point() else t)(torch.as_tensor(a)))
    def _A_setup():
        B, S, D = 1, 2048, 1024
        ks = 4
        return {
            "q": _w((lambda *s: torch.randn(*s, dtype=torch.bfloat16) * 0.05)(B, S, D)),
            "k": _w((lambda *s: torch.randn(*s, dtype=torch.bfloat16) * 0.4)(B, S, D)),
            "v": _w((lambda *s: torch.randn(*s, dtype=torch.bfloat16) * 0.4)(B, S, D)),
            "shift_k": _w((lambda *s: torch.randn(*s, dtype=torch.bfloat16) * 0.4)(D, ks) * 0.5),
            "ssm_k": _w((lambda *s: torch.randn(*s, dtype=torch.bfloat16) * 0.4)(D, S) * (1.0 / S ** 0.5)),
            "ssm_D": _w((lambda *s: torch.randn(*s, dtype=torch.bfloat16) * 0.4)(D)),
        }
    _A_in = _A_setup()

    def _B_setup():
        B, S, D, F = 1, 2048, 1024, 3584
        return {
            "x": _w((lambda *s: torch.randn(*s, dtype=torch.bfloat16) * 0.05)(B, S, D)),
            "w_gate": _w((lambda *s: torch.randn(*s, dtype=torch.bfloat16) * 0.05)(D, F)),
            "w_up": _w((lambda *s: torch.randn(*s, dtype=torch.bfloat16) * 0.05)(D, F)),
            "w_down": _w((lambda *s: torch.randn(*s, dtype=torch.bfloat16) * 0.05)(F, D)),
        }
    _B_in = _B_setup()

    return {
        "A_q": _A_in["q"],
        "A_k": _A_in["k"],
        "A_v": _A_in["v"],
        "A_shift_k": _A_in["shift_k"],
        "A_ssm_k": _A_in["ssm_k"],
        "A_ssm_D": _A_in["ssm_D"],
        "B_x": _B_in["x"],
        "B_w_gate": _B_in["w_gate"],
        "B_w_up": _B_in["w_up"],
        "B_w_down": _B_in["w_down"],
        "gate_w": _w((lambda *s: torch.randn(*s, dtype=torch.bfloat16) * 0.05)(1024) * 16.0),
    }

def reference(A_q, A_k, A_v, A_shift_k, A_ssm_k, A_ssm_D, B_x, B_w_gate, B_w_up, B_w_down, gate_w):
    def _A_ref(q, k, v, shift_k, ssm_k, ssm_D):
        B, S, D = q.shape
        ks = shift_k.shape[-1]
        k_pad = _pad(k, ((0, 0), (ks - 1, 0), (0, 0)))
        k_shift = torch.zeros_like(k)
        for t in range(ks):
            k_shift = k_shift + k_pad[:, t:t + S, :] * shift_k[:, ks - 1 - t][None, None, :]
        kv = k_shift * v
        L = 2 * S
        kv_pad = _pad(kv, ((0, 0), (0, S), (0, 0)))
        kf_pad = _pad(ssm_k, ((0, 0), (0, S)))
        kv_f = (lambda x, axes=(-2,-1): torch.fft.rfft2(x.float(), dim=axes))(kv_pad[:, None, :, :], axes=(1, 2))
        kf_f = (lambda x, axes=(-2,-1): torch.fft.rfft2(x.float(), dim=axes))(kf_pad[:, None, :], axes=(1, 2))
        kf_f = (lambda x, *d: x.permute(*d))(kf_f, 1, 2, 0)
        y_f = kv_f * kf_f[None, :, :, :]
        y = (lambda x, s, axes=(-2,-1): torch.fft.irfft2(x, s=s, dim=axes).to(torch.bfloat16))(y_f, (1, L), axes=(1, 2))[:, 0, :S, :]
        y = y + kv * ssm_D[None, None, :]
        return q * y

    def _B_ref(x, w_gate, w_up, w_down):
        g = _silu(x @ w_gate)
        u = x @ w_up
        return (g * u) @ w_down

    x = A_q
    g = _sigmoid((x * gate_w).sum(-1, keepdims=True))
    a = _A_ref(x, A_k, A_v, A_shift_k, A_ssm_k, A_ssm_D)
    b = _B_ref(x, B_w_gate, B_w_up, B_w_down)
    return g * a + (1 - g) * b
```

```asm
; @launch grid=(256,1,1) block=(256,1,1) lds=158720
.amdgcn_target "amdgcn-amd-amdhsa--gfx950"
.text
.globl gated_mix__ssm_conv_h3__swiglu_ffn__prompt_kernel
.p2align 8
.type gated_mix__ssm_conv_h3__swiglu_ffn__prompt_kernel,@function
gated_mix__ssm_conv_h3__swiglu_ffn__prompt_kernel:
    s_cmp_ge_u32 s2, 256
    s_cbranch_scc1 L_end
    s_load_dwordx4 s[48:51], s[0:1], 0
    s_load_dwordx4 s[56:59], s[0:1], 56
    s_load_dwordx4 s[52:55], s[0:1], 16
    s_load_dwordx4 s[96:99], s[0:1], 72
    s_load_dwordx4 s[60:63], s[0:1], 32
    s_load_dwordx4 s[76:79], s[0:1], 88
    s_load_dwordx2 s[100:101], s[0:1], 104
    v_lshrrev_b32 v1, 6, v0
    v_and_b32 v2, 63, v0
    v_readfirstlane_b32 s32, v1
    s_and_b32 s46, s2, 7
    s_lshr_b32 s47, s2, 3
    s_lshr_b32 s33, s47, 2
    s_and_b32 s44, s47, 3
    s_lshl_b32 s45, s46, 2
    s_add_u32 s34, s45, s44
    v_lshlrev_b32 v28, 11, v2
    v_mov_b32 v30, 0x7f000000
    v_cmp_gt_u32 vcc, 8, v2
    s_nop 1
    v_cndmask_b32 v28, v30, v28, vcc
    v_mul_u32_u24 v29, 37, v2
    v_lshrrev_b32 v29, 8, v29
    v_mul_u32_u24 v31, 7, v29
    v_sub_u32 v31, v2, v31
    v_mul_u32_u24 v29, 7168, v29
    v_lshl_add_u32 v29, v31, 7, v29
    v_cmp_gt_u32 vcc, 28, v2
    s_nop 1
    v_cndmask_b32 v29, v30, v29, vcc
    s_cmp_lt_u32 s32, 2
    s_cselect_b64 vcc, -1, 0
    v_cndmask_b32 v21, v29, v28, vcc
    s_lshl_b32 s44, s2, 14
    s_lshl_b32 s45, s32, 7
    s_add_u32 s44, s44, s45
    s_add_u32 s44, s44, 512
    s_mul_i32 s45, s47, 28672
    s_mul_i32 s41, s46, 896
    s_add_u32 s45, s45, s41
    s_cmp_lt_u32 s32, 2
    s_cselect_b32 s41, s44, s45
    s_movk_i32 s44, 256
    s_cselect_b32 s42, s44, 917504
    v_lshrrev_b32 v28, 1, v2
    v_and_b32 v29, 1, v2
    v_lshlrev_b32 v29, 7, v29
    v_lshl_add_u32 v3, v28, 11, v29
    s_lshl_b32 s44, s47, 1
    s_add_u32 s44, s44, s32
    s_lshl_b32 s44, s44, 16
    s_cmp_lt_u32 s32, 2
    s_cselect_b32 s92, s44, 0x7f000000
    s_lshl_b32 s44, s47, 2
    s_add_u32 s44, s44, s32
    s_lshl_b32 s93, s44, 9
    v_lshrrev_b32 v34, 2, v2
    v_lshrrev_b32 v28, 4, v2
    v_and_b32 v29, 7, v2
    v_xor_b32 v29, v29, v28
    v_lshlrev_b32 v29, 4, v29
    v_lshrrev_b32 v28, 3, v2
    v_lshl_add_u32 v4, v28, 11, v29
    v_xor_b32 v5, 64, v4
    v_add_u32 v5, 16384, v5
    v_add_u32 v6, 32768, v4
    v_add_u32 v7, 32768, v5
    v_add_u32 v8, 32768, v6
    v_add_u32 v9, 32768, v7
    v_add_u32 v10, 32768, v8
    v_add_u32 v11, 32768, v9
    s_lshl_b32 s35, s33, 8
    s_lshl_b32 s44, s32, 6
    s_add_u32 s43, s35, s44
    s_lshl_b32 s35, s43, 11
    s_mov_b32 s36, 0
    s_lshl_b32 s38, s32, 14
    s_waitcnt lgkmcnt(0)
    s_mov_b32 s4, s48
    s_mov_b32 s5, s49
    s_mov_b32 s6, 0x400000
    s_mov_b32 s7, 0x00020000
    s_mov_b32 s16, s50
    s_mov_b32 s17, s51
    s_mov_b32 s18, 0x400000
    s_mov_b32 s19, 0x00020000
    s_mov_b32 s20, s52
    s_mov_b32 s21, s53
    s_mov_b32 s22, 0x400000
    s_mov_b32 s23, 0x00020000
    s_mov_b32 s24, s54
    s_mov_b32 s25, s55
    s_mov_b32 s26, 0x2000
    s_mov_b32 s27, 0x00020000
    s_mov_b32 s28, s98
    s_mov_b32 s29, s99
    s_mov_b32 s30, 0x800
    s_mov_b32 s31, 0x00020000
    s_cmp_lt_u32 s32, 2
    s_cselect_b32 s8, s56, s58
    s_cselect_b32 s9, s57, s59
    s_mov_b32 s10, 0x700000
    s_mov_b32 s11, 0x00020000
    s_cmp_eq_u32 s32, 2
    s_cselect_b32 s64, s56, s58
    s_cselect_b32 s65, s57, s59
    s_cmp_lt_u32 s32, 2
    s_cselect_b32 s64, s48, s64
    s_cselect_b32 s65, s49, s65
    s_cselect_b32 s66, 0x400000, s10
    s_mov_b32 s67, 0x00020000
    buffer_load_dword v22, v3, s[4:7], s92 offen
    buffer_load_dword v22, v21, s[64:67], s41 offen
    s_add_u32 s92, s92, 256
    s_add_u32 s41, s41, s42
    buffer_load_dword v22, v3, s[4:7], s92 offen
    buffer_load_dword v22, v21, s[64:67], s41 offen
    s_add_u32 s92, s92, 256
    s_add_u32 s41, s41, s42
    s_and_b32 s46, s32, 1
    s_lshr_b32 s47, s32, 1
    s_and_b32 s44, s34, 1
    s_mul_i32 s39, s47, 7168
    s_add_u32 s39, s39, 65536
    s_add_u32 s40, s39, 6144
    s_mul_i32 s45, s46, 3072
    s_add_u32 s39, s39, s45
    s_mul_i32 s46, s46, 48
    s_mul_i32 s47, s34, 224
    s_lshl_b32 s45, s44, 5
    s_add_u32 s45, s45, s47
    s_movk_i32 s37, 7168
    v_bfe_u32 v33, v2, 1, 1
    v_and_b32 v32, 1, v2
    v_lshlrev_b32 v32, 4, v32
    v_add_u32 v28, s46, v34
    v_mul_u32_u24 v29, 43, v28
    v_lshrrev_b32 v29, 7, v29
    v_mul_u32_u24 v30, 3, v29
    v_sub_u32 v30, v28, v30
    v_bfe_u32 v31, v29, 2, 1
    v_xor_b32 v31, v31, v33
    v_lshl_add_u32 v30, v30, 6, v32
    v_lshl_add_u32 v30, v31, 5, v30
    v_add_u32 v30, s45, v30
    v_and_b32 v31, 3, v29
    v_bfe_u32 v28, v29, 2, 2
    v_lshl_add_u32 v31, v28, 3, v31
    v_lshrrev_b32 v28, 4, v29
    v_lshl_add_u32 v31, v28, 2, v31
    v_mad_u32_u24 v12, v31, s37, v30
    v_add_u32 v28, s46, v34
    v_add_u32 v28, 16, v28
    v_mul_u32_u24 v29, 43, v28
    v_lshrrev_b32 v29, 7, v29
    v_mul_u32_u24 v30, 3, v29
    v_sub_u32 v30, v28, v30
    v_bfe_u32 v31, v29, 2, 1
    v_xor_b32 v31, v31, v33
    v_lshl_add_u32 v30, v30, 6, v32
    v_lshl_add_u32 v30, v31, 5, v30
    v_add_u32 v30, s45, v30
    v_and_b32 v31, 3, v29
    v_bfe_u32 v28, v29, 2, 2
    v_lshl_add_u32 v31, v28, 3, v31
    v_lshrrev_b32 v28, 4, v29
    v_lshl_add_u32 v31, v28, 2, v31
    v_mad_u32_u24 v13, v31, s37, v30
    v_add_u32 v28, s46, v34
    v_add_u32 v28, 32, v28
    v_mul_u32_u24 v29, 43, v28
    v_lshrrev_b32 v29, 7, v29
    v_mul_u32_u24 v30, 3, v29
    v_sub_u32 v30, v28, v30
    v_bfe_u32 v31, v29, 2, 1
    v_xor_b32 v31, v31, v33
    v_lshl_add_u32 v30, v30, 6, v32
    v_lshl_add_u32 v30, v31, 5, v30
    v_add_u32 v30, s45, v30
    v_and_b32 v31, 3, v29
    v_bfe_u32 v28, v29, 2, 2
    v_lshl_add_u32 v31, v28, 3, v31
    v_lshrrev_b32 v28, 4, v29
    v_lshl_add_u32 v31, v28, 2, v31
    v_mad_u32_u24 v14, v31, s37, v30
    s_cmp_eq_u32 s44, 0
    s_cselect_b32 s44, 192, 0
    s_add_u32 s44, s44, s47
    v_lshrrev_b32 v29, 1, v2
    v_add_u32 v30, s44, v32
    v_and_b32 v31, 3, v29
    v_bfe_u32 v28, v29, 2, 2
    v_lshl_add_u32 v31, v28, 3, v31
    v_lshrrev_b32 v28, 4, v29
    v_lshl_add_u32 v31, v28, 2, v31
    v_mad_u32_u24 v15, v31, s37, v30
    s_add_u32 m0, s38, 0
    s_nop 0
    buffer_load_dwordx4 v4, s[4:7], s35 offen lds
    s_add_u32 m0, s38, 1024
    s_nop 0
    buffer_load_dwordx4 v5, s[4:7], s35 offen lds
    s_add_u32 m0, s38, 2048
    s_nop 0
    buffer_load_dwordx4 v6, s[4:7], s35 offen lds
    s_add_u32 m0, s38, 3072
    s_nop 0
    buffer_load_dwordx4 v7, s[4:7], s35 offen lds
    s_add_u32 m0, s38, 4096
    s_nop 0
    buffer_load_dwordx4 v8, s[4:7], s35 offen lds
    s_add_u32 m0, s38, 5120
    s_nop 0
    buffer_load_dwordx4 v9, s[4:7], s35 offen lds
    s_add_u32 m0, s38, 6144
    s_nop 0
    buffer_load_dwordx4 v10, s[4:7], s35 offen lds
    s_add_u32 m0, s38, 7168
    s_nop 0
    buffer_load_dwordx4 v11, s[4:7], s35 offen lds
    s_add_u32 s35, s35, 128
    s_add_u32 m0, s39, 0
    s_nop 0
    buffer_load_dwordx4 v12, s[8:11], s36 offen lds
    s_add_u32 m0, s39, 1024
    s_nop 0
    buffer_load_dwordx4 v13, s[8:11], s36 offen lds
    s_add_u32 m0, s39, 2048
    s_nop 0
    buffer_load_dwordx4 v14, s[8:11], s36 offen lds
    s_add_u32 m0, s40, 0
    s_nop 0
    buffer_load_dwordx4 v15, s[8:11], s36 offen lds
    s_add_u32 s36, s36, 229376
    s_add_u32 m0, s39, 14336
    s_nop 0
    buffer_load_dwordx4 v12, s[8:11], s36 offen lds
    s_add_u32 m0, s39, 15360
    s_nop 0
    buffer_load_dwordx4 v13, s[8:11], s36 offen lds
    s_add_u32 m0, s39, 16384
    s_nop 0
    buffer_load_dwordx4 v14, s[8:11], s36 offen lds
    s_add_u32 m0, s40, 14336
    s_nop 0
    buffer_load_dwordx4 v15, s[8:11], s36 offen lds
    s_add_u32 s36, s36, 229376
    v_bfe_u32 v28, v2, 1, 3
    v_lshrrev_b32 v29, 4, v2
    v_xor_b32 v29, v29, v28
    v_and_b32 v28, 15, v2
    v_lshlrev_b32 v28, 7, v28
    v_lshl_add_u32 v16, v29, 4, v28
    v_add_u32 v16, s38, v16
    v_xor_b32 v17, 64, v16
    v_mul_u32_u24 v28, 192, v34
    v_and_b32 v29, 3, v2
    v_lshlrev_b32 v29, 3, v29
    v_add_u32 v29, 65536, v29
    v_add_u32 v28, v28, v29
    v_bfe_u32 v30, v2, 4, 1
    v_lshlrev_b32 v30, 5, v30
    v_add_u32 v18, v28, v30
    v_xor_b32 v30, 32, v30
    v_add_u32 v19, v28, v30
    v_lshl_add_u32 v20, v34, 5, v29
    s_mov_b32 s12, s100
    s_mov_b32 s13, s101
    s_mov_b32 s14, 0x1e00000
    s_mov_b32 s15, 0x00020000
    s_mov_b32 s68, s96
    s_mov_b32 s69, s97
    s_mov_b32 s70, 0x700000
    s_mov_b32 s71, 0x00020000
    s_mov_b32 s72, s60
    s_mov_b32 s73, s61
    s_mov_b32 s74, 0x400000
    s_mov_b32 s75, 0x00020000
    s_or_b32 s44, s2, s32
    s_cmp_lg_u32 s44, 0
    s_cbranch_scc1 L_notok
    s_mov_b32 s44, 0x1870000
    s_load_dword s45, s[100:101], s44 glc
    s_waitcnt lgkmcnt(0)
    s_add_u32 s45, s45, 1
    s_cmp_eq_u32 s45, 0
    s_cselect_b32 s45, 1, s45
    v_mov_b32 v28, s45
    v_mov_b32 v29, 0
    s_mov_b64 exec, 1
    buffer_store_dword v28, v29, s[12:15], s44 offen sc0 sc1
    global_store_dword v29, v28, s[78:79] sc0 sc1
    s_mov_b64 exec, -1
L_notok:
    v_and_b32 v28, 15, v0
    v_lshrrev_b32 v29, 4, v0
    s_and_b32 s46, s2, 15
    s_lshr_b32 s47, s2, 4
    s_lshl_b32 s46, s46, 6
    s_lshl_b32 s47, s47, 7
    v_lshl_add_u32 v28, v28, 2, s46
    v_lshl_add_u32 v29, v29, 3, s47
    v_lshlrev_b32 v23, 11, v29
    v_lshl_add_u32 v23, v28, 1, v23
    v_subrev_u32 v24, 0x1800, v23
    v_cmp_eq_u32 vcc, 0, v29
    v_mov_b32 v30, 0x7f000000
    s_nop 0
    v_cndmask_b32 v24, v24, v30, vcc
    v_lshlrev_b32 v25, 3, v28
    v_lshlrev_b32 v26, 4, v2
    v_lshrrev_b32 v30, 4, v0
    v_sub_u32 v30, 15, v30
    v_lshlrev_b32 v30, 4, v30
    v_and_b32 v27, 15, v0
    v_lshl_add_u32 v27, v27, 10, v30
    v_add_u32 v27, 140288, v27
    s_lshl_b32 s61, s32, 4
    s_add_u32 s61, s61, s46
    s_lshl_b32 s61, s61, 12
    s_lshl_b32 s44, s47, 1
    s_sub_u32 s61, s61, s44
    s_add_u32 s61, s61, 0x1000f00
    s_lshl_b32 s46, s34, 1
    s_add_u32 s43, s43, s46
    s_movk_i32 s48, 2048
    s_movk_i32 s49, 4096
    s_movk_i32 s50, 6144
    s_movk_i32 s51, 8192
    s_movk_i32 s52, 10240
    s_movk_i32 s53, 12288
    s_movk_i32 s54, 14336
    s_lshl_b32 s55, s43, 11
    s_and_b32 s58, s2, 1
    s_bfe_u32 s44, s2, 0x20001
    s_lshr_b32 s45, s2, 6
    s_lshl_b32 s44, s44, 2
    s_add_u32 s44, s44, s45
    s_bfe_u32 s59, s2, 0x30003
    s_lshl_b32 s56, s44, 3
    s_lshl_b32 s45, s32, 1
    s_add_u32 s56, s56, s45
    s_lshl_b32 s57, s59, 1
    s_add_u32 s57, s57, s58
    s_getpc_b64 s[94:95]
L_pc:
    v_min_u32 v28, 3, v2
    v_lshlrev_b32 v28, 7, v28
    v_add_u32 v28, s93, v28
    s_mov_b32 s44, L_end-L_pc
    v_min_u32 v28, s44, v28
    global_load_dword v22, v28, s[94:95]
    s_waitcnt vmcnt(5)
    s_barrier
    ds_read_b128 a[28:31], v16 offset:0
    ds_read_b64_tr_b16 a[0:1], v18 offset:0
    ds_read_b64_tr_b16 a[2:3], v18 offset:3072
    ds_read_b128 a[32:35], v16 offset:2048
    ds_read_b128 a[36:39], v16 offset:4096
    ds_read_b128 a[40:43], v16 offset:6144
    ds_read_b64_tr_b16 a[4:5], v19 offset:0
    ds_read_b64_tr_b16 a[6:7], v19 offset:3072
    ds_read_b64_tr_b16 a[8:9], v18 offset:64
    ds_read_b64_tr_b16 a[10:11], v18 offset:3136
    ds_read_b64_tr_b16 a[12:13], v19 offset:64
    ds_read_b64_tr_b16 a[14:15], v19 offset:3136
    ds_read_b64_tr_b16 a[16:17], v18 offset:128
    ds_read_b64_tr_b16 a[18:19], v18 offset:3200
    s_waitcnt lgkmcnt(11)
    v_mfma_f32_16x16x32_bf16 v[32:35], a[0:3], a[28:31], 0
    ds_read_b64_tr_b16 a[20:21], v19 offset:128
    s_waitcnt lgkmcnt(11)
    v_mfma_f32_16x16x32_bf16 v[36:39], a[0:3], a[32:35], 0
    ds_read_b64_tr_b16 a[22:23], v19 offset:3200
    s_waitcnt lgkmcnt(11)
    v_mfma_f32_16x16x32_bf16 v[40:43], a[0:3], a[36:39], 0
    ds_read_b128 a[44:47], v17 offset:0
    s_add_u32 m0, s38, 8192
    s_waitcnt lgkmcnt(11)
    v_mfma_f32_16x16x32_bf16 v[44:47], a[0:3], a[40:43], 0
    buffer_load_dwordx4 v4, s[4:7], s35 offen lds
    s_waitcnt lgkmcnt(9)
    v_mfma_f32_16x16x32_bf16 v[60:63], a[4:7], a[40:43], 0
    ds_read_b64_tr_b16 a[24:25], v20 offset:6144
    v_mfma_f32_16x16x32_bf16 v[56:59], a[4:7], a[36:39], 0
    ds_read_b64_tr_b16 a[26:27], v20 offset:6656
    v_mfma_f32_16x16x32_bf16 v[52:55], a[4:7], a[32:35], 0
    ds_read_b128 a[48:51], v17 offset:2048
    s_add_u32 m0, s38, 9216
    v_mfma_f32_16x16x32_bf16 v[48:51], a[4:7], a[28:31], 0
    buffer_load_dwordx4 v5, s[4:7], s35 offen lds
    s_waitcnt lgkmcnt(8)
    v_mfma_f32_16x16x32_bf16 v[64:67], a[8:11], a[28:31], 0
    ds_read_b64_tr_b16 a[0:1], v18 offset:7168
    v_mfma_f32_16x16x32_bf16 v[68:71], a[8:11], a[32:35], 0
    ds_read_b64_tr_b16 a[2:3], v18 offset:10240
    v_mfma_f32_16x16x32_bf16 v[72:75], a[8:11], a[36:39], 0
    ds_read_b128 a[52:55], v17 offset:4096
    s_add_u32 m0, s38, 10240
    v_mfma_f32_16x16x32_bf16 v[76:79], a[8:11], a[40:43], 0
    buffer_load_dwordx4 v6, s[4:7], s35 offen lds
    v_mfma_f32_16x16x32_bf16 v[92:95], a[12:15], a[40:43], 0
    ds_read_b64_tr_b16 a[4:5], v19 offset:7168
    v_mfma_f32_16x16x32_bf16 v[88:91], a[12:15], a[36:39], 0
    ds_read_b64_tr_b16 a[6:7], v19 offset:10240
    v_mfma_f32_16x16x32_bf16 v[84:87], a[12:15], a[32:35], 0
    ds_read_b128 a[56:59], v17 offset:6144
    s_add_u32 m0, s38, 11264
    v_mfma_f32_16x16x32_bf16 v[80:83], a[12:15], a[28:31], 0
    buffer_load_dwordx4 v7, s[4:7], s35 offen lds
    s_waitcnt lgkmcnt(10)
    v_mfma_f32_16x16x32_bf16 v[96:99], a[16:19], a[28:31], 0
    ds_read_b64_tr_b16 a[8:9], v18 offset:7232
    v_mfma_f32_16x16x32_bf16 v[100:103], a[16:19], a[32:35], 0
    ds_read_b64_tr_b16 a[10:11], v18 offset:10304
    v_mfma_f32_16x16x32_bf16 v[104:107], a[16:19], a[36:39], 0
    s_add_u32 m0, s38, 12288
    v_mfma_f32_16x16x32_bf16 v[108:111], a[16:19], a[40:43], 0
    buffer_load_dwordx4 v8, s[4:7], s35 offen lds
    v_mfma_f32_16x16x32_bf16 v[124:127], a[20:23], a[40:43], 0
    ds_read_b64_tr_b16 a[12:13], v19 offset:7232
    v_mfma_f32_16x16x32_bf16 v[120:123], a[20:23], a[36:39], 0
    ds_read_b64_tr_b16 a[14:15], v19 offset:10304
    s_waitcnt lgkmcnt(4)
    v_mfma_f32_16x16x32_bf16 v[116:119], a[20:23], a[32:35], 0
    s_add_u32 m0, s38, 13312
    v_mfma_f32_16x16x32_bf16 v[112:115], a[20:23], a[28:31], 0
    buffer_load_dwordx4 v9, s[4:7], s35 offen lds
    v_mfma_f32_16x16x32_bf16 v[128:131], a[24:27], a[28:31], 0
    ds_read_b64_tr_b16 a[16:17], v18 offset:7296
    v_mfma_f32_16x16x32_bf16 v[132:135], a[24:27], a[32:35], 0
    ds_read_b64_tr_b16 a[18:19], v18 offset:10368
    v_mfma_f32_16x16x32_bf16 v[136:139], a[24:27], a[36:39], 0
    s_add_u32 m0, s38, 14336
    v_mfma_f32_16x16x32_bf16 v[140:143], a[24:27], a[40:43], 0
    buffer_load_dwordx4 v10, s[4:7], s35 offen lds
    v_mfma_f32_16x16x32_bf16 v[156:159], a[0:3], a[40:43], 0
    ds_read_b64_tr_b16 a[20:21], v19 offset:7296
    v_mfma_f32_16x16x32_bf16 v[152:155], a[0:3], a[36:39], 0
    ds_read_b64_tr_b16 a[22:23], v19 offset:10368
    v_mfma_f32_16x16x32_bf16 v[148:151], a[0:3], a[32:35], 0
    s_add_u32 m0, s38, 15360
    v_mfma_f32_16x16x32_bf16 v[144:147], a[0:3], a[28:31], 0
    buffer_load_dwordx4 v11, s[4:7], s35 offen lds
    s_waitcnt lgkmcnt(6)
    v_mfma_f32_16x16x32_bf16 v[160:163], a[4:7], a[28:31], 0
    ds_read_b64_tr_b16 a[24:25], v20 offset:13312
    v_mfma_f32_16x16x32_bf16 v[164:167], a[4:7], a[32:35], 0
    ds_read_b64_tr_b16 a[26:27], v20 offset:13824
    v_mfma_f32_16x16x32_bf16 v[168:171], a[4:7], a[36:39], 0
    s_add_u32 s35, s35, 128
    s_add_u32 m0, s39, 28672
    v_mfma_f32_16x16x32_bf16 v[172:175], a[4:7], a[40:43], 0
    buffer_load_dwordx4 v12, s[8:11], s36 offen lds
    v_mfma_f32_16x16x32_bf16 v[188:191], a[8:11], a[40:43], 0
    v_mfma_f32_16x16x32_bf16 v[184:187], a[8:11], a[36:39], 0
    v_mfma_f32_16x16x32_bf16 v[180:183], a[8:11], a[32:35], 0
    v_mfma_f32_16x16x32_bf16 v[176:179], a[8:11], a[28:31], 0
    s_waitcnt vmcnt(10) lgkmcnt(0)
    s_barrier
    v_mfma_f32_16x16x32_bf16 v[192:195], a[12:15], a[28:31], 0
    ds_read_b64_tr_b16 a[0:1], v18 offset:14336
    v_mfma_f32_16x16x32_bf16 v[196:199], a[12:15], a[32:35], 0
    ds_read_b64_tr_b16 a[2:3], v18 offset:17408
    v_mfma_f32_16x16x32_bf16 v[200:203], a[12:15], a[36:39], 0
    v_mfma_f32_16x16x32_bf16 v[204:207], a[12:15], a[40:43], 0
    v_mfma_f32_16x16x32_bf16 v[220:223], a[16:19], a[40:43], 0
    ds_read_b64_tr_b16 a[4:5], v19 offset:14336
    v_mfma_f32_16x16x32_bf16 v[216:219], a[16:19], a[36:39], 0
    ds_read_b64_tr_b16 a[6:7], v19 offset:17408
    v_mfma_f32_16x16x32_bf16 v[212:215], a[16:19], a[32:35], 0
    ds_read_b64_tr_b16 a[8:9], v18 offset:14400
    v_mfma_f32_16x16x32_bf16 v[208:211], a[16:19], a[28:31], 0
    ds_read_b64_tr_b16 a[10:11], v18 offset:17472
    v_mfma_f32_16x16x32_bf16 a[160:163], a[20:23], a[28:31], 0
    ds_read_b64_tr_b16 a[12:13], v19 offset:14400
    v_mfma_f32_16x16x32_bf16 a[164:167], a[20:23], a[32:35], 0
    ds_read_b64_tr_b16 a[14:15], v19 offset:17472
    v_mfma_f32_16x16x32_bf16 a[168:171], a[20:23], a[36:39], 0
    s_add_u32 m0, s39, 29696
    v_mfma_f32_16x16x32_bf16 a[172:175], a[20:23], a[40:43], 0
    buffer_load_dwordx4 v13, s[8:11], s36 offen lds
    v_mfma_f32_16x16x32_bf16 a[188:191], a[24:27], a[40:43], 0
    ds_read_b64_tr_b16 a[16:17], v18 offset:14464
    v_mfma_f32_16x16x32_bf16 a[184:187], a[24:27], a[36:39], 0
    ds_read_b64_tr_b16 a[18:19], v18 offset:17536
    v_mfma_f32_16x16x32_bf16 a[180:183], a[24:27], a[32:35], 0
    s_add_u32 m0, s39, 30720
    v_mfma_f32_16x16x32_bf16 a[176:179], a[24:27], a[28:31], 0
    buffer_load_dwordx4 v14, s[8:11], s36 offen lds
    s_waitcnt lgkmcnt(8)
    v_mfma_f32_16x16x32_bf16 v[32:35], a[0:3], a[44:47], v[32:35]
    ds_read_b64_tr_b16 a[20:21], v19 offset:14464
    v_mfma_f32_16x16x32_bf16 v[36:39], a[0:3], a[48:51], v[36:39]
    ds_read_b64_tr_b16 a[22:23], v19 offset:17536
    v_mfma_f32_16x16x32_bf16 v[40:43], a[0:3], a[52:55], v[40:43]
    s_add_u32 m0, s40, 28672
    v_mfma_f32_16x16x32_bf16 v[44:47], a[0:3], a[56:59], v[44:47]
    buffer_load_dwordx4 v15, s[8:11], s36 offen lds
    s_waitcnt lgkmcnt(8)
    v_mfma_f32_16x16x32_bf16 v[60:63], a[4:7], a[56:59], v[60:63]
    ds_read_b64_tr_b16 a[24:25], v20 offset:20480
    v_mfma_f32_16x16x32_bf16 v[56:59], a[4:7], a[52:55], v[56:59]
    ds_read_b64_tr_b16 a[26:27], v20 offset:20992
    v_mfma_f32_16x16x32_bf16 v[52:55], a[4:7], a[48:51], v[52:55]
    s_add_u32 s36, s36, 229376
    s_add_u32 m0, s39, 43008
    v_mfma_f32_16x16x32_bf16 v[48:51], a[4:7], a[44:47], v[48:51]
    buffer_load_dwordx4 v12, s[8:11], s36 offen lds
    s_waitcnt lgkmcnt(6)
    v_mfma_f32_16x16x32_bf16 v[64:67], a[8:11], a[44:47], v[64:67]
    ds_read_b64_tr_b16 a[0:1], v18 offset:21504
    v_mfma_f32_16x16x32_bf16 v[68:71], a[8:11], a[48:51], v[68:71]
    ds_read_b64_tr_b16 a[2:3], v18 offset:24576
    buffer_load_dword v22, v21, s[64:67], s41 offen
    v_mfma_f32_16x16x32_bf16 v[72:75], a[8:11], a[52:55], v[72:75]
    s_add_u32 m0, s39, 44032
    s_add_u32 s41, s41, s42
    v_mfma_f32_16x16x32_bf16 v[76:79], a[8:11], a[56:59], v[76:79]
    buffer_load_dwordx4 v13, s[8:11], s36 offen lds
    v_mfma_f32_16x16x32_bf16 v[92:95], a[12:15], a[56:59], v[92:95]
    ds_read_b64_tr_b16 a[4:5], v19 offset:21504
    v_mfma_f32_16x16x32_bf16 v[88:91], a[12:15], a[52:55], v[88:91]
    ds_read_b64_tr_b16 a[6:7], v19 offset:24576
    v_mfma_f32_16x16x32_bf16 v[84:87], a[12:15], a[48:51], v[84:87]
    s_add_u32 m0, s39, 45056
    v_mfma_f32_16x16x32_bf16 v[80:83], a[12:15], a[44:47], v[80:83]
    buffer_load_dwordx4 v14, s[8:11], s36 offen lds
    s_waitcnt lgkmcnt(6)
    v_mfma_f32_16x16x32_bf16 v[96:99], a[16:19], a[44:47], v[96:99]
    ds_read_b64_tr_b16 a[8:9], v18 offset:21568
    v_mfma_f32_16x16x32_bf16 v[100:103], a[16:19], a[48:51], v[100:103]
    ds_read_b64_tr_b16 a[10:11], v18 offset:24640
    v_mfma_f32_16x16x32_bf16 v[104:107], a[16:19], a[52:55], v[104:107]
    s_add_u32 m0, s40, 43008
    v_mfma_f32_16x16x32_bf16 v[108:111], a[16:19], a[56:59], v[108:111]
    buffer_load_dwordx4 v15, s[8:11], s36 offen lds
    v_mfma_f32_16x16x32_bf16 v[124:127], a[20:23], a[56:59], v[124:127]
    ds_read_b64_tr_b16 a[12:13], v19 offset:21568
    v_mfma_f32_16x16x32_bf16 v[120:123], a[20:23], a[52:55], v[120:123]
    ds_read_b64_tr_b16 a[14:15], v19 offset:24640
    v_mfma_f32_16x16x32_bf16 v[116:119], a[20:23], a[48:51], v[116:119]
    s_add_u32 s36, s36, 229376
    s_add_u32 m0, s38, 0
    v_mfma_f32_16x16x32_bf16 v[112:115], a[20:23], a[44:47], v[112:115]
    buffer_load_dwordx4 v4, s[4:7], s35 offen lds
    s_waitcnt lgkmcnt(6)
    v_mfma_f32_16x16x32_bf16 v[128:131], a[24:27], a[44:47], v[128:131]
    ds_read_b64_tr_b16 a[16:17], v18 offset:21632
    v_mfma_f32_16x16x32_bf16 v[132:135], a[24:27], a[48:51], v[132:135]
    ds_read_b64_tr_b16 a[18:19], v18 offset:24704
    v_mfma_f32_16x16x32_bf16 v[136:139], a[24:27], a[52:55], v[136:139]
    s_add_u32 m0, s38, 1024
    v_mfma_f32_16x16x32_bf16 v[140:143], a[24:27], a[56:59], v[140:143]
    buffer_load_dwordx4 v5, s[4:7], s35 offen lds
    v_mfma_f32_16x16x32_bf16 v[156:159], a[0:3], a[56:59], v[156:159]
    ds_read_b64_tr_b16 a[20:21], v19 offset:21632
    v_mfma_f32_16x16x32_bf16 v[152:155], a[0:3], a[52:55], v[152:155]
    ds_read_b64_tr_b16 a[22:23], v19 offset:24704
    v_mfma_f32_16x16x32_bf16 v[148:151], a[0:3], a[48:51], v[148:151]
    s_add_u32 m0, s38, 2048
    v_mfma_f32_16x16x32_bf16 v[144:147], a[0:3], a[44:47], v[144:147]
    buffer_load_dwordx4 v6, s[4:7], s35 offen lds
    s_waitcnt lgkmcnt(6)
    v_mfma_f32_16x16x32_bf16 v[160:163], a[4:7], a[44:47], v[160:163]
    ds_read_b64_tr_b16 a[24:25], v20 offset:27648
    v_mfma_f32_16x16x32_bf16 v[164:167], a[4:7], a[48:51], v[164:167]
    ds_read_b64_tr_b16 a[26:27], v20 offset:28160
    v_mfma_f32_16x16x32_bf16 v[168:171], a[4:7], a[52:55], v[168:171]
    s_add_u32 m0, s38, 3072
    v_mfma_f32_16x16x32_bf16 v[172:175], a[4:7], a[56:59], v[172:175]
    buffer_load_dwordx4 v7, s[4:7], s35 offen lds
    v_mfma_f32_16x16x32_bf16 v[188:191], a[8:11], a[56:59], v[188:191]
    v_mfma_f32_16x16x32_bf16 v[184:187], a[8:11], a[52:55], v[184:187]
    v_mfma_f32_16x16x32_bf16 v[180:183], a[8:11], a[48:51], v[180:183]
    v_mfma_f32_16x16x32_bf16 v[176:179], a[8:11], a[44:47], v[176:179]
    s_waitcnt vmcnt(9) lgkmcnt(0)
    s_barrier
    ds_read_b128 a[28:31], v16 offset:8192
    v_mfma_f32_16x16x32_bf16 v[192:195], a[12:15], a[44:47], v[192:195]
    ds_read_b64_tr_b16 a[0:1], v18 offset:28672
    v_mfma_f32_16x16x32_bf16 v[196:199], a[12:15], a[48:51], v[196:199]
    ds_read_b64_tr_b16 a[2:3], v18 offset:31744
    v_mfma_f32_16x16x32_bf16 v[200:203], a[12:15], a[52:55], v[200:203]
    ds_read_b128 a[32:35], v16 offset:10240
    v_mfma_f32_16x16x32_bf16 v[204:207], a[12:15], a[56:59], v[204:207]
    ds_read_b128 a[36:39], v16 offset:12288
    v_mfma_f32_16x16x32_bf16 v[220:223], a[16:19], a[56:59], v[220:223]
    ds_read_b128 a[40:43], v16 offset:14336
    v_mfma_f32_16x16x32_bf16 v[216:219], a[16:19], a[52:55], v[216:219]
    ds_read_b64_tr_b16 a[4:5], v19 offset:28672
    v_mfma_f32_16x16x32_bf16 v[212:215], a[16:19], a[48:51], v[212:215]
    ds_read_b64_tr_b16 a[6:7], v19 offset:31744
    v_mfma_f32_16x16x32_bf16 v[208:211], a[16:19], a[44:47], v[208:211]
    ds_read_b64_tr_b16 a[8:9], v18 offset:28736
    v_mfma_f32_16x16x32_bf16 a[160:163], a[20:23], a[44:47], a[160:163]
    ds_read_b64_tr_b16 a[10:11], v18 offset:31808
    v_mfma_f32_16x16x32_bf16 a[164:167], a[20:23], a[48:51], a[164:167]
    ds_read_b64_tr_b16 a[12:13], v19 offset:28736
    v_mfma_f32_16x16x32_bf16 a[168:171], a[20:23], a[52:55], a[168:171]
    ds_read_b64_tr_b16 a[14:15], v19 offset:31808
    s_add_u32 m0, s38, 4096
    v_mfma_f32_16x16x32_bf16 a[172:175], a[20:23], a[56:59], a[172:175]
    buffer_load_dwordx4 v8, s[4:7], s35 offen lds
    v_mfma_f32_16x16x32_bf16 a[188:191], a[24:27], a[56:59], a[188:191]
    ds_read_b64_tr_b16 a[16:17], v18 offset:28800
    v_mfma_f32_16x16x32_bf16 a[184:187], a[24:27], a[52:55], a[184:187]
    ds_read_b64_tr_b16 a[18:19], v18 offset:31872
    v_mfma_f32_16x16x32_bf16 a[180:183], a[24:27], a[48:51], a[180:183]
    s_add_u32 m0, s38, 5120
    v_mfma_f32_16x16x32_bf16 a[176:179], a[24:27], a[44:47], a[176:179]
    buffer_load_dwordx4 v9, s[4:7], s35 offen lds
    s_waitcnt lgkmcnt(11)
    v_mfma_f32_16x16x32_bf16 v[32:35], a[0:3], a[28:31], v[32:35]
    ds_read_b64_tr_b16 a[20:21], v19 offset:28800
    s_waitcnt lgkmcnt(11)
    v_mfma_f32_16x16x32_bf16 v[36:39], a[0:3], a[32:35], v[36:39]
    ds_read_b64_tr_b16 a[22:23], v19 offset:31872
    s_waitcnt lgkmcnt(11)
    v_mfma_f32_16x16x32_bf16 v[40:43], a[0:3], a[36:39], v[40:43]
    ds_read_b128 a[44:47], v17 offset:8192
    s_add_u32 m0, s38, 6144
    s_waitcnt lgkmcnt(11)
    v_mfma_f32_16x16x32_bf16 v[44:47], a[0:3], a[40:43], v[44:47]
    buffer_load_dwordx4 v10, s[4:7], s35 offen lds
    s_waitcnt lgkmcnt(9)
    v_mfma_f32_16x16x32_bf16 v[60:63], a[4:7], a[40:43], v[60:63]
    ds_read_b64_tr_b16 a[24:25], v20 offset:34816
    v_mfma_f32_16x16x32_bf16 v[56:59], a[4:7], a[36:39], v[56:59]
    ds_read_b64_tr_b16 a[26:27], v20 offset:35328
    v_mfma_f32_16x16x32_bf16 v[52:55], a[4:7], a[32:35], v[52:55]
    ds_read_b128 a[48:51], v17 offset:10240
    s_add_u32 m0, s38, 7168
    v_mfma_f32_16x16x32_bf16 v[48:51], a[4:7], a[28:31], v[48:51]
    buffer_load_dwordx4 v11, s[4:7], s35 offen lds
    s_waitcnt lgkmcnt(8)
    v_mfma_f32_16x16x32_bf16 v[64:67], a[8:11], a[28:31], v[64:67]
    ds_read_b64_tr_b16 a[0:1], v18 offset:35840
    v_mfma_f32_16x16x32_bf16 v[68:71], a[8:11], a[32:35], v[68:71]
    ds_read_b64_tr_b16 a[2:3], v18 offset:38912
    buffer_load_dword v22, v3, s[4:7], s92 offen
    v_mfma_f32_16x16x32_bf16 v[72:75], a[8:11], a[36:39], v[72:75]
    ds_read_b128 a[52:55], v17 offset:12288
    s_add_u32 s35, s35, 128
    s_add_u32 s92, s92, 256
    s_add_u32 m0, s39, 0
    v_mfma_f32_16x16x32_bf16 v[76:79], a[8:11], a[40:43], v[76:79]
    buffer_load_dwordx4 v12, s[8:11], s36 offen lds
    v_mfma_f32_16x16x32_bf16 v[92:95], a[12:15], a[40:43], v[92:95]
    ds_read_b64_tr_b16 a[4:5], v19 offset:35840
    v_mfma_f32_16x16x32_bf16 v[88:91], a[12:15], a[36:39], v[88:91]
    ds_read_b64_tr_b16 a[6:7], v19 offset:38912
    v_mfma_f32_16x16x32_bf16 v[84:87], a[12:15], a[32:35], v[84:87]
    ds_read_b128 a[56:59], v17 offset:14336
    s_add_u32 m0, s39, 1024
    v_mfma_f32_16x16x32_bf16 v[80:83], a[12:15], a[28:31], v[80:83]
    buffer_load_dwordx4 v13, s[8:11], s36 offen lds
    s_waitcnt lgkmcnt(10)
    v_mfma_f32_16x16x32_bf16 v[96:99], a[16:19], a[28:31], v[96:99]
    ds_read_b64_tr_b16 a[8:9], v18 offset:35904
    v_mfma_f32_16x16x32_bf16 v[100:103], a[16:19], a[32:35], v[100:103]
    ds_read_b64_tr_b16 a[10:11], v18 offset:38976
    v_mfma_f32_16x16x32_bf16 v[104:107], a[16:19], a[36:39], v[104:107]
    s_add_u32 m0, s39, 2048
    v_mfma_f32_16x16x32_bf16 v[108:111], a[16:19], a[40:43], v[108:111]
    buffer_load_dwordx4 v14, s[8:11], s36 offen lds
    v_mfma_f32_16x16x32_bf16 v[124:127], a[20:23], a[40:43], v[124:127]
    ds_read_b64_tr_b16 a[12:13], v19 offset:35904
    v_mfma_f32_16x16x32_bf16 v[120:123], a[20:23], a[36:39], v[120:123]
    ds_read_b64_tr_b16 a[14:15], v19 offset:38976
    s_waitcnt lgkmcnt(4)
    v_mfma_f32_16x16x32_bf16 v[116:119], a[20:23], a[32:35], v[116:119]
    s_add_u32 m0, s40, 0
    v_mfma_f32_16x16x32_bf16 v[112:115], a[20:23], a[28:31], v[112:115]
    buffer_load_dwordx4 v15, s[8:11], s36 offen lds
    v_mfma_f32_16x16x32_bf16 v[128:131], a[24:27], a[28:31], v[128:131]
    ds_read_b64_tr_b16 a[16:17], v18 offset:35968
    v_mfma_f32_16x16x32_bf16 v[132:135], a[24:27], a[32:35], v[132:135]
    ds_read_b64_tr_b16 a[18:19], v18 offset:39040
    v_mfma_f32_16x16x32_bf16 v[136:139], a[24:27], a[36:39], v[136:139]
    s_add_u32 s36, s36, 229376
    s_add_u32 m0, s39, 14336
    v_mfma_f32_16x16x32_bf16 v[140:143], a[24:27], a[40:43], v[140:143]
    buffer_load_dwordx4 v12, s[8:11], s36 offen lds
    v_mfma_f32_16x16x32_bf16 v[156:159], a[0:3], a[40:43], v[156:159]
    ds_read_b64_tr_b16 a[20:21], v19 offset:35968
    v_mfma_f32_16x16x32_bf16 v[152:155], a[0:3], a[36:39], v[152:155]
    ds_read_b64_tr_b16 a[22:23], v19 offset:39040
    v_mfma_f32_16x16x32_bf16 v[148:151], a[0:3], a[32:35], v[148:151]
    s_add_u32 m0, s39, 15360
    v_mfma_f32_16x16x32_bf16 v[144:147], a[0:3], a[28:31], v[144:147]
    buffer_load_dwordx4 v13, s[8:11], s36 offen lds
    s_waitcnt lgkmcnt(6)
    v_mfma_f32_16x16x32_bf16 v[160:163], a[4:7], a[28:31], v[160:163]
    ds_read_b64_tr_b16 a[24:25], v20 offset:41984
    v_mfma_f32_16x16x32_bf16 v[164:167], a[4:7], a[32:35], v[164:167]
    ds_read_b64_tr_b16 a[26:27], v20 offset:42496
    v_mfma_f32_16x16x32_bf16 v[168:171], a[4:7], a[36:39], v[168:171]
    s_add_u32 m0, s39, 16384
    v_mfma_f32_16x16x32_bf16 v[172:175], a[4:7], a[40:43], v[172:175]
    buffer_load_dwordx4 v14, s[8:11], s36 offen lds
    v_mfma_f32_16x16x32_bf16 v[188:191], a[8:11], a[40:43], v[188:191]
    v_mfma_f32_16x16x32_bf16 v[184:187], a[8:11], a[36:39], v[184:187]
    v_mfma_f32_16x16x32_bf16 v[180:183], a[8:11], a[32:35], v[180:183]
    v_mfma_f32_16x16x32_bf16 v[176:179], a[8:11], a[28:31], v[176:179]
    s_waitcnt vmcnt(16) lgkmcnt(0)
    s_barrier
    v_mfma_f32_16x16x32_bf16 v[192:195], a[12:15], a[28:31], v[192:195]
    ds_read_b64_tr_b16 a[0:1], v18 offset:43008
    v_mfma_f32_16x16x32_bf16 v[196:199], a[12:15], a[32:35], v[196:199]
    ds_read_b64_tr_b16 a[2:3], v18 offset:46080
    v_mfma_f32_16x16x32_bf16 v[200:203], a[12:15], a[36:39], v[200:203]
    v_mfma_f32_16x16x32_bf16 v[204:207], a[12:15], a[40:43], v[204:207]
    v_mfma_f32_16x16x32_bf16 v[220:223], a[16:19], a[40:43], v[220:223]
    ds_read_b64_tr_b16 a[4:5], v19 offset:43008
    v_mfma_f32_16x16x32_bf16 v[216:219], a[16:19], a[36:39], v[216:219]
    ds_read_b64_tr_b16 a[6:7], v19 offset:46080
    v_mfma_f32_16x16x32_bf16 v[212:215], a[16:19], a[32:35], v[212:215]
    ds_read_b64_tr_b16 a[8:9], v18 offset:43072
    v_mfma_f32_16x16x32_bf16 v[208:211], a[16:19], a[28:31], v[208:211]
    ds_read_b64_tr_b16 a[10:11], v18 offset:46144
    v_mfma_f32_16x16x32_bf16 a[160:163], a[20:23], a[28:31], a[160:163]
    ds_read_b64_tr_b16 a[12:13], v19 offset:43072
    v_mfma_f32_16x16x32_bf16 a[164:167], a[20:23], a[32:35], a[164:167]
    ds_read_b64_tr_b16 a[14:15], v19 offset:46144
    v_mfma_f32_16x16x32_bf16 a[168:171], a[20:23], a[36:39], a[168:171]
    s_add_u32 m0, s40, 14336
    v_mfma_f32_16x16x32_bf16 a[172:175], a[20:23], a[40:43], a[172:175]
    buffer_load_dwordx4 v15, s[8:11], s36 offen lds
    v_mfma_f32_16x16x32_bf16 a[188:191], a[24:27], a[40:43], a[188:191]
    ds_read_b64_tr_b16 a[16:17], v18 offset:43136
    v_mfma_f32_16x16x32_bf16 a[184:187], a[24:27], a[36:39], a[184:187]
    ds_read_b64_tr_b16 a[18:19], v18 offset:46208
    v_mfma_f32_16x16x32_bf16 a[180:183], a[24:27], a[32:35], a[180:183]
    s_add_u32 s36, s36, 229376
    s_add_u32 m0, s38, 8192
    v_mfma_f32_16x16x32_bf16 a[176:179], a[24:27], a[28:31], a[176:179]
    buffer_load_dwordx4 v4, s[4:7], s35 offen lds
    s_waitcnt lgkmcnt(8)
    v_mfma_f32_16x16x32_bf16 v[32:35], a[0:3], a[44:47], v[32:35]
    ds_read_b64_tr_b16 a[20:21], v19 offset:43136
    v_mfma_f32_16x16x32_bf16 v[36:39], a[0:3], a[48:51], v[36:39]
    ds_read_b64_tr_b16 a[22:23], v19 offset:46208
    v_mfma_f32_16x16x32_bf16 v[40:43], a[0:3], a[52:55], v[40:43]
    s_add_u32 m0, s38, 9216
    v_mfma_f32_16x16x32_bf16 v[44:47], a[0:3], a[56:59], v[44:47]
    buffer_load_dwordx4 v5, s[4:7], s35 offen lds
    s_waitcnt lgkmcnt(8)
    v_mfma_f32_16x16x32_bf16 v[60:63], a[4:7], a[56:59], v[60:63]
    ds_read_b64_tr_b16 a[24:25], v20 offset:49152
    v_mfma_f32_16x16x32_bf16 v[56:59], a[4:7], a[52:55], v[56:59]
    ds_read_b64_tr_b16 a[26:27], v20 offset:49664
    v_mfma_f32_16x16x32_bf16 v[52:55], a[4:7], a[48:51], v[52:55]
    s_add_u32 m0, s38, 10240
    v_mfma_f32_16x16x32_bf16 v[48:51], a[4:7], a[44:47], v[48:51]
    buffer_load_dwordx4 v6, s[4:7], s35 offen lds
    s_waitcnt lgkmcnt(6)
    v_mfma_f32_16x16x32_bf16 v[64:67], a[8:11], a[44:47], v[64:67]
    ds_read_b64_tr_b16 a[0:1], v18 offset:50176
    v_mfma_f32_16x16x32_bf16 v[68:71], a[8:11], a[48:51], v[68:71]
    ds_read_b64_tr_b16 a[2:3], v18 offset:53248
    v_mfma_f32_16x16x32_bf16 v[72:75], a[8:11], a[52:55], v[72:75]
    s_add_u32 m0, s38, 11264
    v_mfma_f32_16x16x32_bf16 v[76:79], a[8:11], a[56:59], v[76:79]
    buffer_load_dwordx4 v7, s[4:7], s35 offen lds
    v_mfma_f32_16x16x32_bf16 v[92:95], a[12:15], a[56:59], v[92:95]
    ds_read_b64_tr_b16 a[4:5], v19 offset:50176
    v_mfma_f32_16x16x32_bf16 v[88:91], a[12:15], a[52:55], v[88:91]
    ds_read_b64_tr_b16 a[6:7], v19 offset:53248
    v_mfma_f32_16x16x32_bf16 v[84:87], a[12:15], a[48:51], v[84:87]
    s_add_u32 m0, s38, 12288
    v_mfma_f32_16x16x32_bf16 v[80:83], a[12:15], a[44:47], v[80:83]
    buffer_load_dwordx4 v8, s[4:7], s35 offen lds
    s_waitcnt lgkmcnt(6)
    v_mfma_f32_16x16x32_bf16 v[96:99], a[16:19], a[44:47], v[96:99]
    ds_read_b64_tr_b16 a[8:9], v18 offset:50240
    v_mfma_f32_16x16x32_bf16 v[100:103], a[16:19], a[48:51], v[100:103]
    ds_read_b64_tr_b16 a[10:11], v18 offset:53312
    v_mfma_f32_16x16x32_bf16 v[104:107], a[16:19], a[52:55], v[104:107]
    s_add_u32 m0, s38, 13312
    v_mfma_f32_16x16x32_bf16 v[108:111], a[16:19], a[56:59], v[108:111]
    buffer_load_dwordx4 v9, s[4:7], s35 offen lds
    v_mfma_f32_16x16x32_bf16 v[124:127], a[20:23], a[56:59], v[124:127]
    ds_read_b64_tr_b16 a[12:13], v19 offset:50240
    v_mfma_f32_16x16x32_bf16 v[120:123], a[20:23], a[52:55], v[120:123]
    ds_read_b64_tr_b16 a[14:15], v19 offset:53312
    v_mfma_f32_16x16x32_bf16 v[116:119], a[20:23], a[48:51], v[116:119]
    s_add_u32 m0, s38, 14336
    v_mfma_f32_16x16x32_bf16 v[112:115], a[20:23], a[44:47], v[112:115]
    buffer_load_dwordx4 v10, s[4:7], s35 offen lds
    s_waitcnt lgkmcnt(6)
    v_mfma_f32_16x16x32_bf16 v[128:131], a[24:27], a[44:47], v[128:131]
    ds_read_b64_tr_b16 a[16:17], v18 offset:50304
    v_mfma_f32_16x16x32_bf16 v[132:135], a[24:27], a[48:51], v[132:135]
    ds_read_b64_tr_b16 a[18:19], v18 offset:53376
    v_mfma_f32_16x16x32_bf16 v[136:139], a[24:27], a[52:55], v[136:139]
    s_add_u32 m0, s38, 15360
    v_mfma_f32_16x16x32_bf16 v[140:143], a[24:27], a[56:59], v[140:143]
    buffer_load_dwordx4 v11, s[4:7], s35 offen lds
    v_mfma_f32_16x16x32_bf16 v[156:159], a[0:3], a[56:59], v[156:159]
    ds_read_b64_tr_b16 a[20:21], v19 offset:50304
    v_mfma_f32_16x16x32_bf16 v[152:155], a[0:3], a[52:55], v[152:155]
    ds_read_b64_tr_b16 a[22:23], v19 offset:53376
    v_mfma_f32_16x16x32_bf16 v[148:151], a[0:3], a[48:51], v[148:151]
    s_add_u32 s35, s35, 128
    s_add_u32 m0, s39, 28672
    v_mfma_f32_16x16x32_bf16 v[144:147], a[0:3], a[44:47], v[144:147]
    buffer_load_dwordx4 v12, s[8:11], s36 offen lds
    s_waitcnt lgkmcnt(6)
    v_mfma_f32_16x16x32_bf16 v[160:163], a[4:7], a[44:47], v[160:163]
    ds_read_b64_tr_b16 a[24:25], v20 offset:56320
    v_mfma_f32_16x16x32_bf16 v[164:167], a[4:7], a[48:51], v[164:167]
    ds_read_b64_tr_b16 a[26:27], v20 offset:56832
    v_mfma_f32_16x16x32_bf16 v[168:171], a[4:7], a[52:55], v[168:171]
    s_add_u32 m0, s39, 29696
    v_mfma_f32_16x16x32_bf16 v[172:175], a[4:7], a[56:59], v[172:175]
    buffer_load_dwordx4 v13, s[8:11], s36 offen lds
    v_mfma_f32_16x16x32_bf16 v[188:191], a[8:11], a[56:59], v[188:191]
    v_mfma_f32_16x16x32_bf16 v[184:187], a[8:11], a[52:55], v[184:187]
    v_mfma_f32_16x16x32_bf16 v[180:183], a[8:11], a[48:51], v[180:183]
    v_mfma_f32_16x16x32_bf16 v[176:179], a[8:11], a[44:47], v[176:179]
    s_waitcnt vmcnt(14) lgkmcnt(0)
    s_barrier
    ds_read_b128 a[28:31], v16 offset:0
    v_mfma_f32_16x16x32_bf16 v[192:195], a[12:15], a[44:47], v[192:195]
    ds_read_b64_tr_b16 a[0:1], v18 offset:0
    v_mfma_f32_16x16x32_bf16 v[196:199], a[12:15], a[48:51], v[196:199]
    ds_read_b64_tr_b16 a[2:3], v18 offset:3072
    v_mfma_f32_16x16x32_bf16 v[200:203], a[12:15], a[52:55], v[200:203]
    ds_read_b128 a[32:35], v16 offset:2048
    v_mfma_f32_16x16x32_bf16 v[204:207], a[12:15], a[56:59], v[204:207]
    ds_read_b128 a[36:39], v16 offset:4096
    v_mfma_f32_16x16x32_bf16 v[220:223], a[16:19], a[56:59], v[220:223]
    ds_read_b128 a[40:43], v16 offset:6144
    v_mfma_f32_16x16x32_bf16 v[216:219], a[16:19], a[52:55], v[216:219]
    ds_read_b64_tr_b16 a[4:5], v19 offset:0
    v_mfma_f32_16x16x32_bf16 v[212:215], a[16:19], a[48:51], v[212:215]
    ds_read_b64_tr_b16 a[6:7], v19 offset:3072
    v_mfma_f32_16x16x32_bf16 v[208:211], a[16:19], a[44:47], v[208:211]
    ds_read_b64_tr_b16 a[8:9], v18 offset:64
    v_mfma_f32_16x16x32_bf16 a[160:163], a[20:23], a[44:47], a[160:163]
    ds_read_b64_tr_b16 a[10:11], v18 offset:3136
    v_mfma_f32_16x16x32_bf16 a[164:167], a[20:23], a[48:51], a[164:167]
    ds_read_b64_tr_b16 a[12:13], v19 offset:64
    v_mfma_f32_16x16x32_bf16 a[168:171], a[20:23], a[52:55], a[168:171]
    ds_read_b64_tr_b16 a[14:15], v19 offset:3136
    s_add_u32 m0, s39, 30720
    v_mfma_f32_16x16x32_bf16 a[172:175], a[20:23], a[56:59], a[172:175]
    buffer_load_dwordx4 v14, s[8:11], s36 offen lds
    v_mfma_f32_16x16x32_bf16 a[188:191], a[24:27], a[56:59], a[188:191]
    ds_read_b64_tr_b16 a[16:17], v18 offset:128
    v_mfma_f32_16x16x32_bf16 a[184:187], a[24:27], a[52:55], a[184:187]
    ds_read_b64_tr_b16 a[18:19], v18 offset:3200
    v_mfma_f32_16x16x32_bf16 a[180:183], a[24:27], a[48:51], a[180:183]
    s_add_u32 m0, s40, 28672
    v_mfma_f32_16x16x32_bf16 a[176:179], a[24:27], a[44:47], a[176:179]
    buffer_load_dwordx4 v15, s[8:11], s36 offen lds
    s_waitcnt lgkmcnt(11)
    v_mfma_f32_16x16x32_bf16 v[32:35], a[0:3], a[28:31], v[32:35]
    ds_read_b64_tr_b16 a[20:21], v19 offset:128
    s_waitcnt lgkmcnt(11)
    v_mfma_f32_16x16x32_bf16 v[36:39], a[0:3], a[32:35], v[36:39]
    ds_read_b64_tr_b16 a[22:23], v19 offset:3200
    s_waitcnt lgkmcnt(11)
    v_mfma_f32_16x16x32_bf16 v[40:43], a[0:3], a[36:39], v[40:43]
    ds_read_b128 a[44:47], v17 offset:0
    s_add_u32 s36, s36, 229376
    s_add_u32 m0, s39, 43008
    s_waitcnt lgkmcnt(11)
    v_mfma_f32_16x16x32_bf16 v[44:47], a[0:3], a[40:43], v[44:47]
    buffer_load_dwordx4 v12, s[8:11], s36 offen lds
    s_waitcnt lgkmcnt(9)
    v_mfma_f32_16x16x32_bf16 v[60:63], a[4:7], a[40:43], v[60:63]
    ds_read_b64_tr_b16 a[24:25], v20 offset:6144
    v_mfma_f32_16x16x32_bf16 v[56:59], a[4:7], a[36:39], v[56:59]
    ds_read_b64_tr_b16 a[26:27], v20 offset:6656
    v_mfma_f32_16x16x32_bf16 v[52:55], a[4:7], a[32:35], v[52:55]
    ds_read_b128 a[48:51], v17 offset:2048
    s_add_u32 m0, s39, 44032
    v_mfma_f32_16x16x32_bf16 v[48:51], a[4:7], a[28:31], v[48:51]
    buffer_load_dwordx4 v13, s[8:11], s36 offen lds
    s_waitcnt lgkmcnt(8)
    v_mfma_f32_16x16x32_bf16 v[64:67], a[8:11], a[28:31], v[64:67]
    ds_read_b64_tr_b16 a[0:1], v18 offset:7168
    v_mfma_f32_16x16x32_bf16 v[68:71], a[8:11], a[32:35], v[68:71]
    ds_read_b64_tr_b16 a[2:3], v18 offset:10240
    buffer_load_dword v22, v21, s[64:67], s41 offen
    buffer_load_dwordx2 a[64:65], v24, s[16:19], 0 offen nt
    buffer_load_dwordx2 a[66:67], v24, s[16:19], s48 offen nt
    buffer_load_dwordx2 a[68:69], v24, s[16:19], s49 offen nt
    buffer_load_dwordx2 a[70:71], v23, s[16:19], 0 offen nt
    buffer_load_dwordx2 a[72:73], v23, s[16:19], s48 offen nt
    buffer_load_dwordx2 a[74:75], v23, s[16:19], s49 offen nt
    buffer_load_dwordx2 a[76:77], v23, s[16:19], s50 offen nt
    buffer_load_dwordx2 a[78:79], v23, s[16:19], s51 offen nt
    buffer_load_dwordx2 a[80:81], v23, s[16:19], s52 offen nt
    buffer_load_dwordx2 a[82:83], v23, s[16:19], s53 offen nt
    buffer_load_dwordx2 a[84:85], v23, s[16:19], s54 offen nt
    v_mfma_f32_16x16x32_bf16 v[72:75], a[8:11], a[36:39], v[72:75]
    ds_read_b128 a[52:55], v17 offset:4096
    s_add_u32 m0, s39, 45056
    s_add_u32 s41, s41, s42
    v_mfma_f32_16x16x32_bf16 v[76:79], a[8:11], a[40:43], v[76:79]
    buffer_load_dwordx4 v14, s[8:11], s36 offen lds
    v_mfma_f32_16x16x32_bf16 v[92:95], a[12:15], a[40:43], v[92:95]
    ds_read_b64_tr_b16 a[4:5], v19 offset:7168
    v_mfma_f32_16x16x32_bf16 v[88:91], a[12:15], a[36:39], v[88:91]
    ds_read_b64_tr_b16 a[6:7], v19 offset:10240
    v_mfma_f32_16x16x32_bf16 v[84:87], a[12:15], a[32:35], v[84:87]
    ds_read_b128 a[56:59], v17 offset:6144
    s_add_u32 m0, s40, 43008
    v_mfma_f32_16x16x32_bf16 v[80:83], a[12:15], a[28:31], v[80:83]
    buffer_load_dwordx4 v15, s[8:11], s36 offen lds
    s_waitcnt lgkmcnt(10)
    v_mfma_f32_16x16x32_bf16 v[96:99], a[16:19], a[28:31], v[96:99]
    ds_read_b64_tr_b16 a[8:9], v18 offset:7232
    v_mfma_f32_16x16x32_bf16 v[100:103], a[16:19], a[32:35], v[100:103]
    ds_read_b64_tr_b16 a[10:11], v18 offset:10304
    v_mfma_f32_16x16x32_bf16 v[104:107], a[16:19], a[36:39], v[104:107]
    v_mfma_f32_16x16x32_bf16 v[108:111], a[16:19], a[40:43], v[108:111]
    v_mfma_f32_16x16x32_bf16 v[124:127], a[20:23], a[40:43], v[124:127]
    ds_read_b64_tr_b16 a[12:13], v19 offset:7232
    v_mfma_f32_16x16x32_bf16 v[120:123], a[20:23], a[36:39], v[120:123]
    ds_read_b64_tr_b16 a[14:15], v19 offset:10304
    s_waitcnt lgkmcnt(4)
    v_mfma_f32_16x16x32_bf16 v[116:119], a[20:23], a[32:35], v[116:119]
    s_add_u32 s36, s36, 229376
    s_add_u32 m0, s38, 0
    v_mfma_f32_16x16x32_bf16 v[112:115], a[20:23], a[28:31], v[112:115]
    buffer_load_dwordx4 v4, s[4:7], s35 offen lds
    v_mfma_f32_16x16x32_bf16 v[128:131], a[24:27], a[28:31], v[128:131]
    ds_read_b64_tr_b16 a[16:17], v18 offset:7296
    v_mfma_f32_16x16x32_bf16 v[132:135], a[24:27], a[32:35], v[132:135]
    ds_read_b64_tr_b16 a[18:19], v18 offset:10368
    v_mfma_f32_16x16x32_bf16 v[136:139], a[24:27], a[36:39], v[136:139]
    s_add_u32 m0, s38, 1024
    v_mfma_f32_16x16x32_bf16 v[140:143], a[24:27], a[40:43], v[140:143]
    buffer_load_dwordx4 v5, s[4:7], s35 offen lds
    v_mfma_f32_16x16x32_bf16 v[156:159], a[0:3], a[40:43], v[156:159]
    ds_read_b64_tr_b16 a[20:21], v19 offset:7296
    v_mfma_f32_16x16x32_bf16 v[152:155], a[0:3], a[36:39], v[152:155]
    ds_read_b64_tr_b16 a[22:23], v19 offset:10368
    v_mfma_f32_16x16x32_bf16 v[148:151], a[0:3], a[32:35], v[148:151]
    s_add_u32 m0, s38, 2048
    v_mfma_f32_16x16x32_bf16 v[144:147], a[0:3], a[28:31], v[144:147]
    buffer_load_dwordx4 v6, s[4:7], s35 offen lds
    s_waitcnt lgkmcnt(6)
    v_mfma_f32_16x16x32_bf16 v[160:163], a[4:7], a[28:31], v[160:163]
    ds_read_b64_tr_b16 a[24:25], v20 offset:13312
    v_mfma_f32_16x16x32_bf16 v[164:167], a[4:7], a[32:35], v[164:167]
    ds_read_b64_tr_b16 a[26:27], v20 offset:13824
    v_mfma_f32_16x16x32_bf16 v[168:171], a[4:7], a[36:39], v[168:171]
    s_add_u32 m0, s38, 3072
    v_mfma_f32_16x16x32_bf16 v[172:175], a[4:7], a[40:43], v[172:175]
    buffer_load_dwordx4 v7, s[4:7], s35 offen lds
    v_mfma_f32_16x16x32_bf16 v[188:191], a[8:11], a[40:43], v[188:191]
    v_mfma_f32_16x16x32_bf16 v[184:187], a[8:11], a[36:39], v[184:187]
    v_mfma_f32_16x16x32_bf16 v[180:183], a[8:11], a[32:35], v[180:183]
    v_mfma_f32_16x16x32_bf16 v[176:179], a[8:11], a[28:31], v[176:179]
    s_waitcnt vmcnt(32) lgkmcnt(0)
    s_barrier
    v_mfma_f32_16x16x32_bf16 v[192:195], a[12:15], a[28:31], v[192:195]
    ds_read_b64_tr_b16 a[0:1], v18 offset:14336
    v_mfma_f32_16x16x32_bf16 v[196:199], a[12:15], a[32:35], v[196:199]
    ds_read_b64_tr_b16 a[2:3], v18 offset:17408
    v_mfma_f32_16x16x32_bf16 v[200:203], a[12:15], a[36:39], v[200:203]
    v_mfma_f32_16x16x32_bf16 v[204:207], a[12:15], a[40:43], v[204:207]
    v_mfma_f32_16x16x32_bf16 v[220:223], a[16:19], a[40:43], v[220:223]
    ds_read_b64_tr_b16 a[4:5], v19 offset:14336
    v_mfma_f32_16x16x32_bf16 v[216:219], a[16:19], a[36:39], v[216:219]
    ds_read_b64_tr_b16 a[6:7], v19 offset:17408
    v_mfma_f32_16x16x32_bf16 v[212:215], a[16:19], a[32:35], v[212:215]
    ds_read_b64_tr_b16 a[8:9], v18 offset:14400
    v_mfma_f32_16x16x32_bf16 v[208:211], a[16:19], a[28:31], v[208:211]
    ds_read_b64_tr_b16 a[10:11], v18 offset:17472
    v_mfma_f32_16x16x32_bf16 a[160:163], a[20:23], a[28:31], a[160:163]
    ds_read_b64_tr_b16 a[12:13], v19 offset:14400
    v_mfma_f32_16x16x32_bf16 a[164:167], a[20:23], a[32:35], a[164:167]
    ds_read_b64_tr_b16 a[14:15], v19 offset:17472
    v_mfma_f32_16x16x32_bf16 a[168:171], a[20:23], a[36:39], a[168:171]
    s_add_u32 m0, s38, 4096
    v_mfma_f32_16x16x32_bf16 a[172:175], a[20:23], a[40:43], a[172:175]
    buffer_load_dwordx4 v8, s[4:7], s35 offen lds
    v_mfma_f32_16x16x32_bf16 a[188:191], a[24:27], a[40:43], a[188:191]
    ds_read_b64_tr_b16 a[16:17], v18 offset:14464
    v_mfma_f32_16x16x32_bf16 a[184:187], a[24:27], a[36:39], a[184:187]
    ds_read_b64_tr_b16 a[18:19], v18 offset:17536
    v_mfma_f32_16x16x32_bf16 a[180:183], a[24:27], a[32:35], a[180:183]
    s_add_u32 m0, s38, 5120
    v_mfma_f32_16x16x32_bf16 a[176:179], a[24:27], a[28:31], a[176:179]
    buffer_load_dwordx4 v9, s[4:7], s35 offen lds
    s_waitcnt lgkmcnt(8)
    v_mfma_f32_16x16x32_bf16 v[32:35], a[0:3], a[44:47], v[32:35]
    ds_read_b64_tr_b16 a[20:21], v19 offset:14464
    v_mfma_f32_16x16x32_bf16 v[36:39], a[0:3], a[48:51], v[36:39]
    ds_read_b64_tr_b16 a[22:23], v19 offset:17536
    v_mfma_f32_16x16x32_bf16 v[40:43], a[0:3], a[52:55], v[40:43]
    s_add_u32 m0, s38, 6144
    v_mfma_f32_16x16x32_bf16 v[44:47], a[0:3], a[56:59], v[44:47]
    buffer_load_dwordx4 v10, s[4:7], s35 offen lds
    s_waitcnt lgkmcnt(8)
    v_mfma_f32_16x16x32_bf16 v[60:63], a[4:7], a[56:59], v[60:63]
    ds_read_b64_tr_b16 a[24:25], v20 offset:20480
    v_mfma_f32_16x16x32_bf16 v[56:59], a[4:7], a[52:55], v[56:59]
    ds_read_b64_tr_b16 a[26:27], v20 offset:20992
    v_mfma_f32_16x16x32_bf16 v[52:55], a[4:7], a[48:51], v[52:55]
    s_add_u32 m0, s38, 7168
    v_mfma_f32_16x16x32_bf16 v[48:51], a[4:7], a[44:47], v[48:51]
    buffer_load_dwordx4 v11, s[4:7], s35 offen lds
    s_waitcnt lgkmcnt(6)
    v_mfma_f32_16x16x32_bf16 v[64:67], a[8:11], a[44:47], v[64:67]
    ds_read_b64_tr_b16 a[0:1], v18 offset:21504
    v_mfma_f32_16x16x32_bf16 v[68:71], a[8:11], a[48:51], v[68:71]
    ds_read_b64_tr_b16 a[2:3], v18 offset:24576
    v_mfma_f32_16x16x32_bf16 v[72:75], a[8:11], a[52:55], v[72:75]
    s_add_u32 s35, s35, 128
    s_add_u32 m0, s39, 0
    v_mfma_f32_16x16x32_bf16 v[76:79], a[8:11], a[56:59], v[76:79]
    buffer_load_dwordx4 v12, s[8:11], s36 offen lds
    v_mfma_f32_16x16x32_bf16 v[92:95], a[12:15], a[56:59], v[92:95]
    ds_read_b64_tr_b16 a[4:5], v19 offset:21504
    v_mfma_f32_16x16x32_bf16 v[88:91], a[12:15], a[52:55], v[88:91]
    ds_read_b64_tr_b16 a[6:7], v19 offset:24576
    v_mfma_f32_16x16x32_bf16 v[84:87], a[12:15], a[48:51], v[84:87]
    s_add_u32 m0, s39, 1024
    v_mfma_f32_16x16x32_bf16 v[80:83], a[12:15], a[44:47], v[80:83]
    buffer_load_dwordx4 v13, s[8:11], s36 offen lds
    s_waitcnt lgkmcnt(6)
    v_mfma_f32_16x16x32_bf16 v[96:99], a[16:19], a[44:47], v[96:99]
    ds_read_b64_tr_b16 a[8:9], v18 offset:21568
    v_mfma_f32_16x16x32_bf16 v[100:103], a[16:19], a[48:51], v[100:103]
    ds_read_b64_tr_b16 a[10:11], v18 offset:24640
    v_mfma_f32_16x16x32_bf16 v[104:107], a[16:19], a[52:55], v[104:107]
    s_add_u32 m0, s39, 2048
    v_mfma_f32_16x16x32_bf16 v[108:111], a[16:19], a[56:59], v[108:111]
    buffer_load_dwordx4 v14, s[8:11], s36 offen lds
    v_mfma_f32_16x16x32_bf16 v[124:127], a[20:23], a[56:59], v[124:127]
    ds_read_b64_tr_b16 a[12:13], v19 offset:21568
    v_mfma_f32_16x16x32_bf16 v[120:123], a[20:23], a[52:55], v[120:123]
    ds_read_b64_tr_b16 a[14:15], v19 offset:24640
    v_mfma_f32_16x16x32_bf16 v[116:119], a[20:23], a[48:51], v[116:119]
    s_add_u32 m0, s40, 0
    v_mfma_f32_16x16x32_bf16 v[112:115], a[20:23], a[44:47], v[112:115]
    buffer_load_dwordx4 v15, s[8:11], s36 offen lds
    s_waitcnt lgkmcnt(6)
    v_mfma_f32_16x16x32_bf16 v[128:131], a[24:27], a[44:47], v[128:131]
    ds_read_b64_tr_b16 a[16:17], v18 offset:21632
    v_mfma_f32_16x16x32_bf16 v[132:135], a[24:27], a[48:51], v[132:135]
    ds_read_b64_tr_b16 a[18:19], v18 offset:24704
    v_mfma_f32_16x16x32_bf16 v[136:139], a[24:27], a[52:55], v[136:139]
    v_mfma_f32_16x16x32_bf16 v[140:143], a[24:27], a[56:59], v[140:143]
    v_mfma_f32_16x16x32_bf16 v[156:159], a[0:3], a[56:59], v[156:159]
    ds_read_b64_tr_b16 a[20:21], v19 offset:21632
    v_mfma_f32_16x16x32_bf16 v[152:155], a[0:3], a[52:55], v[152:155]
    ds_read_b64_tr_b16 a[22:23], v19 offset:24704
    v_mfma_f32_16x16x32_bf16 v[148:151], a[0:3], a[48:51], v[148:151]
    s_add_u32 s36, s36, 229376
    v_mfma_f32_16x16x32_bf16 v[144:147], a[0:3], a[44:47], v[144:147]
    s_waitcnt lgkmcnt(6)
    v_mfma_f32_16x16x32_bf16 v[160:163], a[4:7], a[44:47], v[160:163]
    ds_read_b64_tr_b16 a[24:25], v20 offset:27648
    v_mfma_f32_16x16x32_bf16 v[164:167], a[4:7], a[48:51], v[164:167]
    ds_read_b64_tr_b16 a[26:27], v20 offset:28160
    v_mfma_f32_16x16x32_bf16 v[168:171], a[4:7], a[52:55], v[168:171]
    v_mfma_f32_16x16x32_bf16 v[172:175], a[4:7], a[56:59], v[172:175]
    v_mfma_f32_16x16x32_bf16 v[188:191], a[8:11], a[56:59], v[188:191]
    v_mfma_f32_16x16x32_bf16 v[184:187], a[8:11], a[52:55], v[184:187]
    v_mfma_f32_16x16x32_bf16 v[180:183], a[8:11], a[48:51], v[180:183]
    v_mfma_f32_16x16x32_bf16 v[176:179], a[8:11], a[44:47], v[176:179]
    s_waitcnt vmcnt(28) lgkmcnt(0)
    s_barrier
    ds_read_b128 a[28:31], v16 offset:8192
    v_mfma_f32_16x16x32_bf16 v[192:195], a[12:15], a[44:47], v[192:195]
    ds_read_b64_tr_b16 a[0:1], v18 offset:28672
    v_mfma_f32_16x16x32_bf16 v[196:199], a[12:15], a[48:51], v[196:199]
    ds_read_b64_tr_b16 a[2:3], v18 offset:31744
    v_mfma_f32_16x16x32_bf16 v[200:203], a[12:15], a[52:55], v[200:203]
    ds_read_b128 a[32:35], v16 offset:10240
    v_mfma_f32_16x16x32_bf16 v[204:207], a[12:15], a[56:59], v[204:207]
    ds_read_b128 a[36:39], v16 offset:12288
    v_mfma_f32_16x16x32_bf16 v[220:223], a[16:19], a[56:59], v[220:223]
    ds_read_b128 a[40:43], v16 offset:14336
    v_mfma_f32_16x16x32_bf16 v[216:219], a[16:19], a[52:55], v[216:219]
    ds_read_b64_tr_b16 a[4:5], v19 offset:28672
    v_mfma_f32_16x16x32_bf16 v[212:215], a[16:19], a[48:51], v[212:215]
    ds_read_b64_tr_b16 a[6:7], v19 offset:31744
    v_mfma_f32_16x16x32_bf16 v[208:211], a[16:19], a[44:47], v[208:211]
    ds_read_b64_tr_b16 a[8:9], v18 offset:28736
    v_mfma_f32_16x16x32_bf16 a[160:163], a[20:23], a[44:47], a[160:163]
    ds_read_b64_tr_b16 a[10:11], v18 offset:31808
    v_mfma_f32_16x16x32_bf16 a[164:167], a[20:23], a[48:51], a[164:167]
    ds_read_b64_tr_b16 a[12:13], v19 offset:28736
    v_mfma_f32_16x16x32_bf16 a[168:171], a[20:23], a[52:55], a[168:171]
    ds_read_b64_tr_b16 a[14:15], v19 offset:31808
    s_add_u32 m0, s39, 14336
    v_mfma_f32_16x16x32_bf16 a[172:175], a[20:23], a[56:59], a[172:175]
    buffer_load_dwordx4 v12, s[8:11], s36 offen lds
    v_mfma_f32_16x16x32_bf16 a[188:191], a[24:27], a[56:59], a[188:191]
    ds_read_b64_tr_b16 a[16:17], v18 offset:28800
    v_mfma_f32_16x16x32_bf16 a[184:187], a[24:27], a[52:55], a[184:187]
    ds_read_b64_tr_b16 a[18:19], v18 offset:31872
    v_mfma_f32_16x16x32_bf16 a[180:183], a[24:27], a[48:51], a[180:183]
    s_add_u32 m0, s39, 15360
    v_mfma_f32_16x16x32_bf16 a[176:179], a[24:27], a[44:47], a[176:179]
    buffer_load_dwordx4 v13, s[8:11], s36 offen lds
    s_waitcnt lgkmcnt(11)
    v_mfma_f32_16x16x32_bf16 v[32:35], a[0:3], a[28:31], v[32:35]
    ds_read_b64_tr_b16 a[20:21], v19 offset:28800
    s_waitcnt lgkmcnt(11)
    v_mfma_f32_16x16x32_bf16 v[36:39], a[0:3], a[32:35], v[36:39]
    ds_read_b64_tr_b16 a[22:23], v19 offset:31872
    s_waitcnt lgkmcnt(11)
    v_mfma_f32_16x16x32_bf16 v[40:43], a[0:3], a[36:39], v[40:43]
    ds_read_b128 a[44:47], v17 offset:8192
    s_add_u32 m0, s39, 16384
    s_waitcnt lgkmcnt(11)
    v_mfma_f32_16x16x32_bf16 v[44:47], a[0:3], a[40:43], v[44:47]
    buffer_load_dwordx4 v14, s[8:11], s36 offen lds
    s_waitcnt lgkmcnt(9)
    v_mfma_f32_16x16x32_bf16 v[60:63], a[4:7], a[40:43], v[60:63]
    ds_read_b64_tr_b16 a[24:25], v20 offset:34816
    v_mfma_f32_16x16x32_bf16 v[56:59], a[4:7], a[36:39], v[56:59]
    ds_read_b64_tr_b16 a[26:27], v20 offset:35328
    v_mfma_f32_16x16x32_bf16 v[52:55], a[4:7], a[32:35], v[52:55]
    ds_read_b128 a[48:51], v17 offset:10240
    s_add_u32 m0, s40, 14336
    v_mfma_f32_16x16x32_bf16 v[48:51], a[4:7], a[28:31], v[48:51]
    buffer_load_dwordx4 v15, s[8:11], s36 offen lds
    s_waitcnt lgkmcnt(8)
    v_mfma_f32_16x16x32_bf16 v[64:67], a[8:11], a[28:31], v[64:67]
    ds_read_b64_tr_b16 a[0:1], v18 offset:35840
    v_mfma_f32_16x16x32_bf16 v[68:71], a[8:11], a[32:35], v[68:71]
    ds_read_b64_tr_b16 a[2:3], v18 offset:38912
    buffer_load_dword v22, v3, s[4:7], s92 offen
    v_mfma_f32_16x16x32_bf16 v[72:75], a[8:11], a[36:39], v[72:75]
    ds_read_b128 a[52:55], v17 offset:12288
    s_add_u32 s36, s36, 229376
    s_add_u32 s92, s92, 256
    v_mfma_f32_16x16x32_bf16 v[76:79], a[8:11], a[40:43], v[76:79]
    v_mfma_f32_16x16x32_bf16 v[92:95], a[12:15], a[40:43], v[92:95]
    ds_read_b64_tr_b16 a[4:5], v19 offset:35840
    v_mfma_f32_16x16x32_bf16 v[88:91], a[12:15], a[36:39], v[88:91]
    ds_read_b64_tr_b16 a[6:7], v19 offset:38912
    v_mfma_f32_16x16x32_bf16 v[84:87], a[12:15], a[32:35], v[84:87]
    ds_read_b128 a[56:59], v17 offset:14336
    v_mfma_f32_16x16x32_bf16 v[80:83], a[12:15], a[28:31], v[80:83]
    s_waitcnt lgkmcnt(10)
    v_mfma_f32_16x16x32_bf16 v[96:99], a[16:19], a[28:31], v[96:99]
    ds_read_b64_tr_b16 a[8:9], v18 offset:35904
    v_mfma_f32_16x16x32_bf16 v[100:103], a[16:19], a[32:35], v[100:103]
    ds_read_b64_tr_b16 a[10:11], v18 offset:38976
    v_mfma_f32_16x16x32_bf16 v[104:107], a[16:19], a[36:39], v[104:107]
    v_mfma_f32_16x16x32_bf16 v[108:111], a[16:19], a[40:43], v[108:111]
    v_mfma_f32_16x16x32_bf16 v[124:127], a[20:23], a[40:43], v[124:127]
    ds_read_b64_tr_b16 a[12:13], v19 offset:35904
    v_mfma_f32_16x16x32_bf16 v[120:123], a[20:23], a[36:39], v[120:123]
    ds_read_b64_tr_b16 a[14:15], v19 offset:38976
    s_waitcnt lgkmcnt(4)
    v_mfma_f32_16x16x32_bf16 v[116:119], a[20:23], a[32:35], v[116:119]
    s_add_u32 m0, s38, 8192
    v_mfma_f32_16x16x32_bf16 v[112:115], a[20:23], a[28:31], v[112:115]
    buffer_load_dwordx4 v4, s[4:7], s35 offen lds
    v_mfma_f32_16x16x32_bf16 v[128:131], a[24:27], a[28:31], v[128:131]
    ds_read_b64_tr_b16 a[16:17], v18 offset:35968
    v_mfma_f32_16x16x32_bf16 v[132:135], a[24:27], a[32:35], v[132:135]
    ds_read_b64_tr_b16 a[18:19], v18 offset:39040
    v_mfma_f32_16x16x32_bf16 v[136:139], a[24:27], a[36:39], v[136:139]
    s_add_u32 m0, s38, 9216
    v_mfma_f32_16x16x32_bf16 v[140:143], a[24:27], a[40:43], v[140:143]
    buffer_load_dwordx4 v5, s[4:7], s35 offen lds
    v_mfma_f32_16x16x32_bf16 v[156:159], a[0:3], a[40:43], v[156:159]
    ds_read_b64_tr_b16 a[20:21], v19 offset:35968
    v_mfma_f32_16x16x32_bf16 v[152:155], a[0:3], a[36:39], v[152:155]
    ds_read_b64_tr_b16 a[22:23], v19 offset:39040
    v_mfma_f32_16x16x32_bf16 v[148:151], a[0:3], a[32:35], v[148:151]
    s_add_u32 m0, s38, 10240
    v_mfma_f32_16x16x32_bf16 v[144:147], a[0:3], a[28:31], v[144:147]
    buffer_load_dwordx4 v6, s[4:7], s35 offen lds
    s_waitcnt lgkmcnt(6)
    v_mfma_f32_16x16x32_bf16 v[160:163], a[4:7], a[28:31], v[160:163]
    ds_read_b64_tr_b16 a[24:25], v20 offset:41984
    v_mfma_f32_16x16x32_bf16 v[164:167], a[4:7], a[32:35], v[164:167]
    ds_read_b64_tr_b16 a[26:27], v20 offset:42496
    v_mfma_f32_16x16x32_bf16 v[168:171], a[4:7], a[36:39], v[168:171]
    s_add_u32 m0, s38, 11264
    v_mfma_f32_16x16x32_bf16 v[172:175], a[4:7], a[40:43], v[172:175]
    buffer_load_dwordx4 v7, s[4:7], s35 offen lds
    v_mfma_f32_16x16x32_bf16 v[188:191], a[8:11], a[40:43], v[188:191]
    v_mfma_f32_16x16x32_bf16 v[184:187], a[8:11], a[36:39], v[184:187]
    v_mfma_f32_16x16x32_bf16 v[180:183], a[8:11], a[32:35], v[180:183]
    v_mfma_f32_16x16x32_bf16 v[176:179], a[8:11], a[28:31], v[176:179]
    s_waitcnt vmcnt(21) lgkmcnt(0)
    s_barrier
    v_mfma_f32_16x16x32_bf16 v[192:195], a[12:15], a[28:31], v[192:195]
    ds_read_b64_tr_b16 a[0:1], v18 offset:43008
    v_mfma_f32_16x16x32_bf16 v[196:199], a[12:15], a[32:35], v[196:199]
    ds_read_b64_tr_b16 a[2:3], v18 offset:46080
    v_mfma_f32_16x16x32_bf16 v[200:203], a[12:15], a[36:39], v[200:203]
    v_mfma_f32_16x16x32_bf16 v[204:207], a[12:15], a[40:43], v[204:207]
    v_mfma_f32_16x16x32_bf16 v[220:223], a[16:19], a[40:43], v[220:223]
    ds_read_b64_tr_b16 a[4:5], v19 offset:43008
    v_mfma_f32_16x16x32_bf16 v[216:219], a[16:19], a[36:39], v[216:219]
    ds_read_b64_tr_b16 a[6:7], v19 offset:46080
    v_mfma_f32_16x16x32_bf16 v[212:215], a[16:19], a[32:35], v[212:215]
    ds_read_b64_tr_b16 a[8:9], v18 offset:43072
    v_mfma_f32_16x16x32_bf16 v[208:211], a[16:19], a[28:31], v[208:211]
    ds_read_b64_tr_b16 a[10:11], v18 offset:46144
    v_mfma_f32_16x16x32_bf16 a[160:163], a[20:23], a[28:31], a[160:163]
    ds_read_b64_tr_b16 a[12:13], v19 offset:43072
    v_mfma_f32_16x16x32_bf16 a[164:167], a[20:23], a[32:35], a[164:167]
    ds_read_b64_tr_b16 a[14:15], v19 offset:46144
    v_mfma_f32_16x16x32_bf16 a[168:171], a[20:23], a[36:39], a[168:171]
    s_add_u32 m0, s38, 12288
    v_mfma_f32_16x16x32_bf16 a[172:175], a[20:23], a[40:43], a[172:175]
    buffer_load_dwordx4 v8, s[4:7], s35 offen lds
    v_mfma_f32_16x16x32_bf16 a[188:191], a[24:27], a[40:43], a[188:191]
    ds_read_b64_tr_b16 a[16:17], v18 offset:43136
    v_mfma_f32_16x16x32_bf16 a[184:187], a[24:27], a[36:39], a[184:187]
    ds_read_b64_tr_b16 a[18:19], v18 offset:46208
    v_mfma_f32_16x16x32_bf16 a[180:183], a[24:27], a[32:35], a[180:183]
    s_add_u32 m0, s38, 13312
    v_mfma_f32_16x16x32_bf16 a[176:179], a[24:27], a[28:31], a[176:179]
    buffer_load_dwordx4 v9, s[4:7], s35 offen lds
    s_waitcnt lgkmcnt(8)
    v_mfma_f32_16x16x32_bf16 v[32:35], a[0:3], a[44:47], v[32:35]
    ds_read_b64_tr_b16 a[20:21], v19 offset:43136
    v_mfma_f32_16x16x32_bf16 v[36:39], a[0:3], a[48:51], v[36:39]
    ds_read_b64_tr_b16 a[22:23], v19 offset:46208
    v_mfma_f32_16x16x32_bf16 v[40:43], a[0:3], a[52:55], v[40:43]
    s_add_u32 m0, s38, 14336
    v_mfma_f32_16x16x32_bf16 v[44:47], a[0:3], a[56:59], v[44:47]
    buffer_load_dwordx4 v10, s[4:7], s35 offen lds
    s_waitcnt lgkmcnt(8)
    v_mfma_f32_16x16x32_bf16 v[60:63], a[4:7], a[56:59], v[60:63]
    ds_read_b64_tr_b16 a[24:25], v20 offset:49152
    v_mfma_f32_16x16x32_bf16 v[56:59], a[4:7], a[52:55], v[56:59]
    ds_read_b64_tr_b16 a[26:27], v20 offset:49664
    v_mfma_f32_16x16x32_bf16 v[52:55], a[4:7], a[48:51], v[52:55]
    s_add_u32 m0, s38, 15360
    v_mfma_f32_16x16x32_bf16 v[48:51], a[4:7], a[44:47], v[48:51]
    buffer_load_dwordx4 v11, s[4:7], s35 offen lds
    s_waitcnt lgkmcnt(6)
    v_mfma_f32_16x16x32_bf16 v[64:67], a[8:11], a[44:47], v[64:67]
    ds_read_b64_tr_b16 a[0:1], v18 offset:50176
    v_mfma_f32_16x16x32_bf16 v[68:71], a[8:11], a[48:51], v[68:71]
    ds_read_b64_tr_b16 a[2:3], v18 offset:53248
    v_mfma_f32_16x16x32_bf16 v[72:75], a[8:11], a[52:55], v[72:75]
    s_add_u32 s35, s35, 128
    s_add_u32 m0, s39, 28672
    v_mfma_f32_16x16x32_bf16 v[76:79], a[8:11], a[56:59], v[76:79]
    buffer_load_dwordx4 v12, s[8:11], s36 offen lds
    v_mfma_f32_16x16x32_bf16 v[92:95], a[12:15], a[56:59], v[92:95]
    ds_read_b64_tr_b16 a[4:5], v19 offset:50176
    v_mfma_f32_16x16x32_bf16 v[88:91], a[12:15], a[52:55], v[88:91]
    ds_read_b64_tr_b16 a[6:7], v19 offset:53248
    v_mfma_f32_16x16x32_bf16 v[84:87], a[12:15], a[48:51], v[84:87]
    s_add_u32 m0, s39, 29696
    v_mfma_f32_16x16x32_bf16 v[80:83], a[12:15], a[44:47], v[80:83]
    buffer_load_dwordx4 v13, s[8:11], s36 offen lds
    s_waitcnt lgkmcnt(6)
    v_mfma_f32_16x16x32_bf16 v[96:99], a[16:19], a[44:47], v[96:99]
    ds_read_b64_tr_b16 a[8:9], v18 offset:50240
    v_mfma_f32_16x16x32_bf16 v[100:103], a[16:19], a[48:51], v[100:103]
    ds_read_b64_tr_b16 a[10:11], v18 offset:53312
    v_mfma_f32_16x16x32_bf16 v[104:107], a[16:19], a[52:55], v[104:107]
    s_add_u32 m0, s39, 30720
    v_mfma_f32_16x16x32_bf16 v[108:111], a[16:19], a[56:59], v[108:111]
    buffer_load_dwordx4 v14, s[8:11], s36 offen lds
    v_mfma_f32_16x16x32_bf16 v[124:127], a[20:23], a[56:59], v[124:127]
    ds_read_b64_tr_b16 a[12:13], v19 offset:50240
    v_mfma_f32_16x16x32_bf16 v[120:123], a[20:23], a[52:55], v[120:123]
    ds_read_b64_tr_b16 a[14:15], v19 offset:53312
    v_mfma_f32_16x16x32_bf16 v[116:119], a[20:23], a[48:51], v[116:119]
    s_add_u32 m0, s40, 28672
    v_mfma_f32_16x16x32_bf16 v[112:115], a[20:23], a[44:47], v[112:115]
    buffer_load_dwordx4 v15, s[8:11], s36 offen lds
    s_waitcnt lgkmcnt(6)
    v_mfma_f32_16x16x32_bf16 v[128:131], a[24:27], a[44:47], v[128:131]
    ds_read_b64_tr_b16 a[16:17], v18 offset:50304
    v_mfma_f32_16x16x32_bf16 v[132:135], a[24:27], a[48:51], v[132:135]
    ds_read_b64_tr_b16 a[18:19], v18 offset:53376
    v_mfma_f32_16x16x32_bf16 v[136:139], a[24:27], a[52:55], v[136:139]
    v_mfma_f32_16x16x32_bf16 v[140:143], a[24:27], a[56:59], v[140:143]
    v_mfma_f32_16x16x32_bf16 v[156:159], a[0:3], a[56:59], v[156:159]
    ds_read_b64_tr_b16 a[20:21], v19 offset:50304
    v_mfma_f32_16x16x32_bf16 v[152:155], a[0:3], a[52:55], v[152:155]
    ds_read_b64_tr_b16 a[22:23], v19 offset:53376
    v_mfma_f32_16x16x32_bf16 v[148:151], a[0:3], a[48:51], v[148:151]
    s_add_u32 s36, s36, 229376
    v_mfma_f32_16x16x32_bf16 v[144:147], a[0:3], a[44:47], v[144:147]
    s_waitcnt lgkmcnt(6)
    v_mfma_f32_16x16x32_bf16 v[160:163], a[4:7], a[44:47], v[160:163]
    ds_read_b64_tr_b16 a[24:25], v20 offset:56320
    v_mfma_f32_16x16x32_bf16 v[164:167], a[4:7], a[48:51], v[164:167]
    ds_read_b64_tr_b16 a[26:27], v20 offset:56832
    v_mfma_f32_16x16x32_bf16 v[168:171], a[4:7], a[52:55], v[168:171]
    v_mfma_f32_16x16x32_bf16 v[172:175], a[4:7], a[56:59], v[172:175]
    v_mfma_f32_16x16x32_bf16 v[188:191], a[8:11], a[56:59], v[188:191]
    v_mfma_f32_16x16x32_bf16 v[184:187], a[8:11], a[52:55], v[184:187]
    v_mfma_f32_16x16x32_bf16 v[180:183], a[8:11], a[48:51], v[180:183]
    v_mfma_f32_16x16x32_bf16 v[176:179], a[8:11], a[44:47], v[176:179]
    s_waitcnt vmcnt(17) lgkmcnt(0)
    s_barrier
    ds_read_b128 a[28:31], v16 offset:0
    v_mfma_f32_16x16x32_bf16 v[192:195], a[12:15], a[44:47], v[192:195]
    ds_read_b64_tr_b16 a[0:1], v18 offset:0
    v_mfma_f32_16x16x32_bf16 v[196:199], a[12:15], a[48:51], v[196:199]
    ds_read_b64_tr_b16 a[2:3], v18 offset:3072
    v_mfma_f32_16x16x32_bf16 v[200:203], a[12:15], a[52:55], v[200:203]
    ds_read_b128 a[32:35], v16 offset:2048
    v_mfma_f32_16x16x32_bf16 v[204:207], a[12:15], a[56:59], v[204:207]
    ds_read_b128 a[36:39], v16 offset:4096
    v_mfma_f32_16x16x32_bf16 v[220:223], a[16:19], a[56:59], v[220:223]
    ds_read_b128 a[40:43], v16 offset:6144
    v_mfma_f32_16x16x32_bf16 v[216:219], a[16:19], a[52:55], v[216:219]
    ds_read_b64_tr_b16 a[4:5], v19 offset:0
    v_mfma_f32_16x16x32_bf16 v[212:215], a[16:19], a[48:51], v[212:215]
    ds_read_b64_tr_b16 a[6:7], v19 offset:3072
    v_mfma_f32_16x16x32_bf16 v[208:211], a[16:19], a[44:47], v[208:211]
    ds_read_b64_tr_b16 a[8:9], v18 offset:64
    v_mfma_f32_16x16x32_bf16 a[160:163], a[20:23], a[44:47], a[160:163]
    ds_read_b64_tr_b16 a[10:11], v18 offset:3136
    v_mfma_f32_16x16x32_bf16 a[164:167], a[20:23], a[48:51], a[164:167]
    ds_read_b64_tr_b16 a[12:13], v19 offset:64
    v_mfma_f32_16x16x32_bf16 a[168:171], a[20:23], a[52:55], a[168:171]
    ds_read_b64_tr_b16 a[14:15], v19 offset:3136
    s_add_u32 m0, s39, 43008
    v_mfma_f32_16x16x32_bf16 a[172:175], a[20:23], a[56:59], a[172:175]
    buffer_load_dwordx4 v12, s[8:11], s36 offen lds
    v_mfma_f32_16x16x32_bf16 a[188:191], a[24:27], a[56:59], a[188:191]
    ds_read_b64_tr_b16 a[16:17], v18 offset:128
    v_mfma_f32_16x16x32_bf16 a[184:187], a[24:27], a[52:55], a[184:187]
    ds_read_b64_tr_b16 a[18:19], v18 offset:3200
    v_mfma_f32_16x16x32_bf16 a[180:183], a[24:27], a[48:51], a[180:183]
    s_add_u32 m0, s39, 44032
    v_mfma_f32_16x16x32_bf16 a[176:179], a[24:27], a[44:47], a[176:179]
    buffer_load_dwordx4 v13, s[8:11], s36 offen lds
    s_waitcnt lgkmcnt(11)
    v_mfma_f32_16x16x32_bf16 v[32:35], a[0:3], a[28:31], v[32:35]
    ds_read_b64_tr_b16 a[20:21], v19 offset:128
    s_waitcnt lgkmcnt(11)
    v_mfma_f32_16x16x32_bf16 v[36:39], a[0:3], a[32:35], v[36:39]
    ds_read_b64_tr_b16 a[22:23], v19 offset:3200
    s_waitcnt lgkmcnt(11)
    v_mfma_f32_16x16x32_bf16 v[40:43], a[0:3], a[36:39], v[40:43]
    ds_read_b128 a[44:47], v17 offset:0
    s_add_u32 m0, s39, 45056
    s_waitcnt lgkmcnt(11)
    v_mfma_f32_16x16x32_bf16 v[44:47], a[0:3], a[40:43], v[44:47]
    buffer_load_dwordx4 v14, s[8:11], s36 offen lds
    s_waitcnt lgkmcnt(9)
    v_mfma_f32_16x16x32_bf16 v[60:63], a[4:7], a[40:43], v[60:63]
    ds_read_b64_tr_b16 a[24:25], v20 offset:6144
    v_mfma_f32_16x16x32_bf16 v[56:59], a[4:7], a[36:39], v[56:59]
    ds_read_b64_tr_b16 a[26:27], v20 offset:6656
    v_mfma_f32_16x16x32_bf16 v[52:55], a[4:7], a[32:35], v[52:55]
    ds_read_b128 a[48:51], v17 offset:2048
    s_add_u32 m0, s40, 43008
    v_mfma_f32_16x16x32_bf16 v[48:51], a[4:7], a[28:31], v[48:51]
    buffer_load_dwordx4 v15, s[8:11], s36 offen lds
    s_waitcnt lgkmcnt(8)
    v_mfma_f32_16x16x32_bf16 v[64:67], a[8:11], a[28:31], v[64:67]
    ds_read_b64_tr_b16 a[0:1], v18 offset:7168
    v_mfma_f32_16x16x32_bf16 v[68:71], a[8:11], a[32:35], v[68:71]
    ds_read_b64_tr_b16 a[2:3], v18 offset:10240
    buffer_load_dword v22, v21, s[64:67], s41 offen
    buffer_load_dwordx2 a[86:87], v23, s[20:23], 0 offen nt
    buffer_load_dwordx2 a[88:89], v23, s[20:23], s48 offen nt
    buffer_load_dwordx2 a[90:91], v23, s[20:23], s49 offen nt
    buffer_load_dwordx2 a[92:93], v23, s[20:23], s50 offen nt
    buffer_load_dwordx2 a[94:95], v23, s[20:23], s51 offen nt
    buffer_load_dwordx2 a[96:97], v23, s[20:23], s52 offen nt
    buffer_load_dwordx2 a[98:99], v23, s[20:23], s53 offen nt
    buffer_load_dwordx2 a[100:101], v23, s[20:23], s54 offen nt
    buffer_load_dwordx4 a[102:105], v25, s[24:27], 0 offen
    buffer_load_dwordx4 a[106:109], v25, s[24:27], 0 offen offset:16
    v_mfma_f32_16x16x32_bf16 v[72:75], a[8:11], a[36:39], v[72:75]
    ds_read_b128 a[52:55], v17 offset:4096
    s_add_u32 s36, s36, 229376
    s_add_u32 s41, s41, s42
    v_mfma_f32_16x16x32_bf16 v[76:79], a[8:11], a[40:43], v[76:79]
    v_mfma_f32_16x16x32_bf16 v[92:95], a[12:15], a[40:43], v[92:95]
    ds_read_b64_tr_b16 a[4:5], v19 offset:7168
    v_mfma_f32_16x16x32_bf16 v[88:91], a[12:15], a[36:39], v[88:91]
    ds_read_b64_tr_b16 a[6:7], v19 offset:10240
    v_mfma_f32_16x16x32_bf16 v[84:87], a[12:15], a[32:35], v[84:87]
    ds_read_b128 a[56:59], v17 offset:6144
    v_mfma_f32_16x16x32_bf16 v[80:83], a[12:15], a[28:31], v[80:83]
    s_waitcnt lgkmcnt(10)
    v_mfma_f32_16x16x32_bf16 v[96:99], a[16:19], a[28:31], v[96:99]
    ds_read_b64_tr_b16 a[8:9], v18 offset:7232
    v_mfma_f32_16x16x32_bf16 v[100:103], a[16:19], a[32:35], v[100:103]
    ds_read_b64_tr_b16 a[10:11], v18 offset:10304
    v_mfma_f32_16x16x32_bf16 v[104:107], a[16:19], a[36:39], v[104:107]
    v_mfma_f32_16x16x32_bf16 v[108:111], a[16:19], a[40:43], v[108:111]
    v_mfma_f32_16x16x32_bf16 v[124:127], a[20:23], a[40:43], v[124:127]
    ds_read_b64_tr_b16 a[12:13], v19 offset:7232
    v_mfma_f32_16x16x32_bf16 v[120:123], a[20:23], a[36:39], v[120:123]
    ds_read_b64_tr_b16 a[14:15], v19 offset:10304
    s_waitcnt lgkmcnt(4)
    v_mfma_f32_16x16x32_bf16 v[116:119], a[20:23], a[32:35], v[116:119]
    s_add_u32 m0, s38, 0
    v_mfma_f32_16x16x32_bf16 v[112:115], a[20:23], a[28:31], v[112:115]
    buffer_load_dwordx4 v4, s[4:7], s35 offen lds
    v_mfma_f32_16x16x32_bf16 v[128:131], a[24:27], a[28:31], v[128:131]
    ds_read_b64_tr_b16 a[16:17], v18 offset:7296
    v_mfma_f32_16x16x32_bf16 v[132:135], a[24:27], a[32:35], v[132:135]
    ds_read_b64_tr_b16 a[18:19], v18 offset:10368
    v_mfma_f32_16x16x32_bf16 v[136:139], a[24:27], a[36:39], v[136:139]
    s_add_u32 m0, s38, 1024
    v_mfma_f32_16x16x32_bf16 v[140:143], a[24:27], a[40:43], v[140:143]
    buffer_load_dwordx4 v5, s[4:7], s35 offen lds
    v_mfma_f32_16x16x32_bf16 v[156:159], a[0:3], a[40:43], v[156:159]
    ds_read_b64_tr_b16 a[20:21], v19 offset:7296
    v_mfma_f32_16x16x32_bf16 v[152:155], a[0:3], a[36:39], v[152:155]
    ds_read_b64_tr_b16 a[22:23], v19 offset:10368
    v_mfma_f32_16x16x32_bf16 v[148:151], a[0:3], a[32:35], v[148:151]
    s_add_u32 m0, s38, 2048
    v_mfma_f32_16x16x32_bf16 v[144:147], a[0:3], a[28:31], v[144:147]
    buffer_load_dwordx4 v6, s[4:7], s35 offen lds
    s_waitcnt lgkmcnt(6)
    v_mfma_f32_16x16x32_bf16 v[160:163], a[4:7], a[28:31], v[160:163]
    ds_read_b64_tr_b16 a[24:25], v20 offset:13312
    v_mfma_f32_16x16x32_bf16 v[164:167], a[4:7], a[32:35], v[164:167]
    ds_read_b64_tr_b16 a[26:27], v20 offset:13824
    v_mfma_f32_16x16x32_bf16 v[168:171], a[4:7], a[36:39], v[168:171]
    s_add_u32 m0, s38, 3072
    v_mfma_f32_16x16x32_bf16 v[172:175], a[4:7], a[40:43], v[172:175]
    buffer_load_dwordx4 v7, s[4:7], s35 offen lds
    v_mfma_f32_16x16x32_bf16 v[188:191], a[8:11], a[40:43], v[188:191]
    v_mfma_f32_16x16x32_bf16 v[184:187], a[8:11], a[36:39], v[184:187]
    v_mfma_f32_16x16x32_bf16 v[180:183], a[8:11], a[32:35], v[180:183]
    v_mfma_f32_16x16x32_bf16 v[176:179], a[8:11], a[28:31], v[176:179]
    s_waitcnt vmcnt(32) lgkmcnt(0)
    s_barrier
    v_mfma_f32_16x16x32_bf16 v[192:195], a[12:15], a[28:31], v[192:195]
    ds_read_b64_tr_b16 a[0:1], v18 offset:14336
    v_mfma_f32_16x16x32_bf16 v[196:199], a[12:15], a[32:35], v[196:199]
    ds_read_b64_tr_b16 a[2:3], v18 offset:17408
    v_mfma_f32_16x16x32_bf16 v[200:203], a[12:15], a[36:39], v[200:203]
    s_load_dword s60, s[78:79], 0
    v_mfma_f32_16x16x32_bf16 v[204:207], a[12:15], a[40:43], v[204:207]
    v_mfma_f32_16x16x32_bf16 v[220:223], a[16:19], a[40:43], v[220:223]
    ds_read_b64_tr_b16 a[4:5], v19 offset:14336
    v_mfma_f32_16x16x32_bf16 v[216:219], a[16:19], a[36:39], v[216:219]
    ds_read_b64_tr_b16 a[6:7], v19 offset:17408
    v_mfma_f32_16x16x32_bf16 v[212:215], a[16:19], a[32:35], v[212:215]
    ds_read_b64_tr_b16 a[8:9], v18 offset:14400
    v_mfma_f32_16x16x32_bf16 v[208:211], a[16:19], a[28:31], v[208:211]
    ds_read_b64_tr_b16 a[10:11], v18 offset:17472
    v_mfma_f32_16x16x32_bf16 a[160:163], a[20:23], a[28:31], a[160:163]
    ds_read_b64_tr_b16 a[12:13], v19 offset:14400
    v_mfma_f32_16x16x32_bf16 a[164:167], a[20:23], a[32:35], a[164:167]
    ds_read_b64_tr_b16 a[14:15], v19 offset:17472
    v_mfma_f32_16x16x32_bf16 a[168:171], a[20:23], a[36:39], a[168:171]
    s_add_u32 m0, s38, 4096
    v_mfma_f32_16x16x32_bf16 a[172:175], a[20:23], a[40:43], a[172:175]
    buffer_load_dwordx4 v8, s[4:7], s35 offen lds
    v_mfma_f32_16x16x32_bf16 a[188:191], a[24:27], a[40:43], a[188:191]
    ds_read_b64_tr_b16 a[16:17], v18 offset:14464
    v_mfma_f32_16x16x32_bf16 a[184:187], a[24:27], a[36:39], a[184:187]
    ds_read_b64_tr_b16 a[18:19], v18 offset:17536
    v_mfma_f32_16x16x32_bf16 a[180:183], a[24:27], a[32:35], a[180:183]
    s_add_u32 m0, s38, 5120
    v_mfma_f32_16x16x32_bf16 a[176:179], a[24:27], a[28:31], a[176:179]
    buffer_load_dwordx4 v9, s[4:7], s35 offen lds
    s_waitcnt lgkmcnt(8)
    v_mfma_f32_16x16x32_bf16 v[32:35], a[0:3], a[44:47], v[32:35]
    ds_read_b64_tr_b16 a[20:21], v19 offset:14464
    v_mfma_f32_16x16x32_bf16 v[36:39], a[0:3], a[48:51], v[36:39]
    ds_read_b64_tr_b16 a[22:23], v19 offset:17536
    v_mfma_f32_16x16x32_bf16 v[40:43], a[0:3], a[52:55], v[40:43]
    s_add_u32 m0, s38, 6144
    v_mfma_f32_16x16x32_bf16 v[44:47], a[0:3], a[56:59], v[44:47]
    buffer_load_dwordx4 v10, s[4:7], s35 offen lds
    s_waitcnt lgkmcnt(8)
    v_mfma_f32_16x16x32_bf16 v[60:63], a[4:7], a[56:59], v[60:63]
    ds_read_b64_tr_b16 a[24:25], v20 offset:20480
    v_mfma_f32_16x16x32_bf16 v[56:59], a[4:7], a[52:55], v[56:59]
    ds_read_b64_tr_b16 a[26:27], v20 offset:20992
    v_mfma_f32_16x16x32_bf16 v[52:55], a[4:7], a[48:51], v[52:55]
    s_add_u32 m0, s38, 7168
    v_mfma_f32_16x16x32_bf16 v[48:51], a[4:7], a[44:47], v[48:51]
    buffer_load_dwordx4 v11, s[4:7], s35 offen lds
    s_waitcnt lgkmcnt(6)
    v_mfma_f32_16x16x32_bf16 v[64:67], a[8:11], a[44:47], v[64:67]
    ds_read_b64_tr_b16 a[0:1], v18 offset:21504
    v_mfma_f32_16x16x32_bf16 v[68:71], a[8:11], a[48:51], v[68:71]
    ds_read_b64_tr_b16 a[2:3], v18 offset:24576
    v_mfma_f32_16x16x32_bf16 v[72:75], a[8:11], a[52:55], v[72:75]
    s_add_u32 s35, s35, 128
    s_add_u32 m0, s39, 0
    v_mfma_f32_16x16x32_bf16 v[76:79], a[8:11], a[56:59], v[76:79]
    buffer_load_dwordx4 v12, s[8:11], s36 offen lds
    v_mfma_f32_16x16x32_bf16 v[92:95], a[12:15], a[56:59], v[92:95]
    ds_read_b64_tr_b16 a[4:5], v19 offset:21504
    v_mfma_f32_16x16x32_bf16 v[88:91], a[12:15], a[52:55], v[88:91]
    ds_read_b64_tr_b16 a[6:7], v19 offset:24576
    v_mfma_f32_16x16x32_bf16 v[84:87], a[12:15], a[48:51], v[84:87]
    s_add_u32 m0, s39, 1024
    v_mfma_f32_16x16x32_bf16 v[80:83], a[12:15], a[44:47], v[80:83]
    buffer_load_dwordx4 v13, s[8:11], s36 offen lds
    s_waitcnt lgkmcnt(6)
    v_mfma_f32_16x16x32_bf16 v[96:99], a[16:19], a[44:47], v[96:99]
    ds_read_b64_tr_b16 a[8:9], v18 offset:21568
    v_mfma_f32_16x16x32_bf16 v[100:103], a[16:19], a[48:51], v[100:103]
    ds_read_b64_tr_b16 a[10:11], v18 offset:24640
    v_mfma_f32_16x16x32_bf16 v[104:107], a[16:19], a[52:55], v[104:107]
    s_add_u32 m0, s39, 2048
    v_mfma_f32_16x16x32_bf16 v[108:111], a[16:19], a[56:59], v[108:111]
    buffer_load_dwordx4 v14, s[8:11], s36 offen lds
    v_mfma_f32_16x16x32_bf16 v[124:127], a[20:23], a[56:59], v[124:127]
    ds_read_b64_tr_b16 a[12:13], v19 offset:21568
    v_mfma_f32_16x16x32_bf16 v[120:123], a[20:23], a[52:55], v[120:123]
    ds_read_b64_tr_b16 a[14:15], v19 offset:24640
    v_mfma_f32_16x16x32_bf16 v[116:119], a[20:23], a[48:51], v[116:119]
    s_add_u32 m0, s40, 0
    v_mfma_f32_16x16x32_bf16 v[112:115], a[20:23], a[44:47], v[112:115]
    buffer_load_dwordx4 v15, s[8:11], s36 offen lds
    s_waitcnt lgkmcnt(6)
    v_mfma_f32_16x16x32_bf16 v[128:131], a[24:27], a[44:47], v[128:131]
    ds_read_b64_tr_b16 a[16:17], v18 offset:21632
    v_mfma_f32_16x16x32_bf16 v[132:135], a[24:27], a[48:51], v[132:135]
    ds_read_b64_tr_b16 a[18:19], v18 offset:24704
    v_mfma_f32_16x16x32_bf16 v[136:139], a[24:27], a[52:55], v[136:139]
    v_mfma_f32_16x16x32_bf16 v[140:143], a[24:27], a[56:59], v[140:143]
    v_mfma_f32_16x16x32_bf16 v[156:159], a[0:3], a[56:59], v[156:159]
    ds_read_b64_tr_b16 a[20:21], v19 offset:21632
    v_mfma_f32_16x16x32_bf16 v[152:155], a[0:3], a[52:55], v[152:155]
    ds_read_b64_tr_b16 a[22:23], v19 offset:24704
    v_mfma_f32_16x16x32_bf16 v[148:151], a[0:3], a[48:51], v[148:151]
    s_add_u32 s36, s36, 229376
    v_mfma_f32_16x16x32_bf16 v[144:147], a[0:3], a[44:47], v[144:147]
    s_waitcnt lgkmcnt(6)
    v_mfma_f32_16x16x32_bf16 v[160:163], a[4:7], a[44:47], v[160:163]
    ds_read_b64_tr_b16 a[24:25], v20 offset:27648
    v_mfma_f32_16x16x32_bf16 v[164:167], a[4:7], a[48:51], v[164:167]
    ds_read_b64_tr_b16 a[26:27], v20 offset:28160
    v_mfma_f32_16x16x32_bf16 v[168:171], a[4:7], a[52:55], v[168:171]
    v_mfma_f32_16x16x32_bf16 v[172:175], a[4:7], a[56:59], v[172:175]
    v_mfma_f32_16x16x32_bf16 v[188:191], a[8:11], a[56:59], v[188:191]
    v_mfma_f32_16x16x32_bf16 v[184:187], a[8:11], a[52:55], v[184:187]
    v_mfma_f32_16x16x32_bf16 v[180:183], a[8:11], a[48:51], v[180:183]
    v_mfma_f32_16x16x32_bf16 v[176:179], a[8:11], a[44:47], v[176:179]
    s_waitcnt vmcnt(27) lgkmcnt(0)
    s_barrier
    ds_read_b128 a[28:31], v16 offset:8192
    v_mfma_f32_16x16x32_bf16 v[192:195], a[12:15], a[44:47], v[192:195]
    ds_read_b64_tr_b16 a[0:1], v18 offset:28672
    v_mfma_f32_16x16x32_bf16 v[196:199], a[12:15], a[48:51], v[196:199]
    ds_read_b64_tr_b16 a[2:3], v18 offset:31744
    v_mfma_f32_16x16x32_bf16 v[200:203], a[12:15], a[52:55], v[200:203]
    ds_read_b128 a[32:35], v16 offset:10240
    v_mfma_f32_16x16x32_bf16 v[204:207], a[12:15], a[56:59], v[204:207]
    ds_read_b128 a[36:39], v16 offset:12288
    v_mfma_f32_16x16x32_bf16 v[220:223], a[16:19], a[56:59], v[220:223]
    ds_read_b128 a[40:43], v16 offset:14336
    v_mfma_f32_16x16x32_bf16 v[216:219], a[16:19], a[52:55], v[216:219]
    ds_read_b64_tr_b16 a[4:5], v19 offset:28672
    v_mfma_f32_16x16x32_bf16 v[212:215], a[16:19], a[48:51], v[212:215]
    ds_read_b64_tr_b16 a[6:7], v19 offset:31744
    v_mfma_f32_16x16x32_bf16 v[208:211], a[16:19], a[44:47], v[208:211]
    ds_read_b64_tr_b16 a[8:9], v18 offset:28736
    v_mfma_f32_16x16x32_bf16 a[160:163], a[20:23], a[44:47], a[160:163]
    ds_read_b64_tr_b16 a[10:11], v18 offset:31808
    v_mfma_f32_16x16x32_bf16 a[164:167], a[20:23], a[48:51], a[164:167]
    ds_read_b64_tr_b16 a[12:13], v19 offset:28736
    v_mfma_f32_16x16x32_bf16 a[168:171], a[20:23], a[52:55], a[168:171]
    ds_read_b64_tr_b16 a[14:15], v19 offset:31808
    s_add_u32 m0, s39, 14336
    v_mfma_f32_16x16x32_bf16 a[172:175], a[20:23], a[56:59], a[172:175]
    buffer_load_dwordx4 v12, s[8:11], s36 offen lds
    v_mfma_f32_16x16x32_bf16 a[188:191], a[24:27], a[56:59], a[188:191]
    ds_read_b64_tr_b16 a[16:17], v18 offset:28800
    v_mfma_f32_16x16x32_bf16 a[184:187], a[24:27], a[52:55], a[184:187]
    ds_read_b64_tr_b16 a[18:19], v18 offset:31872
    v_mfma_f32_16x16x32_bf16 a[180:183], a[24:27], a[48:51], a[180:183]
    s_add_u32 m0, s39, 15360
    v_mfma_f32_16x16x32_bf16 a[176:179], a[24:27], a[44:47], a[176:179]
    buffer_load_dwordx4 v13, s[8:11], s36 offen lds
    s_waitcnt lgkmcnt(11)
    v_mfma_f32_16x16x32_bf16 v[32:35], a[0:3], a[28:31], v[32:35]
    ds_read_b64_tr_b16 a[20:21], v19 offset:28800
    s_waitcnt lgkmcnt(11)
    v_mfma_f32_16x16x32_bf16 v[36:39], a[0:3], a[32:35], v[36:39]
    ds_read_b64_tr_b16 a[22:23], v19 offset:31872
    s_waitcnt lgkmcnt(11)
    v_mfma_f32_16x16x32_bf16 v[40:43], a[0:3], a[36:39], v[40:43]
    ds_read_b128 a[44:47], v17 offset:8192
    s_add_u32 m0, s39, 16384
    s_waitcnt lgkmcnt(11)
    v_mfma_f32_16x16x32_bf16 v[44:47], a[0:3], a[40:43], v[44:47]
    buffer_load_dwordx4 v14, s[8:11], s36 offen lds
    s_waitcnt lgkmcnt(9)
    v_mfma_f32_16x16x32_bf16 v[60:63], a[4:7], a[40:43], v[60:63]
    ds_read_b64_tr_b16 a[24:25], v20 offset:34816
    v_mfma_f32_16x16x32_bf16 v[56:59], a[4:7], a[36:39], v[56:59]
    ds_read_b64_tr_b16 a[26:27], v20 offset:35328
    v_mfma_f32_16x16x32_bf16 v[52:55], a[4:7], a[32:35], v[52:55]
    ds_read_b128 a[48:51], v17 offset:10240
    s_add_u32 m0, s40, 14336
    v_mfma_f32_16x16x32_bf16 v[48:51], a[4:7], a[28:31], v[48:51]
    buffer_load_dwordx4 v15, s[8:11], s36 offen lds
    s_waitcnt lgkmcnt(8)
    v_mfma_f32_16x16x32_bf16 v[64:67], a[8:11], a[28:31], v[64:67]
    ds_read_b64_tr_b16 a[0:1], v18 offset:35840
    v_mfma_f32_16x16x32_bf16 v[68:71], a[8:11], a[32:35], v[68:71]
    ds_read_b64_tr_b16 a[2:3], v18 offset:38912
    buffer_load_dword v22, v3, s[4:7], s92 offen
    v_mfma_f32_16x16x32_bf16 v[72:75], a[8:11], a[36:39], v[72:75]
    ds_read_b128 a[52:55], v17 offset:12288
    s_add_u32 s36, s36, 229376
    s_add_u32 s92, s92, 256
    v_mfma_f32_16x16x32_bf16 v[76:79], a[8:11], a[40:43], v[76:79]
    v_mfma_f32_16x16x32_bf16 v[92:95], a[12:15], a[40:43], v[92:95]
    ds_read_b64_tr_b16 a[4:5], v19 offset:35840
    v_mfma_f32_16x16x32_bf16 v[88:91], a[12:15], a[36:39], v[88:91]
    ds_read_b64_tr_b16 a[6:7], v19 offset:38912
    v_mfma_f32_16x16x32_bf16 v[84:87], a[12:15], a[32:35], v[84:87]
    ds_read_b128 a[56:59], v17 offset:14336
    v_mfma_f32_16x16x32_bf16 v[80:83], a[12:15], a[28:31], v[80:83]
    s_waitcnt lgkmcnt(10)
    v_mfma_f32_16x16x32_bf16 v[96:99], a[16:19], a[28:31], v[96:99]
    ds_read_b64_tr_b16 a[8:9], v18 offset:35904
    v_mfma_f32_16x16x32_bf16 v[100:103], a[16:19], a[32:35], v[100:103]
    ds_read_b64_tr_b16 a[10:11], v18 offset:38976
    v_mfma_f32_16x16x32_bf16 v[104:107], a[16:19], a[36:39], v[104:107]
    v_mfma_f32_16x16x32_bf16 v[108:111], a[16:19], a[40:43], v[108:111]
    v_mfma_f32_16x16x32_bf16 v[124:127], a[20:23], a[40:43], v[124:127]
    ds_read_b64_tr_b16 a[12:13], v19 offset:35904
    v_mfma_f32_16x16x32_bf16 v[120:123], a[20:23], a[36:39], v[120:123]
    ds_read_b64_tr_b16 a[14:15], v19 offset:38976
    s_waitcnt lgkmcnt(4)
    v_mfma_f32_16x16x32_bf16 v[116:119], a[20:23], a[32:35], v[116:119]
    s_add_u32 m0, s38, 8192
    v_mfma_f32_16x16x32_bf16 v[112:115], a[20:23], a[28:31], v[112:115]
    buffer_load_dwordx4 v4, s[4:7], s35 offen lds
    v_mfma_f32_16x16x32_bf16 v[128:131], a[24:27], a[28:31], v[128:131]
    ds_read_b64_tr_b16 a[16:17], v18 offset:35968
    v_mfma_f32_16x16x32_bf16 v[132:135], a[24:27], a[32:35], v[132:135]
    ds_read_b64_tr_b16 a[18:19], v18 offset:39040
    v_mfma_f32_16x16x32_bf16 v[136:139], a[24:27], a[36:39], v[136:139]
    s_add_u32 m0, s38, 9216
    v_mfma_f32_16x16x32_bf16 v[140:143], a[24:27], a[40:43], v[140:143]
    buffer_load_dwordx4 v5, s[4:7], s35 offen lds
    v_mfma_f32_16x16x32_bf16 v[156:159], a[0:3], a[40:43], v[156:159]
    ds_read_b64_tr_b16 a[20:21], v19 offset:35968
    v_mfma_f32_16x16x32_bf16 v[152:155], a[0:3], a[36:39], v[152:155]
    ds_read_b64_tr_b16 a[22:23], v19 offset:39040
    v_mfma_f32_16x16x32_bf16 v[148:151], a[0:3], a[32:35], v[148:151]
    s_add_u32 m0, s38, 10240
    v_mfma_f32_16x16x32_bf16 v[144:147], a[0:3], a[28:31], v[144:147]
    buffer_load_dwordx4 v6, s[4:7], s35 offen lds
    s_waitcnt lgkmcnt(6)
    v_mfma_f32_16x16x32_bf16 v[160:163], a[4:7], a[28:31], v[160:163]
    ds_read_b64_tr_b16 a[24:25], v20 offset:41984
    v_mfma_f32_16x16x32_bf16 v[164:167], a[4:7], a[32:35], v[164:167]
    ds_read_b64_tr_b16 a[26:27], v20 offset:42496
    v_mfma_f32_16x16x32_bf16 v[168:171], a[4:7], a[36:39], v[168:171]
    s_add_u32 m0, s38, 11264
    v_mfma_f32_16x16x32_bf16 v[172:175], a[4:7], a[40:43], v[172:175]
    buffer_load_dwordx4 v7, s[4:7], s35 offen lds
    v_mfma_f32_16x16x32_bf16 v[188:191], a[8:11], a[40:43], v[188:191]
    v_mfma_f32_16x16x32_bf16 v[184:187], a[8:11], a[36:39], v[184:187]
    v_mfma_f32_16x16x32_bf16 v[180:183], a[8:11], a[32:35], v[180:183]
    v_mfma_f32_16x16x32_bf16 v[176:179], a[8:11], a[28:31], v[176:179]
    s_waitcnt vmcnt(32) lgkmcnt(0)
    s_barrier
    v_mfma_f32_16x16x32_bf16 v[192:195], a[12:15], a[28:31], v[192:195]
    ds_read_b64_tr_b16 a[0:1], v18 offset:43008
    v_mfma_f32_16x16x32_bf16 v[196:199], a[12:15], a[32:35], v[196:199]
    ds_read_b64_tr_b16 a[2:3], v18 offset:46080
    v_mfma_f32_16x16x32_bf16 v[200:203], a[12:15], a[36:39], v[200:203]
    v_mfma_f32_16x16x32_bf16 v[204:207], a[12:15], a[40:43], v[204:207]
    v_mfma_f32_16x16x32_bf16 v[220:223], a[16:19], a[40:43], v[220:223]
    ds_read_b64_tr_b16 a[4:5], v19 offset:43008
    v_mfma_f32_16x16x32_bf16 v[216:219], a[16:19], a[36:39], v[216:219]
    ds_read_b64_tr_b16 a[6:7], v19 offset:46080
    v_mfma_f32_16x16x32_bf16 v[212:215], a[16:19], a[32:35], v[212:215]
    ds_read_b64_tr_b16 a[8:9], v18 offset:43072
    v_mfma_f32_16x16x32_bf16 v[208:211], a[16:19], a[28:31], v[208:211]
    ds_read_b64_tr_b16 a[10:11], v18 offset:46144
    v_mfma_f32_16x16x32_bf16 a[160:163], a[20:23], a[28:31], a[160:163]
    ds_read_b64_tr_b16 a[12:13], v19 offset:43072
    v_mfma_f32_16x16x32_bf16 a[164:167], a[20:23], a[32:35], a[164:167]
    ds_read_b64_tr_b16 a[14:15], v19 offset:46144
    v_mfma_f32_16x16x32_bf16 a[168:171], a[20:23], a[36:39], a[168:171]
    s_add_u32 m0, s38, 12288
    v_mfma_f32_16x16x32_bf16 a[172:175], a[20:23], a[40:43], a[172:175]
    buffer_load_dwordx4 v8, s[4:7], s35 offen lds
    v_mfma_f32_16x16x32_bf16 a[188:191], a[24:27], a[40:43], a[188:191]
    ds_read_b64_tr_b16 a[16:17], v18 offset:43136
    v_mfma_f32_16x16x32_bf16 a[184:187], a[24:27], a[36:39], a[184:187]
    ds_read_b64_tr_b16 a[18:19], v18 offset:46208
    v_mfma_f32_16x16x32_bf16 a[180:183], a[24:27], a[32:35], a[180:183]
    s_add_u32 m0, s38, 13312
    v_mfma_f32_16x16x32_bf16 a[176:179], a[24:27], a[28:31], a[176:179]
    buffer_load_dwordx4 v9, s[4:7], s35 offen lds
    s_waitcnt lgkmcnt(8)
    v_mfma_f32_16x16x32_bf16 v[32:35], a[0:3], a[44:47], v[32:35]
    ds_read_b64_tr_b16 a[20:21], v19 offset:43136
    v_mfma_f32_16x16x32_bf16 v[36:39], a[0:3], a[48:51], v[36:39]
    ds_read_b64_tr_b16 a[22:23], v19 offset:46208
    v_mfma_f32_16x16x32_bf16 v[40:43], a[0:3], a[52:55], v[40:43]
    s_add_u32 m0, s38, 14336
    v_mfma_f32_16x16x32_bf16 v[44:47], a[0:3], a[56:59], v[44:47]
    buffer_load_dwordx4 v10, s[4:7], s35 offen lds
    s_waitcnt lgkmcnt(8)
    v_mfma_f32_16x16x32_bf16 v[60:63], a[4:7], a[56:59], v[60:63]
    ds_read_b64_tr_b16 a[24:25], v20 offset:49152
    v_mfma_f32_16x16x32_bf16 v[56:59], a[4:7], a[52:55], v[56:59]
    ds_read_b64_tr_b16 a[26:27], v20 offset:49664
    v_mfma_f32_16x16x32_bf16 v[52:55], a[4:7], a[48:51], v[52:55]
    s_add_u32 m0, s38, 15360
    v_mfma_f32_16x16x32_bf16 v[48:51], a[4:7], a[44:47], v[48:51]
    buffer_load_dwordx4 v11, s[4:7], s35 offen lds
    s_waitcnt lgkmcnt(6)
    v_mfma_f32_16x16x32_bf16 v[64:67], a[8:11], a[44:47], v[64:67]
    ds_read_b64_tr_b16 a[0:1], v18 offset:50176
    v_mfma_f32_16x16x32_bf16 v[68:71], a[8:11], a[48:51], v[68:71]
    ds_read_b64_tr_b16 a[2:3], v18 offset:53248
    v_mfma_f32_16x16x32_bf16 v[72:75], a[8:11], a[52:55], v[72:75]
    s_add_u32 s35, s35, 128
    s_add_u32 m0, s39, 28672
    v_mfma_f32_16x16x32_bf16 v[76:79], a[8:11], a[56:59], v[76:79]
    buffer_load_dwordx4 v12, s[8:11], s36 offen lds
    v_mfma_f32_16x16x32_bf16 v[92:95], a[12:15], a[56:59], v[92:95]
    ds_read_b64_tr_b16 a[4:5], v19 offset:50176
    v_mfma_f32_16x16x32_bf16 v[88:91], a[12:15], a[52:55], v[88:91]
    ds_read_b64_tr_b16 a[6:7], v19 offset:53248
    v_mfma_f32_16x16x32_bf16 v[84:87], a[12:15], a[48:51], v[84:87]
    s_add_u32 m0, s39, 29696
    v_mfma_f32_16x16x32_bf16 v[80:83], a[12:15], a[44:47], v[80:83]
    buffer_load_dwordx4 v13, s[8:11], s36 offen lds
    s_waitcnt lgkmcnt(6)
    v_mfma_f32_16x16x32_bf16 v[96:99], a[16:19], a[44:47], v[96:99]
    ds_read_b64_tr_b16 a[8:9], v18 offset:50240
    v_mfma_f32_16x16x32_bf16 v[100:103], a[16:19], a[48:51], v[100:103]
    ds_read_b64_tr_b16 a[10:11], v18 offset:53312
    v_mfma_f32_16x16x32_bf16 v[104:107], a[16:19], a[52:55], v[104:107]
    s_add_u32 m0, s39, 30720
    v_mfma_f32_16x16x32_bf16 v[108:111], a[16:19], a[56:59], v[108:111]
    buffer_load_dwordx4 v14, s[8:11], s36 offen lds
    v_mfma_f32_16x16x32_bf16 v[124:127], a[20:23], a[56:59], v[124:127]
    ds_read_b64_tr_b16 a[12:13], v19 offset:50240
    v_mfma_f32_16x16x32_bf16 v[120:123], a[20:23], a[52:55], v[120:123]
    ds_read_b64_tr_b16 a[14:15], v19 offset:53312
    v_mfma_f32_16x16x32_bf16 v[116:119], a[20:23], a[48:51], v[116:119]
    s_add_u32 m0, s40, 28672
    v_mfma_f32_16x16x32_bf16 v[112:115], a[20:23], a[44:47], v[112:115]
    buffer_load_dwordx4 v15, s[8:11], s36 offen lds
    s_waitcnt lgkmcnt(6)
    v_mfma_f32_16x16x32_bf16 v[128:131], a[24:27], a[44:47], v[128:131]
    ds_read_b64_tr_b16 a[16:17], v18 offset:50304
    v_mfma_f32_16x16x32_bf16 v[132:135], a[24:27], a[48:51], v[132:135]
    ds_read_b64_tr_b16 a[18:19], v18 offset:53376
    v_mfma_f32_16x16x32_bf16 v[136:139], a[24:27], a[52:55], v[136:139]
    v_mfma_f32_16x16x32_bf16 v[140:143], a[24:27], a[56:59], v[140:143]
    v_mfma_f32_16x16x32_bf16 v[156:159], a[0:3], a[56:59], v[156:159]
    ds_read_b64_tr_b16 a[20:21], v19 offset:50304
    v_mfma_f32_16x16x32_bf16 v[152:155], a[0:3], a[52:55], v[152:155]
    ds_read_b64_tr_b16 a[22:23], v19 offset:53376
    v_mfma_f32_16x16x32_bf16 v[148:151], a[0:3], a[48:51], v[148:151]
    s_add_u32 s36, s36, 229376
    v_mfma_f32_16x16x32_bf16 v[144:147], a[0:3], a[44:47], v[144:147]
    s_waitcnt lgkmcnt(6)
    v_mfma_f32_16x16x32_bf16 v[160:163], a[4:7], a[44:47], v[160:163]
    ds_read_b64_tr_b16 a[24:25], v20 offset:56320
    v_mfma_f32_16x16x32_bf16 v[164:167], a[4:7], a[48:51], v[164:167]
    ds_read_b64_tr_b16 a[26:27], v20 offset:56832
    v_mfma_f32_16x16x32_bf16 v[168:171], a[4:7], a[52:55], v[168:171]
    v_mfma_f32_16x16x32_bf16 v[172:175], a[4:7], a[56:59], v[172:175]
    v_mfma_f32_16x16x32_bf16 v[188:191], a[8:11], a[56:59], v[188:191]
    v_mfma_f32_16x16x32_bf16 v[184:187], a[8:11], a[52:55], v[184:187]
    v_mfma_f32_16x16x32_bf16 v[180:183], a[8:11], a[48:51], v[180:183]
    v_mfma_f32_16x16x32_bf16 v[176:179], a[8:11], a[44:47], v[176:179]
    s_waitcnt vmcnt(17) lgkmcnt(0)
    s_barrier
    ds_read_b128 a[28:31], v16 offset:0
    v_mfma_f32_16x16x32_bf16 v[192:195], a[12:15], a[44:47], v[192:195]
    ds_read_b64_tr_b16 a[0:1], v18 offset:0
    v_mfma_f32_16x16x32_bf16 v[196:199], a[12:15], a[48:51], v[196:199]
    ds_read_b64_tr_b16 a[2:3], v18 offset:3072
    v_mfma_f32_16x16x32_bf16 v[200:203], a[12:15], a[52:55], v[200:203]
    ds_read_b128 a[32:35], v16 offset:2048
    v_mfma_f32_16x16x32_bf16 v[204:207], a[12:15], a[56:59], v[204:207]
    ds_read_b128 a[36:39], v16 offset:4096
    v_accvgpr_read_b32 v242, a102
    v_mfma_f32_16x16x32_bf16 v[220:223], a[16:19], a[56:59], v[220:223]
    ds_read_b128 a[40:43], v16 offset:6144
    v_lshlrev_b32 v232, 16, v242
    v_mfma_f32_16x16x32_bf16 v[216:219], a[16:19], a[52:55], v[216:219]
    ds_read_b64_tr_b16 a[4:5], v19 offset:0
    v_and_b32 v234, 0xffff0000, v242
    v_mfma_f32_16x16x32_bf16 v[212:215], a[16:19], a[48:51], v[212:215]
    ds_read_b64_tr_b16 a[6:7], v19 offset:3072
    v_accvgpr_read_b32 v242, a104
    v_mfma_f32_16x16x32_bf16 v[208:211], a[16:19], a[44:47], v[208:211]
    ds_read_b64_tr_b16 a[8:9], v18 offset:64
    v_mfma_f32_16x16x32_bf16 a[160:163], a[20:23], a[44:47], a[160:163]
    ds_read_b64_tr_b16 a[10:11], v18 offset:3136
    v_lshlrev_b32 v233, 16, v242
    v_mfma_f32_16x16x32_bf16 a[164:167], a[20:23], a[48:51], a[164:167]
    ds_read_b64_tr_b16 a[12:13], v19 offset:64
    v_and_b32 v235, 0xffff0000, v242
    v_mfma_f32_16x16x32_bf16 a[168:171], a[20:23], a[52:55], a[168:171]
    ds_read_b64_tr_b16 a[14:15], v19 offset:3136
    s_add_u32 m0, s39, 43008
    v_mfma_f32_16x16x32_bf16 a[172:175], a[20:23], a[56:59], a[172:175]
    buffer_load_dwordx4 v12, s[8:11], s36 offen lds
    v_mfma_f32_16x16x32_bf16 a[188:191], a[24:27], a[56:59], a[188:191]
    ds_read_b64_tr_b16 a[16:17], v18 offset:128
    v_accvgpr_read_b32 v242, a103
    v_mfma_f32_16x16x32_bf16 a[184:187], a[24:27], a[52:55], a[184:187]
    ds_read_b64_tr_b16 a[18:19], v18 offset:3200
    v_lshlrev_b32 v236, 16, v242
    v_mfma_f32_16x16x32_bf16 a[180:183], a[24:27], a[48:51], a[180:183]
    s_add_u32 m0, s39, 44032
    v_and_b32 v238, 0xffff0000, v242
    v_mfma_f32_16x16x32_bf16 a[176:179], a[24:27], a[44:47], a[176:179]
    buffer_load_dwordx4 v13, s[8:11], s36 offen lds
    s_waitcnt lgkmcnt(11)
    v_mfma_f32_16x16x32_bf16 v[32:35], a[0:3], a[28:31], v[32:35]
    ds_read_b64_tr_b16 a[20:21], v19 offset:128
    v_accvgpr_read_b32 v242, a105
    s_waitcnt lgkmcnt(11)
    v_mfma_f32_16x16x32_bf16 v[36:39], a[0:3], a[32:35], v[36:39]
    ds_read_b64_tr_b16 a[22:23], v19 offset:3200
    v_lshlrev_b32 v237, 16, v242
    s_waitcnt lgkmcnt(11)
    v_mfma_f32_16x16x32_bf16 v[40:43], a[0:3], a[36:39], v[40:43]
    ds_read_b128 a[44:47], v17 offset:0
    s_add_u32 m0, s39, 45056
    s_waitcnt lgkmcnt(11)
    v_mfma_f32_16x16x32_bf16 v[44:47], a[0:3], a[40:43], v[44:47]
    buffer_load_dwordx4 v14, s[8:11], s36 offen lds
    s_waitcnt lgkmcnt(9)
    v_mfma_f32_16x16x32_bf16 v[60:63], a[4:7], a[40:43], v[60:63]
    ds_read_b64_tr_b16 a[24:25], v20 offset:6144
    v_and_b32 v239, 0xffff0000, v242
    v_mfma_f32_16x16x32_bf16 v[56:59], a[4:7], a[36:39], v[56:59]
    ds_read_b64_tr_b16 a[26:27], v20 offset:6656
    v_accvgpr_read_b32 v242, a64
    v_mfma_f32_16x16x32_bf16 v[52:55], a[4:7], a[32:35], v[52:55]
    ds_read_b128 a[48:51], v17 offset:2048
    s_add_u32 m0, s40, 43008
    v_mfma_f32_16x16x32_bf16 v[48:51], a[4:7], a[28:31], v[48:51]
    buffer_load_dwordx4 v15, s[8:11], s36 offen lds
    s_waitcnt lgkmcnt(8)
    v_mfma_f32_16x16x32_bf16 v[64:67], a[8:11], a[28:31], v[64:67]
    ds_read_b64_tr_b16 a[0:1], v18 offset:7168
    v_lshlrev_b32 v224, 16, v242
    v_mfma_f32_16x16x32_bf16 v[68:71], a[8:11], a[32:35], v[68:71]
    ds_read_b64_tr_b16 a[2:3], v18 offset:10240
    buffer_load_dword v22, v21, s[64:67], s41 offen
    buffer_load_dwordx4 a[110:113], v26, s[4:7], s55 offen offset:0
    buffer_load_dwordx4 a[114:117], v26, s[4:7], s55 offen offset:1024
    buffer_load_dwordx4 a[118:121], v26, s[4:7], s55 offen offset:2048
    buffer_load_dwordx4 a[122:125], v26, s[4:7], s55 offen offset:3072
    buffer_load_dwordx4 a[126:129], v26, s[28:31], 0 offen
    buffer_load_dwordx4 a[130:133], v26, s[28:31], 0 offen offset:1024
    v_mfma_f32_16x16x32_bf16 v[72:75], a[8:11], a[36:39], v[72:75]
    ds_read_b128 a[52:55], v17 offset:4096
    s_add_u32 s36, s36, 229376
    s_add_u32 s41, s41, s42
    v_mfma_f32_16x16x32_bf16 v[76:79], a[8:11], a[40:43], v[76:79]
    v_and_b32 v225, 0xffff0000, v242
    v_accvgpr_read_b32 v242, a66
    v_mfma_f32_16x16x32_bf16 v[92:95], a[12:15], a[40:43], v[92:95]
    ds_read_b64_tr_b16 a[4:5], v19 offset:7168
    v_lshlrev_b32 v226, 16, v242
    v_mfma_f32_16x16x32_bf16 v[88:91], a[12:15], a[36:39], v[88:91]
    ds_read_b64_tr_b16 a[6:7], v19 offset:10240
    v_and_b32 v227, 0xffff0000, v242
    v_mfma_f32_16x16x32_bf16 v[84:87], a[12:15], a[32:35], v[84:87]
    ds_read_b128 a[56:59], v17 offset:6144
    v_accvgpr_read_b32 v242, a68
    v_mfma_f32_16x16x32_bf16 v[80:83], a[12:15], a[28:31], v[80:83]
    v_lshlrev_b32 v228, 16, v242
    s_waitcnt lgkmcnt(10)
    v_mfma_f32_16x16x32_bf16 v[96:99], a[16:19], a[28:31], v[96:99]
    ds_read_b64_tr_b16 a[8:9], v18 offset:7232
    v_and_b32 v229, 0xffff0000, v242
    v_mfma_f32_16x16x32_bf16 v[100:103], a[16:19], a[32:35], v[100:103]
    ds_read_b64_tr_b16 a[10:11], v18 offset:10304
    v_accvgpr_read_b32 v242, a70
    v_mfma_f32_16x16x32_bf16 v[104:107], a[16:19], a[36:39], v[104:107]
    v_lshlrev_b32 v230, 16, v242
    v_and_b32 v231, 0xffff0000, v242
    v_mfma_f32_16x16x32_bf16 v[108:111], a[16:19], a[40:43], v[108:111]
    v_accvgpr_read_b32 v242, a86
    v_lshlrev_b32 v240, 16, v242
    v_mfma_f32_16x16x32_bf16 v[124:127], a[20:23], a[40:43], v[124:127]
    ds_read_b64_tr_b16 a[12:13], v19 offset:7232
    v_and_b32 v241, 0xffff0000, v242
    v_mfma_f32_16x16x32_bf16 v[120:123], a[20:23], a[36:39], v[120:123]
    ds_read_b64_tr_b16 a[14:15], v19 offset:10304
    s_waitcnt lgkmcnt(4)
    v_mfma_f32_16x16x32_bf16 v[116:119], a[20:23], a[32:35], v[116:119]
    s_add_u32 m0, s38, 0
    v_mul_f32 v244, v224, v238
    v_mfma_f32_16x16x32_bf16 v[112:115], a[20:23], a[28:31], v[112:115]
    buffer_load_dwordx4 v4, s[4:7], s35 offen lds
    v_mfma_f32_16x16x32_bf16 v[128:131], a[24:27], a[28:31], v[128:131]
    ds_read_b64_tr_b16 a[16:17], v18 offset:7296
    v_mul_f32 v245, v225, v239
    v_mfma_f32_16x16x32_bf16 v[132:135], a[24:27], a[32:35], v[132:135]
    ds_read_b64_tr_b16 a[18:19], v18 offset:10368
    v_fmac_f32 v244, v226, v236
    v_mfma_f32_16x16x32_bf16 v[136:139], a[24:27], a[36:39], v[136:139]
    s_add_u32 m0, s38, 1024
    v_fmac_f32 v245, v227, v237
    v_mfma_f32_16x16x32_bf16 v[140:143], a[24:27], a[40:43], v[140:143]
    buffer_load_dwordx4 v5, s[4:7], s35 offen lds
    v_mfma_f32_16x16x32_bf16 v[156:159], a[0:3], a[40:43], v[156:159]
    ds_read_b64_tr_b16 a[20:21], v19 offset:7296
    v_fmac_f32 v244, v228, v234
    v_mfma_f32_16x16x32_bf16 v[152:155], a[0:3], a[36:39], v[152:155]
    ds_read_b64_tr_b16 a[22:23], v19 offset:10368
    v_fmac_f32 v245, v229, v235
    v_mfma_f32_16x16x32_bf16 v[148:151], a[0:3], a[32:35], v[148:151]
    s_add_u32 m0, s38, 2048
    v_fmac_f32 v244, v230, v232
    v_mfma_f32_16x16x32_bf16 v[144:147], a[0:3], a[28:31], v[144:147]
    buffer_load_dwordx4 v6, s[4:7], s35 offen lds
    s_waitcnt lgkmcnt(6)
    v_mfma_f32_16x16x32_bf16 v[160:163], a[4:7], a[28:31], v[160:163]
    ds_read_b64_tr_b16 a[24:25], v20 offset:13312
    v_fmac_f32 v245, v231, v233
    v_mfma_f32_16x16x32_bf16 v[164:167], a[4:7], a[32:35], v[164:167]
    ds_read_b64_tr_b16 a[26:27], v20 offset:13824
    v_mul_f32 v244, v244, v240
    v_mfma_f32_16x16x32_bf16 v[168:171], a[4:7], a[36:39], v[168:171]
    s_add_u32 m0, s38, 3072
    v_mul_f32 v245, v245, v241
    v_mfma_f32_16x16x32_bf16 v[172:175], a[4:7], a[40:43], v[172:175]
    buffer_load_dwordx4 v7, s[4:7], s35 offen lds
    v_mfma_f32_16x16x32_bf16 v[188:191], a[8:11], a[40:43], v[188:191]
    v_accvgpr_read_b32 v242, a72
    v_lshlrev_b32 v224, 16, v242
    v_mfma_f32_16x16x32_bf16 v[184:187], a[8:11], a[36:39], v[184:187]
    v_and_b32 v225, 0xffff0000, v242
    v_accvgpr_read_b32 v242, a88
    v_mfma_f32_16x16x32_bf16 v[180:183], a[8:11], a[32:35], v[180:183]
    v_lshlrev_b32 v240, 16, v242
    v_and_b32 v241, 0xffff0000, v242
    v_mfma_f32_16x16x32_bf16 v[176:179], a[8:11], a[28:31], v[176:179]
    s_waitcnt vmcnt(28) lgkmcnt(0)
    s_barrier
    v_mfma_f32_16x16x32_bf16 v[192:195], a[12:15], a[28:31], v[192:195]
    ds_read_b64_tr_b16 a[0:1], v18 offset:14336
    v_mul_f32 v246, v226, v238
    v_mfma_f32_16x16x32_bf16 v[196:199], a[12:15], a[32:35], v[196:199]
    ds_read_b64_tr_b16 a[2:3], v18 offset:17408
    v_mul_f32 v247, v227, v239
    v_mfma_f32_16x16x32_bf16 v[200:203], a[12:15], a[36:39], v[200:203]
    v_fmac_f32 v246, v228, v236
    v_fmac_f32 v247, v229, v237
    v_mfma_f32_16x16x32_bf16 v[204:207], a[12:15], a[40:43], v[204:207]
    v_fmac_f32 v246, v230, v234
    v_fmac_f32 v247, v231, v235
    v_mfma_f32_16x16x32_bf16 v[220:223], a[16:19], a[40:43], v[220:223]
    ds_read_b64_tr_b16 a[4:5], v19 offset:14336
    v_fmac_f32 v246, v224, v232
    v_mfma_f32_16x16x32_bf16 v[216:219], a[16:19], a[36:39], v[216:219]
    ds_read_b64_tr_b16 a[6:7], v19 offset:17408
    v_fmac_f32 v247, v225, v233
    v_mfma_f32_16x16x32_bf16 v[212:215], a[16:19], a[32:35], v[212:215]
    ds_read_b64_tr_b16 a[8:9], v18 offset:14400
    v_mul_f32 v246, v246, v240
    v_mfma_f32_16x16x32_bf16 v[208:211], a[16:19], a[28:31], v[208:211]
    ds_read_b64_tr_b16 a[10:11], v18 offset:17472
    v_mfma_f32_16x16x32_bf16 a[160:163], a[20:23], a[28:31], a[160:163]
    ds_read_b64_tr_b16 a[12:13], v19 offset:14400
    v_mul_f32 v247, v247, v241
    v_mfma_f32_16x16x32_bf16 a[164:167], a[20:23], a[32:35], a[164:167]
    ds_read_b64_tr_b16 a[14:15], v19 offset:17472
    v_cvt_pk_bf16_f32 v251, v246, v244
    v_mfma_f32_16x16x32_bf16 a[168:171], a[20:23], a[36:39], a[168:171]
    s_add_u32 m0, s38, 4096
    v_cvt_pk_bf16_f32 v255, v247, v245
    v_mfma_f32_16x16x32_bf16 a[172:175], a[20:23], a[40:43], a[172:175]
    buffer_load_dwordx4 v8, s[4:7], s35 offen lds
    v_mfma_f32_16x16x32_bf16 a[188:191], a[24:27], a[40:43], a[188:191]
    ds_read_b64_tr_b16 a[16:17], v18 offset:14464
    v_accvgpr_read_b32 v242, a74
    v_mfma_f32_16x16x32_bf16 a[184:187], a[24:27], a[36:39], a[184:187]
    ds_read_b64_tr_b16 a[18:19], v18 offset:17536
    v_lshlrev_b32 v226, 16, v242
    v_mfma_f32_16x16x32_bf16 a[180:183], a[24:27], a[32:35], a[180:183]
    s_add_u32 m0, s38, 5120
    v_and_b32 v227, 0xffff0000, v242
    v_mfma_f32_16x16x32_bf16 a[176:179], a[24:27], a[28:31], a[176:179]
    buffer_load_dwordx4 v9, s[4:7], s35 offen lds
    s_waitcnt lgkmcnt(8)
    v_mfma_f32_16x16x32_bf16 v[32:35], a[0:3], a[44:47], v[32:35]
    ds_read_b64_tr_b16 a[20:21], v19 offset:14464
    v_accvgpr_read_b32 v242, a90
    v_mfma_f32_16x16x32_bf16 v[36:39], a[0:3], a[48:51], v[36:39]
    ds_read_b64_tr_b16 a[22:23], v19 offset:17536
    v_lshlrev_b32 v240, 16, v242
    v_mfma_f32_16x16x32_bf16 v[40:43], a[0:3], a[52:55], v[40:43]
    s_add_u32 m0, s38, 6144
    v_and_b32 v241, 0xffff0000, v242
    v_mfma_f32_16x16x32_bf16 v[44:47], a[0:3], a[56:59], v[44:47]
    buffer_load_dwordx4 v10, s[4:7], s35 offen lds
    s_waitcnt lgkmcnt(8)
    v_mfma_f32_16x16x32_bf16 v[60:63], a[4:7], a[56:59], v[60:63]
    ds_read_b64_tr_b16 a[24:25], v20 offset:20480
    v_mul_f32 v244, v228, v238
    v_mfma_f32_16x16x32_bf16 v[56:59], a[4:7], a[52:55], v[56:59]
    ds_read_b64_tr_b16 a[26:27], v20 offset:20992
    v_mul_f32 v245, v229, v239
    v_mfma_f32_16x16x32_bf16 v[52:55], a[4:7], a[48:51], v[52:55]
    s_add_u32 m0, s38, 7168
    v_fmac_f32 v244, v230, v236
    v_mfma_f32_16x16x32_bf16 v[48:51], a[4:7], a[44:47], v[48:51]
    buffer_load_dwordx4 v11, s[4:7], s35 offen lds
    s_waitcnt lgkmcnt(6)
    v_mfma_f32_16x16x32_bf16 v[64:67], a[8:11], a[44:47], v[64:67]
    ds_read_b64_tr_b16 a[0:1], v18 offset:21504
    v_fmac_f32 v245, v231, v237
    v_mfma_f32_16x16x32_bf16 v[68:71], a[8:11], a[48:51], v[68:71]
    ds_read_b64_tr_b16 a[2:3], v18 offset:24576
    v_fmac_f32 v244, v224, v234
    v_mfma_f32_16x16x32_bf16 v[72:75], a[8:11], a[52:55], v[72:75]
    s_add_u32 s35, s35, 128
    s_add_u32 m0, s39, 0
    v_mfma_f32_16x16x32_bf16 v[76:79], a[8:11], a[56:59], v[76:79]
    buffer_load_dwordx4 v12, s[8:11], s36 offen lds
    v_mfma_f32_16x16x32_bf16 v[92:95], a[12:15], a[56:59], v[92:95]
    ds_read_b64_tr_b16 a[4:5], v19 offset:21504
    v_fmac_f32 v245, v225, v235
    v_mfma_f32_16x16x32_bf16 v[88:91], a[12:15], a[52:55], v[88:91]
    ds_read_b64_tr_b16 a[6:7], v19 offset:24576
    v_fmac_f32 v244, v226, v232
    v_mfma_f32_16x16x32_bf16 v[84:87], a[12:15], a[48:51], v[84:87]
    s_add_u32 m0, s39, 1024
    v_fmac_f32 v245, v227, v233
    v_mfma_f32_16x16x32_bf16 v[80:83], a[12:15], a[44:47], v[80:83]
    buffer_load_dwordx4 v13, s[8:11], s36 offen lds
    s_waitcnt lgkmcnt(6)
    v_mfma_f32_16x16x32_bf16 v[96:99], a[16:19], a[44:47], v[96:99]
    ds_read_b64_tr_b16 a[8:9], v18 offset:21568
    v_mul_f32 v244, v244, v240
    v_mfma_f32_16x16x32_bf16 v[100:103], a[16:19], a[48:51], v[100:103]
    ds_read_b64_tr_b16 a[10:11], v18 offset:24640
    v_mul_f32 v245, v245, v241
    v_mfma_f32_16x16x32_bf16 v[104:107], a[16:19], a[52:55], v[104:107]
    s_add_u32 m0, s39, 2048
    v_accvgpr_read_b32 v242, a76
    v_mfma_f32_16x16x32_bf16 v[108:111], a[16:19], a[56:59], v[108:111]
    buffer_load_dwordx4 v14, s[8:11], s36 offen lds
    v_mfma_f32_16x16x32_bf16 v[124:127], a[20:23], a[56:59], v[124:127]
    ds_read_b64_tr_b16 a[12:13], v19 offset:21568
    s_lshl_b32 s31, s2, 2
    v_mfma_f32_16x16x32_bf16 v[120:123], a[20:23], a[52:55], v[120:123]
    ds_read_b64_tr_b16 a[14:15], v19 offset:24640
    s_add_u32 s31, s31, s32
    v_mfma_f32_16x16x32_bf16 v[116:119], a[20:23], a[48:51], v[116:119]
    s_add_u32 m0, s40, 0
    s_mul_i32 s29, s58, 8257536
    v_mfma_f32_16x16x32_bf16 v[112:115], a[20:23], a[44:47], v[112:115]
    buffer_load_dwordx4 v15, s[8:11], s36 offen lds
    s_waitcnt lgkmcnt(6)
    v_mfma_f32_16x16x32_bf16 v[128:131], a[24:27], a[44:47], v[128:131]
    ds_read_b64_tr_b16 a[16:17], v18 offset:21632
    s_lshl_b32 s24, s56, 10
    v_mfma_f32_16x16x32_bf16 v[132:135], a[24:27], a[48:51], v[132:135]
    ds_read_b64_tr_b16 a[18:19], v18 offset:24704
    s_add_u32 s24, s24, s29
    v_mfma_f32_16x16x32_bf16 v[136:139], a[24:27], a[52:55], v[136:139]
    s_lshr_b32 s96, s32, 1
    s_and_b32 s97, s32, 1
    v_mfma_f32_16x16x32_bf16 v[140:143], a[24:27], a[56:59], v[140:143]
    s_sub_u32 s97, s97, s96
    s_lshl_b32 s26, s97, 14
    v_mfma_f32_16x16x32_bf16 v[156:159], a[0:3], a[56:59], v[156:159]
    ds_read_b64_tr_b16 a[20:21], v19 offset:21632
    s_lshr_b32 s30, s29, 1
    v_mfma_f32_16x16x32_bf16 v[152:155], a[0:3], a[52:55], v[152:155]
    ds_read_b64_tr_b16 a[22:23], v19 offset:24704
    s_lshl_b32 s25, s32, 14
    v_mfma_f32_16x16x32_bf16 v[148:151], a[0:3], a[48:51], v[148:151]
    s_add_u32 s36, s36, 229376
    s_add_u32 s25, s25, s30
    v_mfma_f32_16x16x32_bf16 v[144:147], a[0:3], a[44:47], v[144:147]
    s_lshl_b32 s27, s32, 11
    s_waitcnt lgkmcnt(6)
    v_mfma_f32_16x16x32_bf16 v[160:163], a[4:7], a[44:47], v[160:163]
    ds_read_b64_tr_b16 a[24:25], v20 offset:27648
    s_lshl_b32 s48, s56, 15
    v_mfma_f32_16x16x32_bf16 v[164:167], a[4:7], a[48:51], v[164:167]
    ds_read_b64_tr_b16 a[26:27], v20 offset:28160
    s_lshl_b32 s96, s57, 7
    v_mfma_f32_16x16x32_bf16 v[168:171], a[4:7], a[52:55], v[168:171]
    s_add_u32 s48, s48, s96
    s_add_u32 s49, s48, 0x8000
    v_mfma_f32_16x16x32_bf16 v[172:175], a[4:7], a[56:59], v[172:175]
    s_lshl_b32 s50, s57, 18
    s_lshl_b32 s96, s56, 5
    v_mfma_f32_16x16x32_bf16 v[188:191], a[8:11], a[56:59], v[188:191]
    s_add_u32 s50, s50, s96
    s_add_u32 s50, s50, 0x1400000
    v_mfma_f32_16x16x32_bf16 v[184:187], a[8:11], a[52:55], v[184:187]
    s_lshr_b32 s96, s56, 1
    s_lshl_b32 s96, s96, 4
    v_mfma_f32_16x16x32_bf16 v[180:183], a[8:11], a[48:51], v[180:183]
    s_add_u32 s96, s96, s57
    s_lshl_b32 s96, s96, 12
    v_mfma_f32_16x16x32_bf16 v[176:179], a[8:11], a[44:47], v[176:179]
    s_waitcnt vmcnt(23) lgkmcnt(0)
    s_barrier
    ds_read_b128 a[28:31], v16 offset:8192
    v_mfma_f32_16x16x32_bf16 v[192:195], a[12:15], a[44:47], v[192:195]
    ds_read_b64_tr_b16 a[0:1], v18 offset:28672
    s_add_u32 s52, s96, 0x1a00000
    v_mfma_f32_16x16x32_bf16 v[196:199], a[12:15], a[48:51], v[196:199]
    ds_read_b64_tr_b16 a[2:3], v18 offset:31744
    s_xor_b32 s51, s52, 0x1000
    v_mfma_f32_16x16x32_bf16 v[200:203], a[12:15], a[52:55], v[200:203]
    ds_read_b128 a[32:35], v16 offset:10240
    s_lshr_b32 s54, s31, 4
    v_mfma_f32_16x16x32_bf16 v[204:207], a[12:15], a[56:59], v[204:207]
    ds_read_b128 a[36:39], v16 offset:12288
    s_lshl_b32 s54, s54, 11
    v_mfma_f32_16x16x32_bf16 v[220:223], a[16:19], a[56:59], v[220:223]
    ds_read_b128 a[40:43], v16 offset:14336
    s_add_u32 s54, s54, 0x1840000
    v_mfma_f32_16x16x32_bf16 v[216:219], a[16:19], a[52:55], v[216:219]
    ds_read_b64_tr_b16 a[4:5], v19 offset:28672
    s_lshl_b32 s53, s2, 7
    v_mfma_f32_16x16x32_bf16 v[212:215], a[16:19], a[48:51], v[212:215]
    ds_read_b64_tr_b16 a[6:7], v19 offset:31744
    s_add_u32 s53, s53, 0x1860000
    v_mfma_f32_16x16x32_bf16 v[208:211], a[16:19], a[44:47], v[208:211]
    ds_read_b64_tr_b16 a[8:9], v18 offset:28736
    v_mfma_f32_16x16x32_bf16 a[160:163], a[20:23], a[44:47], a[160:163]
    ds_read_b64_tr_b16 a[10:11], v18 offset:31808
    s_cmp_eq_u32 s32, 0
    s_cselect_b32 s53, s53, 0x7f000000
    v_mfma_f32_16x16x32_bf16 a[164:167], a[20:23], a[48:51], a[164:167]
    ds_read_b64_tr_b16 a[12:13], v19 offset:28736
    s_lshr_b32 s55, s56, 2
    v_mfma_f32_16x16x32_bf16 a[168:171], a[20:23], a[52:55], a[168:171]
    ds_read_b64_tr_b16 a[14:15], v19 offset:31808
    s_add_u32 m0, s39, 14336
    v_mfma_f32_16x16x32_bf16 a[172:175], a[20:23], a[56:59], a[172:175]
    buffer_load_dwordx4 v12, s[8:11], s36 offen lds
    v_mfma_f32_16x16x32_bf16 a[188:191], a[24:27], a[56:59], a[188:191]
    ds_read_b64_tr_b16 a[16:17], v18 offset:28800
    s_lshl_b32 s55, s55, 12
    v_mfma_f32_16x16x32_bf16 a[184:187], a[24:27], a[52:55], a[184:187]
    ds_read_b64_tr_b16 a[18:19], v18 offset:31872
    s_add_u32 s55, s55, 0x1820000
    v_mfma_f32_16x16x32_bf16 a[180:183], a[24:27], a[48:51], a[180:183]
    s_add_u32 m0, s39, 15360
    s_mov_b32 s16, s76
    v_mfma_f32_16x16x32_bf16 a[176:179], a[24:27], a[44:47], a[176:179]
    buffer_load_dwordx4 v13, s[8:11], s36 offen lds
    s_waitcnt lgkmcnt(11)
    v_mfma_f32_16x16x32_bf16 v[32:35], a[0:3], a[28:31], v[32:35]
    ds_read_b64_tr_b16 a[20:21], v19 offset:28800
    s_mov_b32 s17, s77
    s_waitcnt lgkmcnt(11)
    v_mfma_f32_16x16x32_bf16 v[36:39], a[0:3], a[32:35], v[36:39]
    ds_read_b64_tr_b16 a[22:23], v19 offset:31872
    s_mov_b32 s20, s62
    s_waitcnt lgkmcnt(11)
    v_mfma_f32_16x16x32_bf16 v[40:43], a[0:3], a[36:39], v[40:43]
    ds_read_b128 a[44:47], v17 offset:8192
    s_add_u32 m0, s39, 16384
    s_waitcnt lgkmcnt(11)
    v_mfma_f32_16x16x32_bf16 v[44:47], a[0:3], a[40:43], v[44:47]
    buffer_load_dwordx4 v14, s[8:11], s36 offen lds
    s_waitcnt lgkmcnt(9)
    v_mfma_f32_16x16x32_bf16 v[60:63], a[4:7], a[40:43], v[60:63]
    ds_read_b64_tr_b16 a[24:25], v20 offset:34816
    s_mov_b32 s21, s63
    v_mfma_f32_16x16x32_bf16 v[56:59], a[4:7], a[36:39], v[56:59]
    ds_read_b64_tr_b16 a[26:27], v20 offset:35328
    s_movk_i32 s22, 2048
    v_mfma_f32_16x16x32_bf16 v[52:55], a[4:7], a[32:35], v[52:55]
    ds_read_b128 a[48:51], v17 offset:10240
    s_add_u32 m0, s40, 14336
    v_mfma_f32_16x16x32_bf16 v[48:51], a[4:7], a[28:31], v[48:51]
    buffer_load_dwordx4 v15, s[8:11], s36 offen lds
    s_waitcnt lgkmcnt(8)
    v_mfma_f32_16x16x32_bf16 v[64:67], a[8:11], a[28:31], v[64:67]
    ds_read_b64_tr_b16 a[0:1], v18 offset:35840
    v_lshlrev_b32 v228, 16, v242
    v_mfma_f32_16x16x32_bf16 v[68:71], a[8:11], a[32:35], v[68:71]
    ds_read_b64_tr_b16 a[2:3], v18 offset:38912
    buffer_load_dword v22, v3, s[4:7], s92 offen
    v_mfma_f32_16x16x32_bf16 v[72:75], a[8:11], a[36:39], v[72:75]
    ds_read_b128 a[52:55], v17 offset:12288
    s_add_u32 s36, s36, 229376
    s_add_u32 s92, s92, 256
    v_mfma_f32_16x16x32_bf16 v[76:79], a[8:11], a[40:43], v[76:79]
    v_and_b32 v229, 0xffff0000, v242
    v_accvgpr_read_b32 v242, a92
    v_mfma_f32_16x16x32_bf16 v[92:95], a[12:15], a[40:43], v[92:95]
    ds_read_b64_tr_b16 a[4:5], v19 offset:35840
    v_lshlrev_b32 v240, 16, v242
    v_mfma_f32_16x16x32_bf16 v[88:91], a[12:15], a[36:39], v[88:91]
    ds_read_b64_tr_b16 a[6:7], v19 offset:38912
    v_and_b32 v241, 0xffff0000, v242
    v_mfma_f32_16x16x32_bf16 v[84:87], a[12:15], a[32:35], v[84:87]
    ds_read_b128 a[56:59], v17 offset:14336
    v_mul_f32 v246, v230, v238
    v_mfma_f32_16x16x32_bf16 v[80:83], a[12:15], a[28:31], v[80:83]
    v_mul_f32 v247, v231, v239
    s_waitcnt lgkmcnt(10)
    v_mfma_f32_16x16x32_bf16 v[96:99], a[16:19], a[28:31], v[96:99]
    ds_read_b64_tr_b16 a[8:9], v18 offset:35904
    v_fmac_f32 v246, v224, v236
    v_mfma_f32_16x16x32_bf16 v[100:103], a[16:19], a[32:35], v[100:103]
    ds_read_b64_tr_b16 a[10:11], v18 offset:38976
    v_fmac_f32 v247, v225, v237
    v_mfma_f32_16x16x32_bf16 v[104:107], a[16:19], a[36:39], v[104:107]
    v_fmac_f32 v246, v226, v234
    v_fmac_f32 v247, v227, v235
    v_mfma_f32_16x16x32_bf16 v[108:111], a[16:19], a[40:43], v[108:111]
    v_fmac_f32 v246, v228, v232
    v_fmac_f32 v247, v229, v233
    v_mfma_f32_16x16x32_bf16 v[124:127], a[20:23], a[40:43], v[124:127]
    ds_read_b64_tr_b16 a[12:13], v19 offset:35904
    v_mul_f32 v246, v246, v240
    v_mfma_f32_16x16x32_bf16 v[120:123], a[20:23], a[36:39], v[120:123]
    ds_read_b64_tr_b16 a[14:15], v19 offset:38976
    s_waitcnt lgkmcnt(4)
    v_mfma_f32_16x16x32_bf16 v[116:119], a[20:23], a[32:35], v[116:119]
    s_add_u32 m0, s38, 8192
    v_mul_f32 v247, v247, v241
    v_mfma_f32_16x16x32_bf16 v[112:115], a[20:23], a[28:31], v[112:115]
    buffer_load_dwordx4 v4, s[4:7], s35 offen lds
    v_mfma_f32_16x16x32_bf16 v[128:131], a[24:27], a[28:31], v[128:131]
    ds_read_b64_tr_b16 a[16:17], v18 offset:35968
    v_cvt_pk_bf16_f32 v250, v246, v244
    v_mfma_f32_16x16x32_bf16 v[132:135], a[24:27], a[32:35], v[132:135]
    ds_read_b64_tr_b16 a[18:19], v18 offset:39040
    v_cvt_pk_bf16_f32 v254, v247, v245
    v_mfma_f32_16x16x32_bf16 v[136:139], a[24:27], a[36:39], v[136:139]
    s_add_u32 m0, s38, 9216
    v_accvgpr_read_b32 v242, a78
    v_mfma_f32_16x16x32_bf16 v[140:143], a[24:27], a[40:43], v[140:143]
    buffer_load_dwordx4 v5, s[4:7], s35 offen lds
    v_mfma_f32_16x16x32_bf16 v[156:159], a[0:3], a[40:43], v[156:159]
    ds_read_b64_tr_b16 a[20:21], v19 offset:35968
    v_lshlrev_b32 v230, 16, v242
    v_mfma_f32_16x16x32_bf16 v[152:155], a[0:3], a[36:39], v[152:155]
    ds_read_b64_tr_b16 a[22:23], v19 offset:39040
    v_and_b32 v231, 0xffff0000, v242
    v_mfma_f32_16x16x32_bf16 v[148:151], a[0:3], a[32:35], v[148:151]
    s_add_u32 m0, s38, 10240
    v_accvgpr_read_b32 v242, a94
    v_mfma_f32_16x16x32_bf16 v[144:147], a[0:3], a[28:31], v[144:147]
    buffer_load_dwordx4 v6, s[4:7], s35 offen lds
    s_waitcnt lgkmcnt(6)
    v_mfma_f32_16x16x32_bf16 v[160:163], a[4:7], a[28:31], v[160:163]
    ds_read_b64_tr_b16 a[24:25], v20 offset:41984
    v_lshlrev_b32 v240, 16, v242
    v_mfma_f32_16x16x32_bf16 v[164:167], a[4:7], a[32:35], v[164:167]
    ds_read_b64_tr_b16 a[26:27], v20 offset:42496
    v_and_b32 v241, 0xffff0000, v242
    v_mfma_f32_16x16x32_bf16 v[168:171], a[4:7], a[36:39], v[168:171]
    s_add_u32 m0, s38, 11264
    v_mul_f32 v244, v224, v238
    v_mfma_f32_16x16x32_bf16 v[172:175], a[4:7], a[40:43], v[172:175]
    buffer_load_dwordx4 v7, s[4:7], s35 offen lds
    v_mfma_f32_16x16x32_bf16 v[188:191], a[8:11], a[40:43], v[188:191]
    v_mul_f32 v245, v225, v239
    v_fmac_f32 v244, v226, v236
    v_mfma_f32_16x16x32_bf16 v[184:187], a[8:11], a[36:39], v[184:187]
    v_fmac_f32 v245, v227, v237
    v_fmac_f32 v244, v228, v234
    v_mfma_f32_16x16x32_bf16 v[180:183], a[8:11], a[32:35], v[180:183]
    v_fmac_f32 v245, v229, v235
    v_fmac_f32 v244, v230, v232
    v_mfma_f32_16x16x32_bf16 v[176:179], a[8:11], a[28:31], v[176:179]
    s_waitcnt vmcnt(28) lgkmcnt(0)
    s_barrier
    v_mfma_f32_16x16x32_bf16 v[192:195], a[12:15], a[28:31], v[192:195]
    ds_read_b64_tr_b16 a[0:1], v18 offset:43008
    v_fmac_f32 v245, v231, v233
    v_mfma_f32_16x16x32_bf16 v[196:199], a[12:15], a[32:35], v[196:199]
    ds_read_b64_tr_b16 a[2:3], v18 offset:46080
    v_mul_f32 v244, v244, v240
    v_mfma_f32_16x16x32_bf16 v[200:203], a[12:15], a[36:39], v[200:203]
    v_mul_f32 v245, v245, v241
    v_accvgpr_read_b32 v242, a80
    v_mfma_f32_16x16x32_bf16 v[204:207], a[12:15], a[40:43], v[204:207]
    v_lshlrev_b32 v224, 16, v242
    v_and_b32 v225, 0xffff0000, v242
    v_mfma_f32_16x16x32_bf16 v[220:223], a[16:19], a[40:43], v[220:223]
    ds_read_b64_tr_b16 a[4:5], v19 offset:43008
    v_accvgpr_read_b32 v242, a96
    v_mfma_f32_16x16x32_bf16 v[216:219], a[16:19], a[36:39], v[216:219]
    ds_read_b64_tr_b16 a[6:7], v19 offset:46080
    v_lshlrev_b32 v240, 16, v242
    v_mfma_f32_16x16x32_bf16 v[212:215], a[16:19], a[32:35], v[212:215]
    ds_read_b64_tr_b16 a[8:9], v18 offset:43072
    v_and_b32 v241, 0xffff0000, v242
    v_mfma_f32_16x16x32_bf16 v[208:211], a[16:19], a[28:31], v[208:211]
    ds_read_b64_tr_b16 a[10:11], v18 offset:46144
    v_mfma_f32_16x16x32_bf16 a[160:163], a[20:23], a[28:31], a[160:163]
    ds_read_b64_tr_b16 a[12:13], v19 offset:43072
    v_mul_f32 v246, v226, v238
    v_mfma_f32_16x16x32_bf16 a[164:167], a[20:23], a[32:35], a[164:167]
    ds_read_b64_tr_b16 a[14:15], v19 offset:46144
    v_mul_f32 v247, v227, v239
    v_mfma_f32_16x16x32_bf16 a[168:171], a[20:23], a[36:39], a[168:171]
    s_add_u32 m0, s38, 12288
    v_fmac_f32 v246, v228, v236
    v_mfma_f32_16x16x32_bf16 a[172:175], a[20:23], a[40:43], a[172:175]
    buffer_load_dwordx4 v8, s[4:7], s35 offen lds
    v_mfma_f32_16x16x32_bf16 a[188:191], a[24:27], a[40:43], a[188:191]
    ds_read_b64_tr_b16 a[16:17], v18 offset:43136
    v_fmac_f32 v247, v229, v237
    v_mfma_f32_16x16x32_bf16 a[184:187], a[24:27], a[36:39], a[184:187]
    ds_read_b64_tr_b16 a[18:19], v18 offset:46208
    v_fmac_f32 v246, v230, v234
    v_mfma_f32_16x16x32_bf16 a[180:183], a[24:27], a[32:35], a[180:183]
    s_add_u32 m0, s38, 13312
    v_fmac_f32 v247, v231, v235
    v_mfma_f32_16x16x32_bf16 a[176:179], a[24:27], a[28:31], a[176:179]
    buffer_load_dwordx4 v9, s[4:7], s35 offen lds
    s_waitcnt lgkmcnt(8)
    v_mfma_f32_16x16x32_bf16 v[32:35], a[0:3], a[44:47], v[32:35]
    ds_read_b64_tr_b16 a[20:21], v19 offset:43136
    v_fmac_f32 v246, v224, v232
    v_mfma_f32_16x16x32_bf16 v[36:39], a[0:3], a[48:51], v[36:39]
    ds_read_b64_tr_b16 a[22:23], v19 offset:46208
    v_fmac_f32 v247, v225, v233
    v_mfma_f32_16x16x32_bf16 v[40:43], a[0:3], a[52:55], v[40:43]
    s_add_u32 m0, s38, 14336
    v_mul_f32 v246, v246, v240
    v_mfma_f32_16x16x32_bf16 v[44:47], a[0:3], a[56:59], v[44:47]
    buffer_load_dwordx4 v10, s[4:7], s35 offen lds
    s_waitcnt lgkmcnt(8)
    v_mfma_f32_16x16x32_bf16 v[60:63], a[4:7], a[56:59], v[60:63]
    ds_read_b64_tr_b16 a[24:25], v20 offset:49152
    v_mul_f32 v247, v247, v241
    v_mfma_f32_16x16x32_bf16 v[56:59], a[4:7], a[52:55], v[56:59]
    ds_read_b64_tr_b16 a[26:27], v20 offset:49664
    v_cvt_pk_bf16_f32 v249, v246, v244
    v_mfma_f32_16x16x32_bf16 v[52:55], a[4:7], a[48:51], v[52:55]
    s_add_u32 m0, s38, 15360
    v_cvt_pk_bf16_f32 v253, v247, v245
    v_mfma_f32_16x16x32_bf16 v[48:51], a[4:7], a[44:47], v[48:51]
    buffer_load_dwordx4 v11, s[4:7], s35 offen lds
    s_waitcnt lgkmcnt(6)
    v_mfma_f32_16x16x32_bf16 v[64:67], a[8:11], a[44:47], v[64:67]
    ds_read_b64_tr_b16 a[0:1], v18 offset:50176
    v_accvgpr_read_b32 v242, a82
    v_mfma_f32_16x16x32_bf16 v[68:71], a[8:11], a[48:51], v[68:71]
    ds_read_b64_tr_b16 a[2:3], v18 offset:53248
    v_lshlrev_b32 v226, 16, v242
    v_mfma_f32_16x16x32_bf16 v[72:75], a[8:11], a[52:55], v[72:75]
    s_add_u32 s35, s35, 128
    s_add_u32 m0, s39, 28672
    v_mfma_f32_16x16x32_bf16 v[76:79], a[8:11], a[56:59], v[76:79]
    buffer_load_dwordx4 v12, s[8:11], s36 offen lds
    v_mfma_f32_16x16x32_bf16 v[92:95], a[12:15], a[56:59], v[92:95]
    ds_read_b64_tr_b16 a[4:5], v19 offset:50176
    v_and_b32 v227, 0xffff0000, v242
    v_mfma_f32_16x16x32_bf16 v[88:91], a[12:15], a[52:55], v[88:91]
    ds_read_b64_tr_b16 a[6:7], v19 offset:53248
    v_accvgpr_read_b32 v242, a98
    v_mfma_f32_16x16x32_bf16 v[84:87], a[12:15], a[48:51], v[84:87]
    s_add_u32 m0, s39, 29696
    v_lshlrev_b32 v240, 16, v242
    v_mfma_f32_16x16x32_bf16 v[80:83], a[12:15], a[44:47], v[80:83]
    buffer_load_dwordx4 v13, s[8:11], s36 offen lds
    s_waitcnt lgkmcnt(6)
    v_mfma_f32_16x16x32_bf16 v[96:99], a[16:19], a[44:47], v[96:99]
    ds_read_b64_tr_b16 a[8:9], v18 offset:50240
    v_and_b32 v241, 0xffff0000, v242
    v_mfma_f32_16x16x32_bf16 v[100:103], a[16:19], a[48:51], v[100:103]
    ds_read_b64_tr_b16 a[10:11], v18 offset:53312
    v_mul_f32 v244, v228, v238
    v_mfma_f32_16x16x32_bf16 v[104:107], a[16:19], a[52:55], v[104:107]
    s_add_u32 m0, s39, 30720
    v_mul_f32 v245, v229, v239
    v_mfma_f32_16x16x32_bf16 v[108:111], a[16:19], a[56:59], v[108:111]
    buffer_load_dwordx4 v14, s[8:11], s36 offen lds
    v_mfma_f32_16x16x32_bf16 v[124:127], a[20:23], a[56:59], v[124:127]
    ds_read_b64_tr_b16 a[12:13], v19 offset:50240
    v_fmac_f32 v244, v230, v236
    v_mfma_f32_16x16x32_bf16 v[120:123], a[20:23], a[52:55], v[120:123]
    ds_read_b64_tr_b16 a[14:15], v19 offset:53312
    v_fmac_f32 v245, v231, v237
    v_mfma_f32_16x16x32_bf16 v[116:119], a[20:23], a[48:51], v[116:119]
    s_add_u32 m0, s40, 28672
    v_fmac_f32 v244, v224, v234
    v_mfma_f32_16x16x32_bf16 v[112:115], a[20:23], a[44:47], v[112:115]
    buffer_load_dwordx4 v15, s[8:11], s36 offen lds
    s_waitcnt lgkmcnt(6)
    v_mfma_f32_16x16x32_bf16 v[128:131], a[24:27], a[44:47], v[128:131]
    ds_read_b64_tr_b16 a[16:17], v18 offset:50304
    v_fmac_f32 v245, v225, v235
    v_mfma_f32_16x16x32_bf16 v[132:135], a[24:27], a[48:51], v[132:135]
    ds_read_b64_tr_b16 a[18:19], v18 offset:53376
    v_fmac_f32 v244, v226, v232
    v_mfma_f32_16x16x32_bf16 v[136:139], a[24:27], a[52:55], v[136:139]
    v_fmac_f32 v245, v227, v233
    v_mul_f32 v244, v244, v240
    v_mfma_f32_16x16x32_bf16 v[140:143], a[24:27], a[56:59], v[140:143]
    v_mul_f32 v245, v245, v241
    v_accvgpr_read_b32 v242, a84
    v_mfma_f32_16x16x32_bf16 v[156:159], a[0:3], a[56:59], v[156:159]
    ds_read_b64_tr_b16 a[20:21], v19 offset:50304
    v_lshlrev_b32 v228, 16, v242
    v_mfma_f32_16x16x32_bf16 v[152:155], a[0:3], a[52:55], v[152:155]
    ds_read_b64_tr_b16 a[22:23], v19 offset:53376
    v_and_b32 v229, 0xffff0000, v242
    v_mfma_f32_16x16x32_bf16 v[148:151], a[0:3], a[48:51], v[148:151]
    s_add_u32 s36, s36, 229376
    v_accvgpr_read_b32 v242, a100
    v_mfma_f32_16x16x32_bf16 v[144:147], a[0:3], a[44:47], v[144:147]
    v_lshlrev_b32 v240, 16, v242
    s_waitcnt lgkmcnt(6)
    v_mfma_f32_16x16x32_bf16 v[160:163], a[4:7], a[44:47], v[160:163]
    ds_read_b64_tr_b16 a[24:25], v20 offset:56320
    v_and_b32 v241, 0xffff0000, v242
    v_mfma_f32_16x16x32_bf16 v[164:167], a[4:7], a[48:51], v[164:167]
    ds_read_b64_tr_b16 a[26:27], v20 offset:56832
    v_mul_f32 v246, v230, v238
    v_mfma_f32_16x16x32_bf16 v[168:171], a[4:7], a[52:55], v[168:171]
    v_mul_f32 v247, v231, v239
    v_fmac_f32 v246, v224, v236
    v_mfma_f32_16x16x32_bf16 v[172:175], a[4:7], a[56:59], v[172:175]
    v_fmac_f32 v247, v225, v237
    v_fmac_f32 v246, v226, v234
    v_mfma_f32_16x16x32_bf16 v[188:191], a[8:11], a[56:59], v[188:191]
    v_fmac_f32 v247, v227, v235
    v_fmac_f32 v246, v228, v232
    v_mfma_f32_16x16x32_bf16 v[184:187], a[8:11], a[52:55], v[184:187]
    v_fmac_f32 v247, v229, v233
    v_mul_f32 v246, v246, v240
    v_mfma_f32_16x16x32_bf16 v[180:183], a[8:11], a[48:51], v[180:183]
    v_mul_f32 v247, v247, v241
    v_cvt_pk_bf16_f32 v248, v246, v244
    v_mfma_f32_16x16x32_bf16 v[176:179], a[8:11], a[44:47], v[176:179]
    s_waitcnt vmcnt(17) lgkmcnt(0)
    s_barrier
    ds_read_b128 a[28:31], v16 offset:0
    v_mfma_f32_16x16x32_bf16 v[192:195], a[12:15], a[44:47], v[192:195]
    ds_read_b64_tr_b16 a[0:1], v18 offset:0
    v_cvt_pk_bf16_f32 v252, v247, v245
    v_mfma_f32_16x16x32_bf16 v[196:199], a[12:15], a[48:51], v[196:199]
    ds_read_b64_tr_b16 a[2:3], v18 offset:3072
    ds_write_b128 v27, v[248:251] offset:0
    v_mfma_f32_16x16x32_bf16 v[200:203], a[12:15], a[52:55], v[200:203]
    ds_read_b128 a[32:35], v16 offset:2048
    ds_write_b128 v27, v[252:255] offset:256
    v_mfma_f32_16x16x32_bf16 v[204:207], a[12:15], a[56:59], v[204:207]
    ds_read_b128 a[36:39], v16 offset:4096
    v_accvgpr_read_b32 v242, a106
    v_mfma_f32_16x16x32_bf16 v[220:223], a[16:19], a[56:59], v[220:223]
    ds_read_b128 a[40:43], v16 offset:6144
    v_lshlrev_b32 v232, 16, v242
    v_mfma_f32_16x16x32_bf16 v[216:219], a[16:19], a[52:55], v[216:219]
    ds_read_b64_tr_b16 a[4:5], v19 offset:0
    v_and_b32 v234, 0xffff0000, v242
    v_mfma_f32_16x16x32_bf16 v[212:215], a[16:19], a[48:51], v[212:215]
    ds_read_b64_tr_b16 a[6:7], v19 offset:3072
    v_accvgpr_read_b32 v242, a108
    v_mfma_f32_16x16x32_bf16 v[208:211], a[16:19], a[44:47], v[208:211]
    ds_read_b64_tr_b16 a[8:9], v18 offset:64
    v_mfma_f32_16x16x32_bf16 a[160:163], a[20:23], a[44:47], a[160:163]
    ds_read_b64_tr_b16 a[10:11], v18 offset:3136
    v_lshlrev_b32 v233, 16, v242
    v_mfma_f32_16x16x32_bf16 a[164:167], a[20:23], a[48:51], a[164:167]
    ds_read_b64_tr_b16 a[12:13], v19 offset:64
    v_and_b32 v235, 0xffff0000, v242
    v_mfma_f32_16x16x32_bf16 a[168:171], a[20:23], a[52:55], a[168:171]
    ds_read_b64_tr_b16 a[14:15], v19 offset:3136
    s_add_u32 m0, s39, 43008
    v_mfma_f32_16x16x32_bf16 a[172:175], a[20:23], a[56:59], a[172:175]
    buffer_load_dwordx4 v12, s[8:11], s36 offen lds
    v_mfma_f32_16x16x32_bf16 a[188:191], a[24:27], a[56:59], a[188:191]
    ds_read_b64_tr_b16 a[16:17], v18 offset:128
    s_waitcnt lgkmcnt(8)
    v_mfma_f32_16x16x32_bf16 a[184:187], a[24:27], a[52:55], a[184:187]
    ds_read_b64_tr_b16 a[18:19], v18 offset:3200
    v_accvgpr_read_b32 v242, a107
    v_mfma_f32_16x16x32_bf16 a[180:183], a[24:27], a[48:51], a[180:183]
    s_add_u32 m0, s39, 44032
    v_lshlrev_b32 v236, 16, v242
    v_mfma_f32_16x16x32_bf16 a[176:179], a[24:27], a[44:47], a[176:179]
    buffer_load_dwordx4 v13, s[8:11], s36 offen lds
    v_mfma_f32_16x16x32_bf16 v[32:35], a[0:3], a[28:31], v[32:35]
    ds_read_b64_tr_b16 a[20:21], v19 offset:128
    v_and_b32 v238, 0xffff0000, v242
    v_mfma_f32_16x16x32_bf16 v[36:39], a[0:3], a[32:35], v[36:39]
    ds_read_b64_tr_b16 a[22:23], v19 offset:3200
    v_accvgpr_read_b32 v242, a109
    v_mfma_f32_16x16x32_bf16 v[40:43], a[0:3], a[36:39], v[40:43]
    ds_read_b128 a[44:47], v17 offset:0
    s_add_u32 m0, s39, 45056
    s_waitcnt lgkmcnt(11)
    v_mfma_f32_16x16x32_bf16 v[44:47], a[0:3], a[40:43], v[44:47]
    buffer_load_dwordx4 v14, s[8:11], s36 offen lds
    s_waitcnt lgkmcnt(9)
    v_mfma_f32_16x16x32_bf16 v[60:63], a[4:7], a[40:43], v[60:63]
    ds_read_b64_tr_b16 a[24:25], v20 offset:6144
    v_lshlrev_b32 v237, 16, v242
    v_mfma_f32_16x16x32_bf16 v[56:59], a[4:7], a[36:39], v[56:59]
    ds_read_b64_tr_b16 a[26:27], v20 offset:6656
    v_and_b32 v239, 0xffff0000, v242
    v_mfma_f32_16x16x32_bf16 v[52:55], a[4:7], a[32:35], v[52:55]
    ds_read_b128 a[48:51], v17 offset:2048
    s_add_u32 m0, s40, 43008
    v_mfma_f32_16x16x32_bf16 v[48:51], a[4:7], a[28:31], v[48:51]
    buffer_load_dwordx4 v15, s[8:11], s36 offen lds
    s_waitcnt lgkmcnt(8)
    v_mfma_f32_16x16x32_bf16 v[64:67], a[8:11], a[28:31], v[64:67]
    ds_read_b64_tr_b16 a[0:1], v18 offset:7168
    v_accvgpr_read_b32 v242, a65
    v_mfma_f32_16x16x32_bf16 v[68:71], a[8:11], a[32:35], v[68:71]
    ds_read_b64_tr_b16 a[2:3], v18 offset:10240
    buffer_load_dword v22, v21, s[64:67], s41 offen
    s_lshl_b32 s44, s2, 2
    s_add_u32 s44, s44, s32
    s_lshl_b32 s46, s44, 1
    s_lshl_b32 s44, s44, 12
    s_mul_i32 s45, s32, 4352
    s_add_u32 s45, s45, 122912
    s_add_u32 m0, s45, 0
    s_add_u32 s47, s44, 0
    buffer_load_dwordx4 v26, s[72:75], s47 offen nt lds
    s_add_u32 m0, s45, 1024
    s_add_u32 s47, s44, 1024
    buffer_load_dwordx4 v26, s[72:75], s47 offen nt lds
    s_add_u32 m0, s45, 2048
    s_add_u32 s47, s44, 2048
    buffer_load_dwordx4 v26, s[72:75], s47 offen nt lds
    s_add_u32 m0, s45, 3072
    s_add_u32 s47, s44, 3072
    buffer_load_dwordx4 v26, s[72:75], s47 offen nt lds
    v_mov_b32 v25, 0
    buffer_load_ushort a80, v25, s[20:23], s46 offen
    v_mfma_f32_16x16x32_bf16 v[72:75], a[8:11], a[36:39], v[72:75]
    ds_read_b128 a[52:55], v17 offset:4096
    s_add_u32 s36, s36, 229376
    s_add_u32 s41, s41, s42
    v_mfma_f32_16x16x32_bf16 v[76:79], a[8:11], a[40:43], v[76:79]
    v_lshlrev_b32 v224, 16, v242
    v_and_b32 v225, 0xffff0000, v242
    v_mfma_f32_16x16x32_bf16 v[92:95], a[12:15], a[40:43], v[92:95]
    ds_read_b64_tr_b16 a[4:5], v19 offset:7168
    v_accvgpr_read_b32 v242, a67
    v_mfma_f32_16x16x32_bf16 v[88:91], a[12:15], a[36:39], v[88:91]
    ds_read_b64_tr_b16 a[6:7], v19 offset:10240
    v_lshlrev_b32 v226, 16, v242
    v_mfma_f32_16x16x32_bf16 v[84:87], a[12:15], a[32:35], v[84:87]
    ds_read_b128 a[56:59], v17 offset:6144
    v_and_b32 v227, 0xffff0000, v242
    v_mfma_f32_16x16x32_bf16 v[80:83], a[12:15], a[28:31], v[80:83]
    v_accvgpr_read_b32 v242, a69
    s_waitcnt lgkmcnt(10)
    v_mfma_f32_16x16x32_bf16 v[96:99], a[16:19], a[28:31], v[96:99]
    ds_read_b64_tr_b16 a[8:9], v18 offset:7232
    v_lshlrev_b32 v228, 16, v242
    v_mfma_f32_16x16x32_bf16 v[100:103], a[16:19], a[32:35], v[100:103]
    ds_read_b64_tr_b16 a[10:11], v18 offset:10304
    v_and_b32 v229, 0xffff0000, v242
    v_mfma_f32_16x16x32_bf16 v[104:107], a[16:19], a[36:39], v[104:107]
    v_accvgpr_read_b32 v242, a71
    v_lshlrev_b32 v230, 16, v242
    v_mfma_f32_16x16x32_bf16 v[108:111], a[16:19], a[40:43], v[108:111]
    v_and_b32 v231, 0xffff0000, v242
    v_accvgpr_read_b32 v242, a87
    v_mfma_f32_16x16x32_bf16 v[124:127], a[20:23], a[40:43], v[124:127]
    ds_read_b64_tr_b16 a[12:13], v19 offset:7232
    v_lshlrev_b32 v240, 16, v242
    v_mfma_f32_16x16x32_bf16 v[120:123], a[20:23], a[36:39], v[120:123]
    ds_read_b64_tr_b16 a[14:15], v19 offset:10304
    s_waitcnt lgkmcnt(4)
    v_mfma_f32_16x16x32_bf16 v[116:119], a[20:23], a[32:35], v[116:119]
    s_add_u32 m0, s38, 0
    v_and_b32 v241, 0xffff0000, v242
    v_mfma_f32_16x16x32_bf16 v[112:115], a[20:23], a[28:31], v[112:115]
    buffer_load_dwordx4 v4, s[4:7], s35 offen lds
    v_mfma_f32_16x16x32_bf16 v[128:131], a[24:27], a[28:31], v[128:131]
    ds_read_b64_tr_b16 a[16:17], v18 offset:7296
    v_mul_f32 v244, v224, v238
    v_mfma_f32_16x16x32_bf16 v[132:135], a[24:27], a[32:35], v[132:135]
    ds_read_b64_tr_b16 a[18:19], v18 offset:10368
    v_mul_f32 v245, v225, v239
    v_mfma_f32_16x16x32_bf16 v[136:139], a[24:27], a[36:39], v[136:139]
    s_add_u32 m0, s38, 1024
    v_fmac_f32 v244, v226, v236
    v_mfma_f32_16x16x32_bf16 v[140:143], a[24:27], a[40:43], v[140:143]
    buffer_load_dwordx4 v5, s[4:7], s35 offen lds
    v_mfma_f32_16x16x32_bf16 v[156:159], a[0:3], a[40:43], v[156:159]
    ds_read_b64_tr_b16 a[20:21], v19 offset:7296
    v_fmac_f32 v245, v227, v237
    v_mfma_f32_16x16x32_bf16 v[152:155], a[0:3], a[36:39], v[152:155]
    ds_read_b64_tr_b16 a[22:23], v19 offset:10368
    v_fmac_f32 v244, v228, v234
    v_mfma_f32_16x16x32_bf16 v[148:151], a[0:3], a[32:35], v[148:151]
    s_add_u32 m0, s38, 2048
    v_fmac_f32 v245, v229, v235
    v_mfma_f32_16x16x32_bf16 v[144:147], a[0:3], a[28:31], v[144:147]
    buffer_load_dwordx4 v6, s[4:7], s35 offen lds
    s_waitcnt lgkmcnt(6)
    v_mfma_f32_16x16x32_bf16 v[160:163], a[4:7], a[28:31], v[160:163]
    ds_read_b64_tr_b16 a[24:25], v20 offset:13312
    v_fmac_f32 v244, v230, v232
    v_mfma_f32_16x16x32_bf16 v[164:167], a[4:7], a[32:35], v[164:167]
    ds_read_b64_tr_b16 a[26:27], v20 offset:13824
    v_fmac_f32 v245, v231, v233
    v_mfma_f32_16x16x32_bf16 v[168:171], a[4:7], a[36:39], v[168:171]
    s_add_u32 m0, s38, 3072
    v_mul_f32 v244, v244, v240
    v_mfma_f32_16x16x32_bf16 v[172:175], a[4:7], a[40:43], v[172:175]
    buffer_load_dwordx4 v7, s[4:7], s35 offen lds
    v_mfma_f32_16x16x32_bf16 v[188:191], a[8:11], a[40:43], v[188:191]
    v_mul_f32 v245, v245, v241
    v_accvgpr_read_b32 v242, a73
    v_mfma_f32_16x16x32_bf16 v[184:187], a[8:11], a[36:39], v[184:187]
    v_lshlrev_b32 v224, 16, v242
    v_and_b32 v225, 0xffff0000, v242
    v_mfma_f32_16x16x32_bf16 v[180:183], a[8:11], a[32:35], v[180:183]
    v_accvgpr_read_b32 v242, a89
    v_lshlrev_b32 v240, 16, v242
    v_mfma_f32_16x16x32_bf16 v[176:179], a[8:11], a[28:31], v[176:179]
    s_waitcnt vmcnt(27) lgkmcnt(0)
    s_barrier
    v_mfma_f32_16x16x32_bf16 v[192:195], a[12:15], a[28:31], v[192:195]
    ds_read_b64_tr_b16 a[0:1], v18 offset:14336
    v_and_b32 v241, 0xffff0000, v242
    v_mfma_f32_16x16x32_bf16 v[196:199], a[12:15], a[32:35], v[196:199]
    ds_read_b64_tr_b16 a[2:3], v18 offset:17408
    v_mul_f32 v246, v226, v238
    v_mfma_f32_16x16x32_bf16 v[200:203], a[12:15], a[36:39], v[200:203]
    v_mul_f32 v247, v227, v239
    v_fmac_f32 v246, v228, v236
    v_mfma_f32_16x16x32_bf16 v[204:207], a[12:15], a[40:43], v[204:207]
    v_fmac_f32 v247, v229, v237
    v_fmac_f32 v246, v230, v234
    v_mfma_f32_16x16x32_bf16 v[220:223], a[16:19], a[40:43], v[220:223]
    ds_read_b64_tr_b16 a[4:5], v19 offset:14336
    v_fmac_f32 v247, v231, v235
    v_mfma_f32_16x16x32_bf16 v[216:219], a[16:19], a[36:39], v[216:219]
    ds_read_b64_tr_b16 a[6:7], v19 offset:17408
    v_fmac_f32 v246, v224, v232
    v_mfma_f32_16x16x32_bf16 v[212:215], a[16:19], a[32:35], v[212:215]
    ds_read_b64_tr_b16 a[8:9], v18 offset:14400
    v_fmac_f32 v247, v225, v233
    v_mfma_f32_16x16x32_bf16 v[208:211], a[16:19], a[28:31], v[208:211]
    ds_read_b64_tr_b16 a[10:11], v18 offset:17472
    v_mfma_f32_16x16x32_bf16 a[160:163], a[20:23], a[28:31], a[160:163]
    ds_read_b64_tr_b16 a[12:13], v19 offset:14400
    v_mul_f32 v246, v246, v240
    v_mfma_f32_16x16x32_bf16 a[164:167], a[20:23], a[32:35], a[164:167]
    ds_read_b64_tr_b16 a[14:15], v19 offset:17472
    v_mul_f32 v247, v247, v241
    v_mfma_f32_16x16x32_bf16 a[168:171], a[20:23], a[36:39], a[168:171]
    s_add_u32 m0, s38, 4096
    v_cvt_pk_bf16_f32 v251, v246, v244
    v_mfma_f32_16x16x32_bf16 a[172:175], a[20:23], a[40:43], a[172:175]
    buffer_load_dwordx4 v8, s[4:7], s35 offen lds
    v_mfma_f32_16x16x32_bf16 a[188:191], a[24:27], a[40:43], a[188:191]
    ds_read_b64_tr_b16 a[16:17], v18 offset:14464
    v_cvt_pk_bf16_f32 v255, v247, v245
    v_mfma_f32_16x16x32_bf16 a[184:187], a[24:27], a[36:39], a[184:187]
    ds_read_b64_tr_b16 a[18:19], v18 offset:17536
    v_accvgpr_read_b32 v242, a75
    v_mfma_f32_16x16x32_bf16 a[180:183], a[24:27], a[32:35], a[180:183]
    s_add_u32 m0, s38, 5120
    v_lshlrev_b32 v226, 16, v242
    v_mfma_f32_16x16x32_bf16 a[176:179], a[24:27], a[28:31], a[176:179]
    buffer_load_dwordx4 v9, s[4:7], s35 offen lds
    s_waitcnt lgkmcnt(8)
    v_mfma_f32_16x16x32_bf16 v[32:35], a[0:3], a[44:47], v[32:35]
    ds_read_b64_tr_b16 a[20:21], v19 offset:14464
    v_and_b32 v227, 0xffff0000, v242
    v_mfma_f32_16x16x32_bf16 v[36:39], a[0:3], a[48:51], v[36:39]
    ds_read_b64_tr_b16 a[22:23], v19 offset:17536
    v_accvgpr_read_b32 v242, a91
    v_mfma_f32_16x16x32_bf16 v[40:43], a[0:3], a[52:55], v[40:43]
    s_add_u32 m0, s38, 6144
    v_lshlrev_b32 v240, 16, v242
    v_mfma_f32_16x16x32_bf16 v[44:47], a[0:3], a[56:59], v[44:47]
    buffer_load_dwordx4 v10, s[4:7], s35 offen lds
    s_waitcnt lgkmcnt(8)
    v_mfma_f32_16x16x32_bf16 v[60:63], a[4:7], a[56:59], v[60:63]
    ds_read_b64_tr_b16 a[24:25], v20 offset:20480
    v_and_b32 v241, 0xffff0000, v242
    v_mfma_f32_16x16x32_bf16 v[56:59], a[4:7], a[52:55], v[56:59]
    ds_read_b64_tr_b16 a[26:27], v20 offset:20992
    v_mul_f32 v244, v228, v238
    v_mfma_f32_16x16x32_bf16 v[52:55], a[4:7], a[48:51], v[52:55]
    s_add_u32 m0, s38, 7168
    v_mul_f32 v245, v229, v239
    v_mfma_f32_16x16x32_bf16 v[48:51], a[4:7], a[44:47], v[48:51]
    buffer_load_dwordx4 v11, s[4:7], s35 offen lds
    s_waitcnt lgkmcnt(6)
    v_mfma_f32_16x16x32_bf16 v[64:67], a[8:11], a[44:47], v[64:67]
    ds_read_b64_tr_b16 a[0:1], v18 offset:21504
    v_fmac_f32 v244, v230, v236
    v_mfma_f32_16x16x32_bf16 v[68:71], a[8:11], a[48:51], v[68:71]
    ds_read_b64_tr_b16 a[2:3], v18 offset:24576
    v_fmac_f32 v245, v231, v237
    v_mfma_f32_16x16x32_bf16 v[72:75], a[8:11], a[52:55], v[72:75]
    s_add_u32 s35, s35, 128
    s_add_u32 m0, s39, 0
    v_mfma_f32_16x16x32_bf16 v[76:79], a[8:11], a[56:59], v[76:79]
    buffer_load_dwordx4 v12, s[8:11], s36 offen lds
    v_mfma_f32_16x16x32_bf16 v[92:95], a[12:15], a[56:59], v[92:95]
    ds_read_b64_tr_b16 a[4:5], v19 offset:21504
    v_fmac_f32 v244, v224, v234
    v_mfma_f32_16x16x32_bf16 v[88:91], a[12:15], a[52:55], v[88:91]
    ds_read_b64_tr_b16 a[6:7], v19 offset:24576
    v_fmac_f32 v245, v225, v235
    v_mfma_f32_16x16x32_bf16 v[84:87], a[12:15], a[48:51], v[84:87]
    s_add_u32 m0, s39, 1024
    v_fmac_f32 v244, v226, v232
    v_mfma_f32_16x16x32_bf16 v[80:83], a[12:15], a[44:47], v[80:83]
    buffer_load_dwordx4 v13, s[8:11], s36 offen lds
    s_waitcnt lgkmcnt(6)
    v_mfma_f32_16x16x32_bf16 v[96:99], a[16:19], a[44:47], v[96:99]
    ds_read_b64_tr_b16 a[8:9], v18 offset:21568
    v_fmac_f32 v245, v227, v233
    v_mfma_f32_16x16x32_bf16 v[100:103], a[16:19], a[48:51], v[100:103]
    ds_read_b64_tr_b16 a[10:11], v18 offset:24640
    v_mul_f32 v244, v244, v240
    v_mfma_f32_16x16x32_bf16 v[104:107], a[16:19], a[52:55], v[104:107]
    s_add_u32 m0, s39, 2048
    v_mul_f32 v245, v245, v241
    v_mfma_f32_16x16x32_bf16 v[108:111], a[16:19], a[56:59], v[108:111]
    buffer_load_dwordx4 v14, s[8:11], s36 offen lds
    v_mfma_f32_16x16x32_bf16 v[124:127], a[20:23], a[56:59], v[124:127]
    ds_read_b64_tr_b16 a[12:13], v19 offset:21568
    v_accvgpr_read_b32 v242, a77
    v_mfma_f32_16x16x32_bf16 v[120:123], a[20:23], a[52:55], v[120:123]
    ds_read_b64_tr_b16 a[14:15], v19 offset:24640
    v_lshlrev_b32 v228, 16, v242
    v_mfma_f32_16x16x32_bf16 v[116:119], a[20:23], a[48:51], v[116:119]
    s_add_u32 m0, s40, 0
    v_and_b32 v229, 0xffff0000, v242
    v_mfma_f32_16x16x32_bf16 v[112:115], a[20:23], a[44:47], v[112:115]
    buffer_load_dwordx4 v15, s[8:11], s36 offen lds
    s_waitcnt lgkmcnt(6)
    v_mfma_f32_16x16x32_bf16 v[128:131], a[24:27], a[44:47], v[128:131]
    ds_read_b64_tr_b16 a[16:17], v18 offset:21632
    v_accvgpr_read_b32 v242, a93
    v_mfma_f32_16x16x32_bf16 v[132:135], a[24:27], a[48:51], v[132:135]
    ds_read_b64_tr_b16 a[18:19], v18 offset:24704
    v_lshlrev_b32 v240, 16, v242
    v_mfma_f32_16x16x32_bf16 v[136:139], a[24:27], a[52:55], v[136:139]
    v_and_b32 v241, 0xffff0000, v242
    v_mul_f32 v246, v230, v238
    v_mfma_f32_16x16x32_bf16 v[140:143], a[24:27], a[56:59], v[140:143]
    v_mul_f32 v247, v231, v239
    v_fmac_f32 v246, v224, v236
    v_mfma_f32_16x16x32_bf16 v[156:159], a[0:3], a[56:59], v[156:159]
    ds_read_b64_tr_b16 a[20:21], v19 offset:21632
    v_fmac_f32 v247, v225, v237
    v_mfma_f32_16x16x32_bf16 v[152:155], a[0:3], a[52:55], v[152:155]
    ds_read_b64_tr_b16 a[22:23], v19 offset:24704
    v_fmac_f32 v246, v226, v234
    v_mfma_f32_16x16x32_bf16 v[148:151], a[0:3], a[48:51], v[148:151]
    s_add_u32 s36, s36, 229376
    v_fmac_f32 v247, v227, v235
    v_mfma_f32_16x16x32_bf16 v[144:147], a[0:3], a[44:47], v[144:147]
    v_fmac_f32 v246, v228, v232
    s_waitcnt lgkmcnt(6)
    v_mfma_f32_16x16x32_bf16 v[160:163], a[4:7], a[44:47], v[160:163]
    ds_read_b64_tr_b16 a[24:25], v20 offset:27648
    v_fmac_f32 v247, v229, v233
    v_mfma_f32_16x16x32_bf16 v[164:167], a[4:7], a[48:51], v[164:167]
    ds_read_b64_tr_b16 a[26:27], v20 offset:28160
    v_mul_f32 v246, v246, v240
    v_mfma_f32_16x16x32_bf16 v[168:171], a[4:7], a[52:55], v[168:171]
    v_mul_f32 v247, v247, v241
    v_cvt_pk_bf16_f32 v250, v246, v244
    v_mfma_f32_16x16x32_bf16 v[172:175], a[4:7], a[56:59], v[172:175]
    v_cvt_pk_bf16_f32 v254, v247, v245
    v_accvgpr_read_b32 v242, a79
    v_mfma_f32_16x16x32_bf16 v[188:191], a[8:11], a[56:59], v[188:191]
    v_lshlrev_b32 v230, 16, v242
    v_and_b32 v231, 0xffff0000, v242
    v_mfma_f32_16x16x32_bf16 v[184:187], a[8:11], a[52:55], v[184:187]
    v_accvgpr_read_b32 v242, a95
    v_lshlrev_b32 v240, 16, v242
    v_mfma_f32_16x16x32_bf16 v[180:183], a[8:11], a[48:51], v[180:183]
    v_and_b32 v241, 0xffff0000, v242
    v_mul_f32 v244, v224, v238
    v_mfma_f32_16x16x32_bf16 v[176:179], a[8:11], a[44:47], v[176:179]
    s_waitcnt vmcnt(22) lgkmcnt(0)
    s_barrier
    ds_read_b128 a[28:31], v16 offset:8192
    v_mfma_f32_16x16x32_bf16 v[192:195], a[12:15], a[44:47], v[192:195]
    ds_read_b64_tr_b16 a[0:1], v18 offset:28672
    v_mul_f32 v245, v225, v239
    v_mfma_f32_16x16x32_bf16 v[196:199], a[12:15], a[48:51], v[196:199]
    ds_read_b64_tr_b16 a[2:3], v18 offset:31744
    v_fmac_f32 v244, v226, v236
    v_mfma_f32_16x16x32_bf16 v[200:203], a[12:15], a[52:55], v[200:203]
    ds_read_b128 a[32:35], v16 offset:10240
    v_fmac_f32 v245, v227, v237
    v_mfma_f32_16x16x32_bf16 v[204:207], a[12:15], a[56:59], v[204:207]
    ds_read_b128 a[36:39], v16 offset:12288
    v_fmac_f32 v244, v228, v234
    v_mfma_f32_16x16x32_bf16 v[220:223], a[16:19], a[56:59], v[220:223]
    ds_read_b128 a[40:43], v16 offset:14336
    v_fmac_f32 v245, v229, v235
    v_mfma_f32_16x16x32_bf16 v[216:219], a[16:19], a[52:55], v[216:219]
    ds_read_b64_tr_b16 a[4:5], v19 offset:28672
    v_fmac_f32 v244, v230, v232
    v_mfma_f32_16x16x32_bf16 v[212:215], a[16:19], a[48:51], v[212:215]
    ds_read_b64_tr_b16 a[6:7], v19 offset:31744
    v_fmac_f32 v245, v231, v233
    v_mfma_f32_16x16x32_bf16 v[208:211], a[16:19], a[44:47], v[208:211]
    ds_read_b64_tr_b16 a[8:9], v18 offset:28736
    v_mfma_f32_16x16x32_bf16 a[160:163], a[20:23], a[44:47], a[160:163]
    ds_read_b64_tr_b16 a[10:11], v18 offset:31808
    v_mul_f32 v244, v244, v240
    v_mfma_f32_16x16x32_bf16 a[164:167], a[20:23], a[48:51], a[164:167]
    ds_read_b64_tr_b16 a[12:13], v19 offset:28736
    v_mul_f32 v245, v245, v241
    v_mfma_f32_16x16x32_bf16 a[168:171], a[20:23], a[52:55], a[168:171]
    ds_read_b64_tr_b16 a[14:15], v19 offset:31808
    s_add_u32 m0, s39, 14336
    v_mfma_f32_16x16x32_bf16 a[172:175], a[20:23], a[56:59], a[172:175]
    buffer_load_dwordx4 v12, s[8:11], s36 offen lds
    v_mfma_f32_16x16x32_bf16 a[188:191], a[24:27], a[56:59], a[188:191]
    ds_read_b64_tr_b16 a[16:17], v18 offset:28800
    v_accvgpr_read_b32 v242, a81
    v_mfma_f32_16x16x32_bf16 a[184:187], a[24:27], a[52:55], a[184:187]
    ds_read_b64_tr_b16 a[18:19], v18 offset:31872
    v_lshlrev_b32 v224, 16, v242
    v_mfma_f32_16x16x32_bf16 a[180:183], a[24:27], a[48:51], a[180:183]
    s_add_u32 m0, s39, 15360
    v_and_b32 v225, 0xffff0000, v242
    v_mfma_f32_16x16x32_bf16 a[176:179], a[24:27], a[44:47], a[176:179]
    buffer_load_dwordx4 v13, s[8:11], s36 offen lds
    s_waitcnt lgkmcnt(11)
    v_mfma_f32_16x16x32_bf16 v[32:35], a[0:3], a[28:31], v[32:35]
    ds_read_b64_tr_b16 a[20:21], v19 offset:28800
    v_accvgpr_read_b32 v242, a97
    s_waitcnt lgkmcnt(11)
    v_mfma_f32_16x16x32_bf16 v[36:39], a[0:3], a[32:35], v[36:39]
    ds_read_b64_tr_b16 a[22:23], v19 offset:31872
    v_lshlrev_b32 v240, 16, v242
    s_waitcnt lgkmcnt(11)
    v_mfma_f32_16x16x32_bf16 v[40:43], a[0:3], a[36:39], v[40:43]
    ds_read_b128 a[44:47], v17 offset:8192
    s_add_u32 m0, s39, 16384
    s_waitcnt lgkmcnt(11)
    v_mfma_f32_16x16x32_bf16 v[44:47], a[0:3], a[40:43], v[44:47]
    buffer_load_dwordx4 v14, s[8:11], s36 offen lds
    s_waitcnt lgkmcnt(9)
    v_mfma_f32_16x16x32_bf16 v[60:63], a[4:7], a[40:43], v[60:63]
    ds_read_b64_tr_b16 a[24:25], v20 offset:34816
    v_and_b32 v241, 0xffff0000, v242
    v_mfma_f32_16x16x32_bf16 v[56:59], a[4:7], a[36:39], v[56:59]
    ds_read_b64_tr_b16 a[26:27], v20 offset:35328
    v_mul_f32 v246, v226, v238
    v_mfma_f32_16x16x32_bf16 v[52:55], a[4:7], a[32:35], v[52:55]
    ds_read_b128 a[48:51], v17 offset:10240
    s_add_u32 m0, s40, 14336
    v_mfma_f32_16x16x32_bf16 v[48:51], a[4:7], a[28:31], v[48:51]
    buffer_load_dwordx4 v15, s[8:11], s36 offen lds
    s_waitcnt lgkmcnt(8)
    v_mfma_f32_16x16x32_bf16 v[64:67], a[8:11], a[28:31], v[64:67]
    ds_read_b64_tr_b16 a[0:1], v18 offset:35840
    v_mul_f32 v247, v227, v239
    v_mfma_f32_16x16x32_bf16 v[68:71], a[8:11], a[32:35], v[68:71]
    ds_read_b64_tr_b16 a[2:3], v18 offset:38912
    buffer_load_dword v22, v3, s[4:7], s92 offen
    v_mfma_f32_16x16x32_bf16 v[72:75], a[8:11], a[36:39], v[72:75]
    ds_read_b128 a[52:55], v17 offset:12288
    s_add_u32 s36, s36, 229376
    s_add_u32 s92, s92, 256
    v_mfma_f32_16x16x32_bf16 v[76:79], a[8:11], a[40:43], v[76:79]
    v_fmac_f32 v246, v228, v236
    v_fmac_f32 v247, v229, v237
    v_mfma_f32_16x16x32_bf16 v[92:95], a[12:15], a[40:43], v[92:95]
    ds_read_b64_tr_b16 a[4:5], v19 offset:35840
    v_fmac_f32 v246, v230, v234
    v_mfma_f32_16x16x32_bf16 v[88:91], a[12:15], a[36:39], v[88:91]
    ds_read_b64_tr_b16 a[6:7], v19 offset:38912
    v_fmac_f32 v247, v231, v235
    v_mfma_f32_16x16x32_bf16 v[84:87], a[12:15], a[32:35], v[84:87]
    ds_read_b128 a[56:59], v17 offset:14336
    v_fmac_f32 v246, v224, v232
    v_mfma_f32_16x16x32_bf16 v[80:83], a[12:15], a[28:31], v[80:83]
    v_fmac_f32 v247, v225, v233
    s_waitcnt lgkmcnt(10)
    v_mfma_f32_16x16x32_bf16 v[96:99], a[16:19], a[28:31], v[96:99]
    ds_read_b64_tr_b16 a[8:9], v18 offset:35904
    v_mul_f32 v246, v246, v240
    v_mfma_f32_16x16x32_bf16 v[100:103], a[16:19], a[32:35], v[100:103]
    ds_read_b64_tr_b16 a[10:11], v18 offset:38976
    v_mul_f32 v247, v247, v241
    v_mfma_f32_16x16x32_bf16 v[104:107], a[16:19], a[36:39], v[104:107]
    v_cvt_pk_bf16_f32 v249, v246, v244
    v_cvt_pk_bf16_f32 v253, v247, v245
    v_mfma_f32_16x16x32_bf16 v[108:111], a[16:19], a[40:43], v[108:111]
    v_accvgpr_read_b32 v242, a83
    v_lshlrev_b32 v226, 16, v242
    v_mfma_f32_16x16x32_bf16 v[124:127], a[20:23], a[40:43], v[124:127]
    ds_read_b64_tr_b16 a[12:13], v19 offset:35904
    v_and_b32 v227, 0xffff0000, v242
    v_mfma_f32_16x16x32_bf16 v[120:123], a[20:23], a[36:39], v[120:123]
    ds_read_b64_tr_b16 a[14:15], v19 offset:38976
    s_waitcnt lgkmcnt(4)
    v_mfma_f32_16x16x32_bf16 v[116:119], a[20:23], a[32:35], v[116:119]
    s_add_u32 m0, s38, 8192
    v_accvgpr_read_b32 v242, a99
    v_mfma_f32_16x16x32_bf16 v[112:115], a[20:23], a[28:31], v[112:115]
    buffer_load_dwordx4 v4, s[4:7], s35 offen lds
    v_mfma_f32_16x16x32_bf16 v[128:131], a[24:27], a[28:31], v[128:131]
    ds_read_b64_tr_b16 a[16:17], v18 offset:35968
    v_lshlrev_b32 v240, 16, v242
    v_mfma_f32_16x16x32_bf16 v[132:135], a[24:27], a[32:35], v[132:135]
    ds_read_b64_tr_b16 a[18:19], v18 offset:39040
    v_and_b32 v241, 0xffff0000, v242
    v_mfma_f32_16x16x32_bf16 v[136:139], a[24:27], a[36:39], v[136:139]
    s_add_u32 m0, s38, 9216
    v_mul_f32 v244, v228, v238
    v_mfma_f32_16x16x32_bf16 v[140:143], a[24:27], a[40:43], v[140:143]
    buffer_load_dwordx4 v5, s[4:7], s35 offen lds
    v_mfma_f32_16x16x32_bf16 v[156:159], a[0:3], a[40:43], v[156:159]
    ds_read_b64_tr_b16 a[20:21], v19 offset:35968
    v_mul_f32 v245, v229, v239
    v_mfma_f32_16x16x32_bf16 v[152:155], a[0:3], a[36:39], v[152:155]
    ds_read_b64_tr_b16 a[22:23], v19 offset:39040
    v_fmac_f32 v244, v230, v236
    v_mfma_f32_16x16x32_bf16 v[148:151], a[0:3], a[32:35], v[148:151]
    s_add_u32 m0, s38, 10240
    v_fmac_f32 v245, v231, v237
    v_mfma_f32_16x16x32_bf16 v[144:147], a[0:3], a[28:31], v[144:147]
    buffer_load_dwordx4 v6, s[4:7], s35 offen lds
    s_waitcnt lgkmcnt(6)
    v_mfma_f32_16x16x32_bf16 v[160:163], a[4:7], a[28:31], v[160:163]
    ds_read_b64_tr_b16 a[24:25], v20 offset:41984
    v_fmac_f32 v244, v224, v234
    v_mfma_f32_16x16x32_bf16 v[164:167], a[4:7], a[32:35], v[164:167]
    ds_read_b64_tr_b16 a[26:27], v20 offset:42496
    v_fmac_f32 v245, v225, v235
    v_mfma_f32_16x16x32_bf16 v[168:171], a[4:7], a[36:39], v[168:171]
    s_add_u32 m0, s38, 11264
    v_fmac_f32 v244, v226, v232
    v_mfma_f32_16x16x32_bf16 v[172:175], a[4:7], a[40:43], v[172:175]
    buffer_load_dwordx4 v7, s[4:7], s35 offen lds
    v_mfma_f32_16x16x32_bf16 v[188:191], a[8:11], a[40:43], v[188:191]
    v_fmac_f32 v245, v227, v233
    v_mul_f32 v244, v244, v240
    v_mfma_f32_16x16x32_bf16 v[184:187], a[8:11], a[36:39], v[184:187]
    v_mul_f32 v245, v245, v241
    v_accvgpr_read_b32 v242, a85
    v_mfma_f32_16x16x32_bf16 v[180:183], a[8:11], a[32:35], v[180:183]
    v_lshlrev_b32 v228, 16, v242
    v_and_b32 v229, 0xffff0000, v242
    v_mfma_f32_16x16x32_bf16 v[176:179], a[8:11], a[28:31], v[176:179]
    s_waitcnt vmcnt(27) lgkmcnt(0)
    s_barrier
    v_mfma_f32_16x16x32_bf16 v[192:195], a[12:15], a[28:31], v[192:195]
    ds_read_b64_tr_b16 a[0:1], v18 offset:43008
    v_accvgpr_read_b32 v242, a101
    v_mfma_f32_16x16x32_bf16 v[196:199], a[12:15], a[32:35], v[196:199]
    ds_read_b64_tr_b16 a[2:3], v18 offset:46080
    v_lshlrev_b32 v240, 16, v242
    v_mfma_f32_16x16x32_bf16 v[200:203], a[12:15], a[36:39], v[200:203]
    v_and_b32 v241, 0xffff0000, v242
    v_mul_f32 v246, v230, v238
    v_mfma_f32_16x16x32_bf16 v[204:207], a[12:15], a[40:43], v[204:207]
    v_mul_f32 v247, v231, v239
    v_fmac_f32 v246, v224, v236
    v_mfma_f32_16x16x32_bf16 v[220:223], a[16:19], a[40:43], v[220:223]
    ds_read_b64_tr_b16 a[4:5], v19 offset:43008
    v_fmac_f32 v247, v225, v237
    v_mfma_f32_16x16x32_bf16 v[216:219], a[16:19], a[36:39], v[216:219]
    ds_read_b64_tr_b16 a[6:7], v19 offset:46080
    v_fmac_f32 v246, v226, v234
    v_mfma_f32_16x16x32_bf16 v[212:215], a[16:19], a[32:35], v[212:215]
    ds_read_b64_tr_b16 a[8:9], v18 offset:43072
    v_fmac_f32 v247, v227, v235
    v_mfma_f32_16x16x32_bf16 v[208:211], a[16:19], a[28:31], v[208:211]
    ds_read_b64_tr_b16 a[10:11], v18 offset:46144
    v_mfma_f32_16x16x32_bf16 a[160:163], a[20:23], a[28:31], a[160:163]
    ds_read_b64_tr_b16 a[12:13], v19 offset:43072
    v_fmac_f32 v246, v228, v232
    v_mfma_f32_16x16x32_bf16 a[164:167], a[20:23], a[32:35], a[164:167]
    ds_read_b64_tr_b16 a[14:15], v19 offset:46144
    v_fmac_f32 v247, v229, v233
    v_mfma_f32_16x16x32_bf16 a[168:171], a[20:23], a[36:39], a[168:171]
    s_add_u32 m0, s38, 12288
    v_mul_f32 v246, v246, v240
    v_mfma_f32_16x16x32_bf16 a[172:175], a[20:23], a[40:43], a[172:175]
    buffer_load_dwordx4 v8, s[4:7], s35 offen lds
    v_mfma_f32_16x16x32_bf16 a[188:191], a[24:27], a[40:43], a[188:191]
    ds_read_b64_tr_b16 a[16:17], v18 offset:43136
    v_mul_f32 v247, v247, v241
    v_mfma_f32_16x16x32_bf16 a[184:187], a[24:27], a[36:39], a[184:187]
    ds_read_b64_tr_b16 a[18:19], v18 offset:46208
    v_cvt_pk_bf16_f32 v248, v246, v244
    v_mfma_f32_16x16x32_bf16 a[180:183], a[24:27], a[32:35], a[180:183]
    s_add_u32 m0, s38, 13312
    v_cvt_pk_bf16_f32 v252, v247, v245
    v_mfma_f32_16x16x32_bf16 a[176:179], a[24:27], a[28:31], a[176:179]
    buffer_load_dwordx4 v9, s[4:7], s35 offen lds
    s_waitcnt lgkmcnt(8)
    v_mfma_f32_16x16x32_bf16 v[32:35], a[0:3], a[44:47], v[32:35]
    ds_read_b64_tr_b16 a[20:21], v19 offset:43136
    ds_write_b128 v27, v[248:251] offset:512
    v_mfma_f32_16x16x32_bf16 v[36:39], a[0:3], a[48:51], v[36:39]
    ds_read_b64_tr_b16 a[22:23], v19 offset:46208
    ds_write_b128 v27, v[252:255] offset:768
    v_mfma_f32_16x16x32_bf16 v[40:43], a[0:3], a[52:55], v[40:43]
    s_add_u32 m0, s38, 14336
    v_mfma_f32_16x16x32_bf16 v[44:47], a[0:3], a[56:59], v[44:47]
    buffer_load_dwordx4 v10, s[4:7], s35 offen lds
    s_waitcnt lgkmcnt(10)
    v_mfma_f32_16x16x32_bf16 v[60:63], a[4:7], a[56:59], v[60:63]
    ds_read_b64_tr_b16 a[24:25], v20 offset:49152
    v_mfma_f32_16x16x32_bf16 v[56:59], a[4:7], a[52:55], v[56:59]
    ds_read_b64_tr_b16 a[26:27], v20 offset:49664
    v_mfma_f32_16x16x32_bf16 v[52:55], a[4:7], a[48:51], v[52:55]
    s_add_u32 m0, s38, 15360
    v_mfma_f32_16x16x32_bf16 v[48:51], a[4:7], a[44:47], v[48:51]
    buffer_load_dwordx4 v11, s[4:7], s35 offen lds
    s_waitcnt lgkmcnt(8)
    v_mfma_f32_16x16x32_bf16 v[64:67], a[8:11], a[44:47], v[64:67]
    ds_read_b64_tr_b16 a[0:1], v18 offset:50176
    v_mfma_f32_16x16x32_bf16 v[68:71], a[8:11], a[48:51], v[68:71]
    ds_read_b64_tr_b16 a[2:3], v18 offset:53248
    v_mfma_f32_16x16x32_bf16 v[72:75], a[8:11], a[52:55], v[72:75]
    s_add_u32 s35, s35, 128
    s_add_u32 m0, s39, 28672
    v_mfma_f32_16x16x32_bf16 v[76:79], a[8:11], a[56:59], v[76:79]
    buffer_load_dwordx4 v12, s[8:11], s36 offen lds
    v_mfma_f32_16x16x32_bf16 v[92:95], a[12:15], a[56:59], v[92:95]
    ds_read_b64_tr_b16 a[4:5], v19 offset:50176
    v_mfma_f32_16x16x32_bf16 v[88:91], a[12:15], a[52:55], v[88:91]
    ds_read_b64_tr_b16 a[6:7], v19 offset:53248
    v_mfma_f32_16x16x32_bf16 v[84:87], a[12:15], a[48:51], v[84:87]
    s_add_u32 m0, s39, 29696
    v_mfma_f32_16x16x32_bf16 v[80:83], a[12:15], a[44:47], v[80:83]
    buffer_load_dwordx4 v13, s[8:11], s36 offen lds
    s_waitcnt lgkmcnt(7)
    v_mfma_f32_16x16x32_bf16 v[96:99], a[16:19], a[44:47], v[96:99]
    ds_read_b64_tr_b16 a[8:9], v18 offset:50240
    v_mfma_f32_16x16x32_bf16 v[100:103], a[16:19], a[48:51], v[100:103]
    ds_read_b64_tr_b16 a[10:11], v18 offset:53312
    v_mfma_f32_16x16x32_bf16 v[104:107], a[16:19], a[52:55], v[104:107]
    s_add_u32 m0, s39, 30720
    v_mfma_f32_16x16x32_bf16 v[108:111], a[16:19], a[56:59], v[108:111]
    buffer_load_dwordx4 v14, s[8:11], s36 offen lds
    v_mfma_f32_16x16x32_bf16 v[124:127], a[20:23], a[56:59], v[124:127]
    ds_read_b64_tr_b16 a[12:13], v19 offset:50240
    v_mfma_f32_16x16x32_bf16 v[120:123], a[20:23], a[52:55], v[120:123]
    ds_read_b64_tr_b16 a[14:15], v19 offset:53312
    v_mfma_f32_16x16x32_bf16 v[116:119], a[20:23], a[48:51], v[116:119]
    s_add_u32 m0, s40, 28672
    v_mfma_f32_16x16x32_bf16 v[112:115], a[20:23], a[44:47], v[112:115]
    buffer_load_dwordx4 v15, s[8:11], s36 offen lds
    s_waitcnt lgkmcnt(6)
    v_mfma_f32_16x16x32_bf16 v[128:131], a[24:27], a[44:47], v[128:131]
    ds_read_b64_tr_b16 a[16:17], v18 offset:50304
    v_mfma_f32_16x16x32_bf16 v[132:135], a[24:27], a[48:51], v[132:135]
    ds_read_b64_tr_b16 a[18:19], v18 offset:53376
    v_mfma_f32_16x16x32_bf16 v[136:139], a[24:27], a[52:55], v[136:139]
    v_mfma_f32_16x16x32_bf16 v[140:143], a[24:27], a[56:59], v[140:143]
    v_mfma_f32_16x16x32_bf16 v[156:159], a[0:3], a[56:59], v[156:159]
    ds_read_b64_tr_b16 a[20:21], v19 offset:50304
    v_mfma_f32_16x16x32_bf16 v[152:155], a[0:3], a[52:55], v[152:155]
    ds_read_b64_tr_b16 a[22:23], v19 offset:53376
    v_mfma_f32_16x16x32_bf16 v[148:151], a[0:3], a[48:51], v[148:151]
    s_add_u32 s36, s36, 229376
    v_mfma_f32_16x16x32_bf16 v[144:147], a[0:3], a[44:47], v[144:147]
    s_waitcnt lgkmcnt(6)
    v_mfma_f32_16x16x32_bf16 v[160:163], a[4:7], a[44:47], v[160:163]
    ds_read_b64_tr_b16 a[24:25], v20 offset:56320
    v_mfma_f32_16x16x32_bf16 v[164:167], a[4:7], a[48:51], v[164:167]
    ds_read_b64_tr_b16 a[26:27], v20 offset:56832
    v_mfma_f32_16x16x32_bf16 v[168:171], a[4:7], a[52:55], v[168:171]
    v_mfma_f32_16x16x32_bf16 v[172:175], a[4:7], a[56:59], v[172:175]
    v_mfma_f32_16x16x32_bf16 v[188:191], a[8:11], a[56:59], v[188:191]
    v_mfma_f32_16x16x32_bf16 v[184:187], a[8:11], a[52:55], v[184:187]
    v_mfma_f32_16x16x32_bf16 v[180:183], a[8:11], a[48:51], v[180:183]
    v_mfma_f32_16x16x32_bf16 v[176:179], a[8:11], a[44:47], v[176:179]
    s_waitcnt vmcnt(17) lgkmcnt(0)
    s_barrier
    ds_read_b128 a[28:31], v16 offset:0
    v_mfma_f32_16x16x32_bf16 v[192:195], a[12:15], a[44:47], v[192:195]
    ds_read_b64_tr_b16 a[0:1], v18 offset:0
    v_mfma_f32_16x16x32_bf16 v[196:199], a[12:15], a[48:51], v[196:199]
    ds_read_b64_tr_b16 a[2:3], v18 offset:3072
    v_mfma_f32_16x16x32_bf16 v[200:203], a[12:15], a[52:55], v[200:203]
    ds_read_b128 a[32:35], v16 offset:2048
    v_mfma_f32_16x16x32_bf16 v[204:207], a[12:15], a[56:59], v[204:207]
    ds_read_b128 a[36:39], v16 offset:4096
    v_mfma_f32_16x16x32_bf16 v[220:223], a[16:19], a[56:59], v[220:223]
    ds_read_b128 a[40:43], v16 offset:6144
    v_mfma_f32_16x16x32_bf16 v[216:219], a[16:19], a[52:55], v[216:219]
    ds_read_b64_tr_b16 a[4:5], v19 offset:0
    v_mfma_f32_16x16x32_bf16 v[212:215], a[16:19], a[48:51], v[212:215]
    ds_read_b64_tr_b16 a[6:7], v19 offset:3072
    v_mfma_f32_16x16x32_bf16 v[208:211], a[16:19], a[44:47], v[208:211]
    ds_read_b64_tr_b16 a[8:9], v18 offset:64
    v_mfma_f32_16x16x32_bf16 a[160:163], a[20:23], a[44:47], a[160:163]
    ds_read_b64_tr_b16 a[10:11], v18 offset:3136
    v_mfma_f32_16x16x32_bf16 a[164:167], a[20:23], a[48:51], a[164:167]
    ds_read_b64_tr_b16 a[12:13], v19 offset:64
    v_mfma_f32_16x16x32_bf16 a[168:171], a[20:23], a[52:55], a[168:171]
    ds_read_b64_tr_b16 a[14:15], v19 offset:3136
    s_add_u32 m0, s39, 43008
    v_mfma_f32_16x16x32_bf16 a[172:175], a[20:23], a[56:59], a[172:175]
    buffer_load_dwordx4 v12, s[8:11], s36 offen lds
    v_mfma_f32_16x16x32_bf16 a[188:191], a[24:27], a[56:59], a[188:191]
    ds_read_b64_tr_b16 a[16:17], v18 offset:128
    v_mfma_f32_16x16x32_bf16 a[184:187], a[24:27], a[52:55], a[184:187]
    ds_read_b64_tr_b16 a[18:19], v18 offset:3200
    v_mfma_f32_16x16x32_bf16 a[180:183], a[24:27], a[48:51], a[180:183]
    s_add_u32 m0, s39, 44032
    v_mfma_f32_16x16x32_bf16 a[176:179], a[24:27], a[44:47], a[176:179]
    buffer_load_dwordx4 v13, s[8:11], s36 offen lds
    s_waitcnt lgkmcnt(11)
    v_mfma_f32_16x16x32_bf16 v[32:35], a[0:3], a[28:31], v[32:35]
    ds_read_b64_tr_b16 a[20:21], v19 offset:128
    s_waitcnt lgkmcnt(11)
    v_mfma_f32_16x16x32_bf16 v[36:39], a[0:3], a[32:35], v[36:39]
    ds_read_b64_tr_b16 a[22:23], v19 offset:3200
    s_waitcnt lgkmcnt(11)
    v_mfma_f32_16x16x32_bf16 v[40:43], a[0:3], a[36:39], v[40:43]
    ds_read_b128 a[44:47], v17 offset:0
    s_add_u32 m0, s39, 45056
    s_waitcnt lgkmcnt(11)
    v_mfma_f32_16x16x32_bf16 v[44:47], a[0:3], a[40:43], v[44:47]
    buffer_load_dwordx4 v14, s[8:11], s36 offen lds
    s_waitcnt lgkmcnt(9)
    v_mfma_f32_16x16x32_bf16 v[60:63], a[4:7], a[40:43], v[60:63]
    ds_read_b64_tr_b16 a[24:25], v20 offset:6144
    v_accvgpr_read_b32 v236, a126
    v_mfma_f32_16x16x32_bf16 v[56:59], a[4:7], a[36:39], v[56:59]
    ds_read_b64_tr_b16 a[26:27], v20 offset:6656
    v_lshlrev_b32 v224, 16, v236
    v_mfma_f32_16x16x32_bf16 v[52:55], a[4:7], a[32:35], v[52:55]
    ds_read_b128 a[48:51], v17 offset:2048
    s_add_u32 m0, s40, 43008
    v_mfma_f32_16x16x32_bf16 v[48:51], a[4:7], a[28:31], v[48:51]
    buffer_load_dwordx4 v15, s[8:11], s36 offen lds
    s_waitcnt lgkmcnt(8)
    v_mfma_f32_16x16x32_bf16 v[64:67], a[8:11], a[28:31], v[64:67]
    ds_read_b64_tr_b16 a[0:1], v18 offset:7168
    v_and_b32 v225, 0xffff0000, v236
    v_mfma_f32_16x16x32_bf16 v[68:71], a[8:11], a[32:35], v[68:71]
    ds_read_b64_tr_b16 a[2:3], v18 offset:10240
    buffer_load_dword v22, v21, s[64:67], s41 offen
    v_mfma_f32_16x16x32_bf16 v[72:75], a[8:11], a[36:39], v[72:75]
    ds_read_b128 a[52:55], v17 offset:4096
    s_add_u32 s36, s36, 229376
    s_add_u32 s41, s41, s42
    v_mfma_f32_16x16x32_bf16 v[76:79], a[8:11], a[40:43], v[76:79]
    v_accvgpr_read_b32 v237, a110
    v_lshlrev_b32 v226, 16, v237
    v_mfma_f32_16x16x32_bf16 v[92:95], a[12:15], a[40:43], v[92:95]
    ds_read_b64_tr_b16 a[4:5], v19 offset:7168
    v_and_b32 v227, 0xffff0000, v237
    v_mfma_f32_16x16x32_bf16 v[88:91], a[12:15], a[36:39], v[88:91]
    ds_read_b64_tr_b16 a[6:7], v19 offset:10240
    v_mul_f32 v228, v226, v224
    v_mfma_f32_16x16x32_bf16 v[84:87], a[12:15], a[32:35], v[84:87]
    ds_read_b128 a[56:59], v17 offset:6144
    v_mul_f32 v229, v227, v225
    v_mfma_f32_16x16x32_bf16 v[80:83], a[12:15], a[28:31], v[80:83]
    v_cvt_pk_bf16_f32 v230, v228, v229
    s_waitcnt lgkmcnt(10)
    v_mfma_f32_16x16x32_bf16 v[96:99], a[16:19], a[28:31], v[96:99]
    ds_read_b64_tr_b16 a[8:9], v18 offset:7232
    v_lshlrev_b32 v232, 16, v230
    v_mfma_f32_16x16x32_bf16 v[100:103], a[16:19], a[32:35], v[100:103]
    ds_read_b64_tr_b16 a[10:11], v18 offset:10304
    v_and_b32 v233, 0xffff0000, v230
    v_mfma_f32_16x16x32_bf16 v[104:107], a[16:19], a[36:39], v[104:107]
    v_accvgpr_read_b32 v237, a118
    v_lshlrev_b32 v226, 16, v237
    v_mfma_f32_16x16x32_bf16 v[108:111], a[16:19], a[40:43], v[108:111]
    v_and_b32 v227, 0xffff0000, v237
    v_mul_f32 v228, v226, v224
    v_mfma_f32_16x16x32_bf16 v[124:127], a[20:23], a[40:43], v[124:127]
    ds_read_b64_tr_b16 a[12:13], v19 offset:7232
    v_mul_f32 v229, v227, v225
    v_mfma_f32_16x16x32_bf16 v[120:123], a[20:23], a[36:39], v[120:123]
    ds_read_b64_tr_b16 a[14:15], v19 offset:10304
    s_waitcnt lgkmcnt(4)
    v_mfma_f32_16x16x32_bf16 v[116:119], a[20:23], a[32:35], v[116:119]
    s_add_u32 m0, s38, 0
    v_cvt_pk_bf16_f32 v230, v228, v229
    v_mfma_f32_16x16x32_bf16 v[112:115], a[20:23], a[28:31], v[112:115]
    buffer_load_dwordx4 v4, s[4:7], s35 offen lds
    v_mfma_f32_16x16x32_bf16 v[128:131], a[24:27], a[28:31], v[128:131]
    ds_read_b64_tr_b16 a[16:17], v18 offset:7296
    v_lshlrev_b32 v234, 16, v230
    v_mfma_f32_16x16x32_bf16 v[132:135], a[24:27], a[32:35], v[132:135]
    ds_read_b64_tr_b16 a[18:19], v18 offset:10368
    v_and_b32 v235, 0xffff0000, v230
    v_mfma_f32_16x16x32_bf16 v[136:139], a[24:27], a[36:39], v[136:139]
    s_add_u32 m0, s38, 1024
    v_accvgpr_read_b32 v236, a127
    v_mfma_f32_16x16x32_bf16 v[140:143], a[24:27], a[40:43], v[140:143]
    buffer_load_dwordx4 v5, s[4:7], s35 offen lds
    v_mfma_f32_16x16x32_bf16 v[156:159], a[0:3], a[40:43], v[156:159]
    ds_read_b64_tr_b16 a[20:21], v19 offset:7296
    v_lshlrev_b32 v224, 16, v236
    v_mfma_f32_16x16x32_bf16 v[152:155], a[0:3], a[36:39], v[152:155]
    ds_read_b64_tr_b16 a[22:23], v19 offset:10368
    v_and_b32 v225, 0xffff0000, v236
    v_mfma_f32_16x16x32_bf16 v[148:151], a[0:3], a[32:35], v[148:151]
    s_add_u32 m0, s38, 2048
    v_accvgpr_read_b32 v237, a111
    v_mfma_f32_16x16x32_bf16 v[144:147], a[0:3], a[28:31], v[144:147]
    buffer_load_dwordx4 v6, s[4:7], s35 offen lds
    s_waitcnt lgkmcnt(6)
    v_mfma_f32_16x16x32_bf16 v[160:163], a[4:7], a[28:31], v[160:163]
    ds_read_b64_tr_b16 a[24:25], v20 offset:13312
    v_lshlrev_b32 v226, 16, v237
    v_mfma_f32_16x16x32_bf16 v[164:167], a[4:7], a[32:35], v[164:167]
    ds_read_b64_tr_b16 a[26:27], v20 offset:13824
    v_and_b32 v227, 0xffff0000, v237
    v_mfma_f32_16x16x32_bf16 v[168:171], a[4:7], a[36:39], v[168:171]
    s_add_u32 m0, s38, 3072
    v_mul_f32 v228, v226, v224
    v_mfma_f32_16x16x32_bf16 v[172:175], a[4:7], a[40:43], v[172:175]
    buffer_load_dwordx4 v7, s[4:7], s35 offen lds
    v_mfma_f32_16x16x32_bf16 v[188:191], a[8:11], a[40:43], v[188:191]
    v_mul_f32 v229, v227, v225
    v_cvt_pk_bf16_f32 v230, v228, v229
    v_mfma_f32_16x16x32_bf16 v[184:187], a[8:11], a[36:39], v[184:187]
    v_lshlrev_b32 v228, 16, v230
    v_and_b32 v229, 0xffff0000, v230
    v_mfma_f32_16x16x32_bf16 v[180:183], a[8:11], a[32:35], v[180:183]
    v_add_f32 v232, v232, v228
    v_add_f32 v233, v233, v229
    v_mfma_f32_16x16x32_bf16 v[176:179], a[8:11], a[28:31], v[176:179]
    s_waitcnt vmcnt(22) lgkmcnt(0)
    s_barrier
    v_mfma_f32_16x16x32_bf16 v[192:195], a[12:15], a[28:31], v[192:195]
    ds_read_b64_tr_b16 a[0:1], v18 offset:14336
    v_accvgpr_read_b32 v237, a119
    v_mfma_f32_16x16x32_bf16 v[196:199], a[12:15], a[32:35], v[196:199]
    ds_read_b64_tr_b16 a[2:3], v18 offset:17408
    v_lshlrev_b32 v226, 16, v237
    v_mfma_f32_16x16x32_bf16 v[200:203], a[12:15], a[36:39], v[200:203]
    s_lshl_b32 s44, s32, 12
    s_add_u32 s44, s44, 140288
    v_add_u32 v27, s44, v26
    ds_read_b128 a[64:67], v27 offset:0
    ds_read_b128 a[68:71], v27 offset:1024
    ds_read_b128 a[72:75], v27 offset:2048
    ds_read_b128 a[76:79], v27 offset:3072
    v_lshrrev_b32 v27, 4, v2
    v_lshlrev_b32 v27, 12, v27
    v_and_b32 v23, 15, v2
    v_lshl_add_u32 v27, v23, 4, v27
    v_mfma_f32_16x16x32_bf16 v[204:207], a[12:15], a[40:43], v[204:207]
    v_and_b32 v227, 0xffff0000, v237
    v_mul_f32 v228, v226, v224
    v_mfma_f32_16x16x32_bf16 v[220:223], a[16:19], a[40:43], v[220:223]
    ds_read_b64_tr_b16 a[4:5], v19 offset:14336
    v_mul_f32 v229, v227, v225
    v_mfma_f32_16x16x32_bf16 v[216:219], a[16:19], a[36:39], v[216:219]
    ds_read_b64_tr_b16 a[6:7], v19 offset:17408
    v_cvt_pk_bf16_f32 v230, v228, v229
    v_mfma_f32_16x16x32_bf16 v[212:215], a[16:19], a[32:35], v[212:215]
    ds_read_b64_tr_b16 a[8:9], v18 offset:14400
    v_lshlrev_b32 v228, 16, v230
    v_mfma_f32_16x16x32_bf16 v[208:211], a[16:19], a[28:31], v[208:211]
    ds_read_b64_tr_b16 a[10:11], v18 offset:17472
    v_mfma_f32_16x16x32_bf16 a[160:163], a[20:23], a[28:31], a[160:163]
    ds_read_b64_tr_b16 a[12:13], v19 offset:14400
    v_and_b32 v229, 0xffff0000, v230
    v_mfma_f32_16x16x32_bf16 a[164:167], a[20:23], a[32:35], a[164:167]
    ds_read_b64_tr_b16 a[14:15], v19 offset:17472
    v_add_f32 v234, v234, v228
    v_mfma_f32_16x16x32_bf16 a[168:171], a[20:23], a[36:39], a[168:171]
    s_add_u32 m0, s38, 4096
    v_add_f32 v235, v235, v229
    v_mfma_f32_16x16x32_bf16 a[172:175], a[20:23], a[40:43], a[172:175]
    buffer_load_dwordx4 v8, s[4:7], s35 offen lds
    v_mfma_f32_16x16x32_bf16 a[188:191], a[24:27], a[40:43], a[188:191]
    ds_read_b64_tr_b16 a[16:17], v18 offset:14464
    v_accvgpr_read_b32 v236, a128
    v_mfma_f32_16x16x32_bf16 a[184:187], a[24:27], a[36:39], a[184:187]
    ds_read_b64_tr_b16 a[18:19], v18 offset:17536
    v_lshlrev_b32 v224, 16, v236
    v_mfma_f32_16x16x32_bf16 a[180:183], a[24:27], a[32:35], a[180:183]
    s_add_u32 m0, s38, 5120
    v_and_b32 v225, 0xffff0000, v236
    v_mfma_f32_16x16x32_bf16 a[176:179], a[24:27], a[28:31], a[176:179]
    buffer_load_dwordx4 v9, s[4:7], s35 offen lds
    s_waitcnt lgkmcnt(12)
    v_mfma_f32_16x16x32_bf16 v[32:35], a[0:3], a[44:47], v[32:35]
    ds_read_b64_tr_b16 a[20:21], v19 offset:14464
    v_accvgpr_read_b32 v237, a112
    v_mfma_f32_16x16x32_bf16 v[36:39], a[0:3], a[48:51], v[36:39]
    ds_read_b64_tr_b16 a[22:23], v19 offset:17536
    v_lshlrev_b32 v226, 16, v237
    v_mfma_f32_16x16x32_bf16 v[40:43], a[0:3], a[52:55], v[40:43]
    s_add_u32 m0, s38, 6144
    s_waitcnt lgkmcnt(13)
    buffer_store_dwordx4 a[64:67], v27, s[12:15], s61 offen sc0 sc1
    s_add_u32 s61, s61, 0x4000
    v_mfma_f32_16x16x32_bf16 v[44:47], a[0:3], a[56:59], v[44:47]
    buffer_load_dwordx4 v10, s[4:7], s35 offen lds
    s_waitcnt lgkmcnt(8)
    v_mfma_f32_16x16x32_bf16 v[60:63], a[4:7], a[56:59], v[60:63]
    ds_read_b64_tr_b16 a[24:25], v20 offset:20480
    v_and_b32 v227, 0xffff0000, v237
    v_mfma_f32_16x16x32_bf16 v[56:59], a[4:7], a[52:55], v[56:59]
    ds_read_b64_tr_b16 a[26:27], v20 offset:20992
    v_mul_f32 v228, v226, v224
    v_mfma_f32_16x16x32_bf16 v[52:55], a[4:7], a[48:51], v[52:55]
    s_add_u32 m0, s38, 7168
    buffer_store_dwordx4 a[68:71], v27, s[12:15], s61 offen sc0 sc1
    s_add_u32 s61, s61, 0x4000
    v_mfma_f32_16x16x32_bf16 v[48:51], a[4:7], a[44:47], v[48:51]
    buffer_load_dwordx4 v11, s[4:7], s35 offen lds
    s_waitcnt lgkmcnt(6)
    v_mfma_f32_16x16x32_bf16 v[64:67], a[8:11], a[44:47], v[64:67]
    ds_read_b64_tr_b16 a[0:1], v18 offset:21504
    v_mul_f32 v229, v227, v225
    v_mfma_f32_16x16x32_bf16 v[68:71], a[8:11], a[48:51], v[68:71]
    ds_read_b64_tr_b16 a[2:3], v18 offset:24576
    v_cvt_pk_bf16_f32 v230, v228, v229
    v_mfma_f32_16x16x32_bf16 v[72:75], a[8:11], a[52:55], v[72:75]
    s_add_u32 s35, s35, 128
    s_add_u32 m0, s39, 0
    buffer_store_dwordx4 a[72:75], v27, s[12:15], s61 offen sc0 sc1
    s_add_u32 s61, s61, 0x4000
    v_mfma_f32_16x16x32_bf16 v[76:79], a[8:11], a[56:59], v[76:79]
    buffer_load_dwordx4 v12, s[8:11], s36 offen lds
    v_mfma_f32_16x16x32_bf16 v[92:95], a[12:15], a[56:59], v[92:95]
    ds_read_b64_tr_b16 a[4:5], v19 offset:21504
    v_lshlrev_b32 v228, 16, v230
    v_mfma_f32_16x16x32_bf16 v[88:91], a[12:15], a[52:55], v[88:91]
    ds_read_b64_tr_b16 a[6:7], v19 offset:24576
    v_and_b32 v229, 0xffff0000, v230
    v_mfma_f32_16x16x32_bf16 v[84:87], a[12:15], a[48:51], v[84:87]
    s_add_u32 m0, s39, 1024
    buffer_store_dwordx4 a[76:79], v27, s[12:15], s61 offen sc0 sc1
    s_add_u32 s61, s61, 0x4000
    v_mfma_f32_16x16x32_bf16 v[80:83], a[12:15], a[44:47], v[80:83]
    buffer_load_dwordx4 v13, s[8:11], s36 offen lds
    s_waitcnt lgkmcnt(6)
    v_mfma_f32_16x16x32_bf16 v[96:99], a[16:19], a[44:47], v[96:99]
    ds_read_b64_tr_b16 a[8:9], v18 offset:21568
    v_add_f32 v232, v232, v228
    v_mfma_f32_16x16x32_bf16 v[100:103], a[16:19], a[48:51], v[100:103]
    ds_read_b64_tr_b16 a[10:11], v18 offset:24640
    v_add_f32 v233, v233, v229
    v_mfma_f32_16x16x32_bf16 v[104:107], a[16:19], a[52:55], v[104:107]
    s_add_u32 m0, s39, 2048
    v_accvgpr_read_b32 v237, a120
    v_mfma_f32_16x16x32_bf16 v[108:111], a[16:19], a[56:59], v[108:111]
    buffer_load_dwordx4 v14, s[8:11], s36 offen lds
    v_mfma_f32_16x16x32_bf16 v[124:127], a[20:23], a[56:59], v[124:127]
    ds_read_b64_tr_b16 a[12:13], v19 offset:21568
    v_lshlrev_b32 v226, 16, v237
    v_mfma_f32_16x16x32_bf16 v[120:123], a[20:23], a[52:55], v[120:123]
    ds_read_b64_tr_b16 a[14:15], v19 offset:24640
    v_and_b32 v227, 0xffff0000, v237
    v_mfma_f32_16x16x32_bf16 v[116:119], a[20:23], a[48:51], v[116:119]
    s_add_u32 m0, s40, 0
    v_mul_f32 v228, v226, v224
    v_mfma_f32_16x16x32_bf16 v[112:115], a[20:23], a[44:47], v[112:115]
    buffer_load_dwordx4 v15, s[8:11], s36 offen lds
    s_waitcnt lgkmcnt(6)
    v_mfma_f32_16x16x32_bf16 v[128:131], a[24:27], a[44:47], v[128:131]
    ds_read_b64_tr_b16 a[16:17], v18 offset:21632
    v_mul_f32 v229, v227, v225
    v_mfma_f32_16x16x32_bf16 v[132:135], a[24:27], a[48:51], v[132:135]
    ds_read_b64_tr_b16 a[18:19], v18 offset:24704
    v_cvt_pk_bf16_f32 v230, v228, v229
    v_mfma_f32_16x16x32_bf16 v[136:139], a[24:27], a[52:55], v[136:139]
    v_lshlrev_b32 v228, 16, v230
    v_and_b32 v229, 0xffff0000, v230
    v_mfma_f32_16x16x32_bf16 v[140:143], a[24:27], a[56:59], v[140:143]
    v_add_f32 v234, v234, v228
    v_add_f32 v235, v235, v229
    v_mfma_f32_16x16x32_bf16 v[156:159], a[0:3], a[56:59], v[156:159]
    ds_read_b64_tr_b16 a[20:21], v19 offset:21632
    v_accvgpr_read_b32 v236, a129
    v_mfma_f32_16x16x32_bf16 v[152:155], a[0:3], a[52:55], v[152:155]
    ds_read_b64_tr_b16 a[22:23], v19 offset:24704
    v_lshlrev_b32 v224, 16, v236
    v_mfma_f32_16x16x32_bf16 v[148:151], a[0:3], a[48:51], v[148:151]
    s_add_u32 s36, s36, 229376
    v_and_b32 v225, 0xffff0000, v236
    v_mfma_f32_16x16x32_bf16 v[144:147], a[0:3], a[44:47], v[144:147]
    v_accvgpr_read_b32 v237, a113
    s_waitcnt lgkmcnt(6)
    v_mfma_f32_16x16x32_bf16 v[160:163], a[4:7], a[44:47], v[160:163]
    ds_read_b64_tr_b16 a[24:25], v20 offset:27648
    v_lshlrev_b32 v226, 16, v237
    v_mfma_f32_16x16x32_bf16 v[164:167], a[4:7], a[48:51], v[164:167]
    ds_read_b64_tr_b16 a[26:27], v20 offset:28160
    v_and_b32 v227, 0xffff0000, v237
    v_mfma_f32_16x16x32_bf16 v[168:171], a[4:7], a[52:55], v[168:171]
    v_mul_f32 v228, v226, v224
    v_mul_f32 v229, v227, v225
    v_mfma_f32_16x16x32_bf16 v[172:175], a[4:7], a[56:59], v[172:175]
    v_cvt_pk_bf16_f32 v230, v228, v229
    v_lshlrev_b32 v228, 16, v230
    v_mfma_f32_16x16x32_bf16 v[188:191], a[8:11], a[56:59], v[188:191]
    v_and_b32 v229, 0xffff0000, v230
    v_add_f32 v232, v232, v228
    v_mfma_f32_16x16x32_bf16 v[184:187], a[8:11], a[52:55], v[184:187]
    v_add_f32 v233, v233, v229
    v_accvgpr_read_b32 v237, a121
    v_mfma_f32_16x16x32_bf16 v[180:183], a[8:11], a[48:51], v[180:183]
    v_lshlrev_b32 v226, 16, v237
    v_and_b32 v227, 0xffff0000, v237
    v_mfma_f32_16x16x32_bf16 v[176:179], a[8:11], a[44:47], v[176:179]
    s_waitcnt vmcnt(21) lgkmcnt(0)
    s_barrier
    ds_read_b128 a[28:31], v16 offset:8192
    v_mfma_f32_16x16x32_bf16 v[192:195], a[12:15], a[44:47], v[192:195]
    ds_read_b64_tr_b16 a[0:1], v18 offset:28672
    v_mul_f32 v228, v226, v224
    v_mfma_f32_16x16x32_bf16 v[196:199], a[12:15], a[48:51], v[196:199]
    ds_read_b64_tr_b16 a[2:3], v18 offset:31744
    v_mul_f32 v229, v227, v225
    v_mfma_f32_16x16x32_bf16 v[200:203], a[12:15], a[52:55], v[200:203]
    ds_read_b128 a[32:35], v16 offset:10240
    v_cvt_pk_bf16_f32 v230, v228, v229
    v_mfma_f32_16x16x32_bf16 v[204:207], a[12:15], a[56:59], v[204:207]
    ds_read_b128 a[36:39], v16 offset:12288
    v_lshlrev_b32 v228, 16, v230
    v_mfma_f32_16x16x32_bf16 v[220:223], a[16:19], a[56:59], v[220:223]
    ds_read_b128 a[40:43], v16 offset:14336
    v_and_b32 v229, 0xffff0000, v230
    v_mfma_f32_16x16x32_bf16 v[216:219], a[16:19], a[52:55], v[216:219]
    ds_read_b64_tr_b16 a[4:5], v19 offset:28672
    v_add_f32 v234, v234, v228
    v_mfma_f32_16x16x32_bf16 v[212:215], a[16:19], a[48:51], v[212:215]
    ds_read_b64_tr_b16 a[6:7], v19 offset:31744
    v_add_f32 v235, v235, v229
    v_mfma_f32_16x16x32_bf16 v[208:211], a[16:19], a[44:47], v[208:211]
    ds_read_b64_tr_b16 a[8:9], v18 offset:28736
    v_mfma_f32_16x16x32_bf16 a[160:163], a[20:23], a[44:47], a[160:163]
    ds_read_b64_tr_b16 a[10:11], v18 offset:31808
    v_accvgpr_read_b32 v236, a130
    v_mfma_f32_16x16x32_bf16 a[164:167], a[20:23], a[48:51], a[164:167]
    ds_read_b64_tr_b16 a[12:13], v19 offset:28736
    v_lshlrev_b32 v224, 16, v236
    v_mfma_f32_16x16x32_bf16 a[168:171], a[20:23], a[52:55], a[168:171]
    ds_read_b64_tr_b16 a[14:15], v19 offset:31808
    s_add_u32 m0, s39, 14336
    v_mfma_f32_16x16x32_bf16 a[172:175], a[20:23], a[56:59], a[172:175]
    buffer_load_dwordx4 v12, s[8:11], s36 offen lds
    v_mfma_f32_16x16x32_bf16 a[188:191], a[24:27], a[56:59], a[188:191]
    ds_read_b64_tr_b16 a[16:17], v18 offset:28800
    v_and_b32 v225, 0xffff0000, v236
    v_mfma_f32_16x16x32_bf16 a[184:187], a[24:27], a[52:55], a[184:187]
    ds_read_b64_tr_b16 a[18:19], v18 offset:31872
    v_accvgpr_read_b32 v237, a114
    v_mfma_f32_16x16x32_bf16 a[180:183], a[24:27], a[48:51], a[180:183]
    s_add_u32 m0, s39, 15360
    v_lshlrev_b32 v226, 16, v237
    v_mfma_f32_16x16x32_bf16 a[176:179], a[24:27], a[44:47], a[176:179]
    buffer_load_dwordx4 v13, s[8:11], s36 offen lds
    s_waitcnt lgkmcnt(11)
    v_mfma_f32_16x16x32_bf16 v[32:35], a[0:3], a[28:31], v[32:35]
    ds_read_b64_tr_b16 a[20:21], v19 offset:28800
    v_and_b32 v227, 0xffff0000, v237
    s_waitcnt lgkmcnt(11)
    v_mfma_f32_16x16x32_bf16 v[36:39], a[0:3], a[32:35], v[36:39]
    ds_read_b64_tr_b16 a[22:23], v19 offset:31872
    v_mul_f32 v228, v226, v224
    s_waitcnt lgkmcnt(11)
    v_mfma_f32_16x16x32_bf16 v[40:43], a[0:3], a[36:39], v[40:43]
    ds_read_b128 a[44:47], v17 offset:8192
    s_add_u32 m0, s39, 16384
    s_waitcnt lgkmcnt(11)
    v_mfma_f32_16x16x32_bf16 v[44:47], a[0:3], a[40:43], v[44:47]
    buffer_load_dwordx4 v14, s[8:11], s36 offen lds
    s_waitcnt lgkmcnt(9)
    v_mfma_f32_16x16x32_bf16 v[60:63], a[4:7], a[40:43], v[60:63]
    ds_read_b64_tr_b16 a[24:25], v20 offset:34816
    v_mul_f32 v229, v227, v225
    v_mfma_f32_16x16x32_bf16 v[56:59], a[4:7], a[36:39], v[56:59]
    ds_read_b64_tr_b16 a[26:27], v20 offset:35328
    v_cvt_pk_bf16_f32 v230, v228, v229
    v_mfma_f32_16x16x32_bf16 v[52:55], a[4:7], a[32:35], v[52:55]
    ds_read_b128 a[48:51], v17 offset:10240
    s_add_u32 m0, s40, 14336
    v_mfma_f32_16x16x32_bf16 v[48:51], a[4:7], a[28:31], v[48:51]
    buffer_load_dwordx4 v15, s[8:11], s36 offen lds
    s_waitcnt lgkmcnt(8)
    v_mfma_f32_16x16x32_bf16 v[64:67], a[8:11], a[28:31], v[64:67]
    ds_read_b64_tr_b16 a[0:1], v18 offset:35840
    v_lshlrev_b32 v228, 16, v230
    v_mfma_f32_16x16x32_bf16 v[68:71], a[8:11], a[32:35], v[68:71]
    ds_read_b64_tr_b16 a[2:3], v18 offset:38912
    buffer_load_dword v22, v3, s[4:7], s92 offen
    v_mfma_f32_16x16x32_bf16 v[72:75], a[8:11], a[36:39], v[72:75]
    ds_read_b128 a[52:55], v17 offset:12288
    s_add_u32 s36, s36, 229376
    s_add_u32 s92, s92, 256
    v_mfma_f32_16x16x32_bf16 v[76:79], a[8:11], a[40:43], v[76:79]
    v_and_b32 v229, 0xffff0000, v230
    v_add_f32 v232, v232, v228
    v_mfma_f32_16x16x32_bf16 v[92:95], a[12:15], a[40:43], v[92:95]
    ds_read_b64_tr_b16 a[4:5], v19 offset:35840
    v_add_f32 v233, v233, v229
    v_mfma_f32_16x16x32_bf16 v[88:91], a[12:15], a[36:39], v[88:91]
    ds_read_b64_tr_b16 a[6:7], v19 offset:38912
    v_accvgpr_read_b32 v237, a122
    v_mfma_f32_16x16x32_bf16 v[84:87], a[12:15], a[32:35], v[84:87]
    ds_read_b128 a[56:59], v17 offset:14336
    v_lshlrev_b32 v226, 16, v237
    v_mfma_f32_16x16x32_bf16 v[80:83], a[12:15], a[28:31], v[80:83]
    v_and_b32 v227, 0xffff0000, v237
    s_waitcnt lgkmcnt(10)
    v_mfma_f32_16x16x32_bf16 v[96:99], a[16:19], a[28:31], v[96:99]
    ds_read_b64_tr_b16 a[8:9], v18 offset:35904
    v_mul_f32 v228, v226, v224
    v_mfma_f32_16x16x32_bf16 v[100:103], a[16:19], a[32:35], v[100:103]
    ds_read_b64_tr_b16 a[10:11], v18 offset:38976
    v_mul_f32 v229, v227, v225
    v_mfma_f32_16x16x32_bf16 v[104:107], a[16:19], a[36:39], v[104:107]
    v_cvt_pk_bf16_f32 v230, v228, v229
    v_lshlrev_b32 v228, 16, v230
    v_mfma_f32_16x16x32_bf16 v[108:111], a[16:19], a[40:43], v[108:111]
    v_and_b32 v229, 0xffff0000, v230
    v_add_f32 v234, v234, v228
    v_mfma_f32_16x16x32_bf16 v[124:127], a[20:23], a[40:43], v[124:127]
    ds_read_b64_tr_b16 a[12:13], v19 offset:35904
    v_add_f32 v235, v235, v229
    v_mfma_f32_16x16x32_bf16 v[120:123], a[20:23], a[36:39], v[120:123]
    ds_read_b64_tr_b16 a[14:15], v19 offset:38976
    s_waitcnt lgkmcnt(4)
    v_mfma_f32_16x16x32_bf16 v[116:119], a[20:23], a[32:35], v[116:119]
    s_add_u32 m0, s38, 8192
    v_accvgpr_read_b32 v236, a131
    v_mfma_f32_16x16x32_bf16 v[112:115], a[20:23], a[28:31], v[112:115]
    buffer_load_dwordx4 v4, s[4:7], s35 offen lds
    v_mfma_f32_16x16x32_bf16 v[128:131], a[24:27], a[28:31], v[128:131]
    ds_read_b64_tr_b16 a[16:17], v18 offset:35968
    v_lshlrev_b32 v224, 16, v236
    v_mfma_f32_16x16x32_bf16 v[132:135], a[24:27], a[32:35], v[132:135]
    ds_read_b64_tr_b16 a[18:19], v18 offset:39040
    v_and_b32 v225, 0xffff0000, v236
    v_mfma_f32_16x16x32_bf16 v[136:139], a[24:27], a[36:39], v[136:139]
    s_add_u32 m0, s38, 9216
    v_accvgpr_read_b32 v237, a115
    v_mfma_f32_16x16x32_bf16 v[140:143], a[24:27], a[40:43], v[140:143]
    buffer_load_dwordx4 v5, s[4:7], s35 offen lds
    v_mfma_f32_16x16x32_bf16 v[156:159], a[0:3], a[40:43], v[156:159]
    ds_read_b64_tr_b16 a[20:21], v19 offset:35968
    v_lshlrev_b32 v226, 16, v237
    v_mfma_f32_16x16x32_bf16 v[152:155], a[0:3], a[36:39], v[152:155]
    ds_read_b64_tr_b16 a[22:23], v19 offset:39040
    v_and_b32 v227, 0xffff0000, v237
    v_mfma_f32_16x16x32_bf16 v[148:151], a[0:3], a[32:35], v[148:151]
    s_add_u32 m0, s38, 10240
    v_mul_f32 v228, v226, v224
    v_mfma_f32_16x16x32_bf16 v[144:147], a[0:3], a[28:31], v[144:147]
    buffer_load_dwordx4 v6, s[4:7], s35 offen lds
    s_waitcnt lgkmcnt(6)
    v_mfma_f32_16x16x32_bf16 v[160:163], a[4:7], a[28:31], v[160:163]
    ds_read_b64_tr_b16 a[24:25], v20 offset:41984
    v_mul_f32 v229, v227, v225
    v_mfma_f32_16x16x32_bf16 v[164:167], a[4:7], a[32:35], v[164:167]
    ds_read_b64_tr_b16 a[26:27], v20 offset:42496
    v_cvt_pk_bf16_f32 v230, v228, v229
    v_mfma_f32_16x16x32_bf16 v[168:171], a[4:7], a[36:39], v[168:171]
    s_add_u32 m0, s38, 11264
    v_lshlrev_b32 v228, 16, v230
    v_mfma_f32_16x16x32_bf16 v[172:175], a[4:7], a[40:43], v[172:175]
    buffer_load_dwordx4 v7, s[4:7], s35 offen lds
    v_mfma_f32_16x16x32_bf16 v[188:191], a[8:11], a[40:43], v[188:191]
    v_and_b32 v229, 0xffff0000, v230
    v_add_f32 v232, v232, v228
    v_mfma_f32_16x16x32_bf16 v[184:187], a[8:11], a[36:39], v[184:187]
    v_add_f32 v233, v233, v229
    v_accvgpr_read_b32 v237, a123
    v_mfma_f32_16x16x32_bf16 v[180:183], a[8:11], a[32:35], v[180:183]
    v_lshlrev_b32 v226, 16, v237
    v_and_b32 v227, 0xffff0000, v237
    v_mfma_f32_16x16x32_bf16 v[176:179], a[8:11], a[28:31], v[176:179]
    s_waitcnt vmcnt(26) lgkmcnt(0)
    s_barrier
    v_mfma_f32_16x16x32_bf16 v[192:195], a[12:15], a[28:31], v[192:195]
    ds_read_b64_tr_b16 a[0:1], v18 offset:43008
    v_mul_f32 v228, v226, v224
    v_mfma_f32_16x16x32_bf16 v[196:199], a[12:15], a[32:35], v[196:199]
    ds_read_b64_tr_b16 a[2:3], v18 offset:46080
    v_mul_f32 v229, v227, v225
    v_mfma_f32_16x16x32_bf16 v[200:203], a[12:15], a[36:39], v[200:203]
    v_cvt_pk_bf16_f32 v230, v228, v229
    v_lshlrev_b32 v228, 16, v230
    v_mfma_f32_16x16x32_bf16 v[204:207], a[12:15], a[40:43], v[204:207]
    v_and_b32 v229, 0xffff0000, v230
    v_add_f32 v234, v234, v228
    v_mfma_f32_16x16x32_bf16 v[220:223], a[16:19], a[40:43], v[220:223]
    ds_read_b64_tr_b16 a[4:5], v19 offset:43008
    v_add_f32 v235, v235, v229
    v_mfma_f32_16x16x32_bf16 v[216:219], a[16:19], a[36:39], v[216:219]
    ds_read_b64_tr_b16 a[6:7], v19 offset:46080
    v_accvgpr_read_b32 v236, a132
    v_mfma_f32_16x16x32_bf16 v[212:215], a[16:19], a[32:35], v[212:215]
    ds_read_b64_tr_b16 a[8:9], v18 offset:43072
    v_lshlrev_b32 v224, 16, v236
    v_mfma_f32_16x16x32_bf16 v[208:211], a[16:19], a[28:31], v[208:211]
    ds_read_b64_tr_b16 a[10:11], v18 offset:46144
    v_mfma_f32_16x16x32_bf16 a[160:163], a[20:23], a[28:31], a[160:163]
    ds_read_b64_tr_b16 a[12:13], v19 offset:43072
    v_and_b32 v225, 0xffff0000, v236
    v_mfma_f32_16x16x32_bf16 a[164:167], a[20:23], a[32:35], a[164:167]
    ds_read_b64_tr_b16 a[14:15], v19 offset:46144
    v_accvgpr_read_b32 v237, a116
    v_mfma_f32_16x16x32_bf16 a[168:171], a[20:23], a[36:39], a[168:171]
    s_add_u32 m0, s38, 12288
    v_lshlrev_b32 v226, 16, v237
    v_mfma_f32_16x16x32_bf16 a[172:175], a[20:23], a[40:43], a[172:175]
    buffer_load_dwordx4 v8, s[4:7], s35 offen lds
    v_mfma_f32_16x16x32_bf16 a[188:191], a[24:27], a[40:43], a[188:191]
    ds_read_b64_tr_b16 a[16:17], v18 offset:43136
    v_and_b32 v227, 0xffff0000, v237
    v_mfma_f32_16x16x32_bf16 a[184:187], a[24:27], a[36:39], a[184:187]
    ds_read_b64_tr_b16 a[18:19], v18 offset:46208
    v_mul_f32 v228, v226, v224
    v_mfma_f32_16x16x32_bf16 a[180:183], a[24:27], a[32:35], a[180:183]
    s_add_u32 m0, s38, 13312
    v_mul_f32 v229, v227, v225
    v_mfma_f32_16x16x32_bf16 a[176:179], a[24:27], a[28:31], a[176:179]
    buffer_load_dwordx4 v9, s[4:7], s35 offen lds
    s_waitcnt lgkmcnt(8)
    v_mfma_f32_16x16x32_bf16 v[32:35], a[0:3], a[44:47], v[32:35]
    ds_read_b64_tr_b16 a[20:21], v19 offset:43136
    v_cvt_pk_bf16_f32 v230, v228, v229
    v_mfma_f32_16x16x32_bf16 v[36:39], a[0:3], a[48:51], v[36:39]
    ds_read_b64_tr_b16 a[22:23], v19 offset:46208
    v_lshlrev_b32 v228, 16, v230
    v_mfma_f32_16x16x32_bf16 v[40:43], a[0:3], a[52:55], v[40:43]
    s_add_u32 m0, s38, 14336
    v_and_b32 v229, 0xffff0000, v230
    v_mfma_f32_16x16x32_bf16 v[44:47], a[0:3], a[56:59], v[44:47]
    buffer_load_dwordx4 v10, s[4:7], s35 offen lds
    s_waitcnt lgkmcnt(8)
    v_mfma_f32_16x16x32_bf16 v[60:63], a[4:7], a[56:59], v[60:63]
    ds_read_b64_tr_b16 a[24:25], v20 offset:49152
    v_add_f32 v232, v232, v228
    v_mfma_f32_16x16x32_bf16 v[56:59], a[4:7], a[52:55], v[56:59]
    ds_read_b64_tr_b16 a[26:27], v20 offset:49664
    v_add_f32 v233, v233, v229
    v_mfma_f32_16x16x32_bf16 v[52:55], a[4:7], a[48:51], v[52:55]
    s_add_u32 m0, s38, 15360
    v_accvgpr_read_b32 v237, a124
    v_mfma_f32_16x16x32_bf16 v[48:51], a[4:7], a[44:47], v[48:51]
    buffer_load_dwordx4 v11, s[4:7], s35 offen lds
    s_waitcnt lgkmcnt(6)
    v_mfma_f32_16x16x32_bf16 v[64:67], a[8:11], a[44:47], v[64:67]
    ds_read_b64_tr_b16 a[0:1], v18 offset:50176
    v_lshlrev_b32 v226, 16, v237
    v_mfma_f32_16x16x32_bf16 v[68:71], a[8:11], a[48:51], v[68:71]
    ds_read_b64_tr_b16 a[2:3], v18 offset:53248
    v_and_b32 v227, 0xffff0000, v237
    v_mfma_f32_16x16x32_bf16 v[72:75], a[8:11], a[52:55], v[72:75]
    s_add_u32 s35, s35, 128
    s_add_u32 m0, s39, 28672
    v_mfma_f32_16x16x32_bf16 v[76:79], a[8:11], a[56:59], v[76:79]
    buffer_load_dwordx4 v12, s[8:11], s36 offen lds
    v_mfma_f32_16x16x32_bf16 v[92:95], a[12:15], a[56:59], v[92:95]
    ds_read_b64_tr_b16 a[4:5], v19 offset:50176
    v_mul_f32 v228, v226, v224
    v_mfma_f32_16x16x32_bf16 v[88:91], a[12:15], a[52:55], v[88:91]
    ds_read_b64_tr_b16 a[6:7], v19 offset:53248
    v_mul_f32 v229, v227, v225
    v_mfma_f32_16x16x32_bf16 v[84:87], a[12:15], a[48:51], v[84:87]
    s_add_u32 m0, s39, 29696
    v_cvt_pk_bf16_f32 v230, v228, v229
    v_mfma_f32_16x16x32_bf16 v[80:83], a[12:15], a[44:47], v[80:83]
    buffer_load_dwordx4 v13, s[8:11], s36 offen lds
    s_waitcnt lgkmcnt(6)
    v_mfma_f32_16x16x32_bf16 v[96:99], a[16:19], a[44:47], v[96:99]
    ds_read_b64_tr_b16 a[8:9], v18 offset:50240
    v_lshlrev_b32 v228, 16, v230
    v_mfma_f32_16x16x32_bf16 v[100:103], a[16:19], a[48:51], v[100:103]
    ds_read_b64_tr_b16 a[10:11], v18 offset:53312
    v_and_b32 v229, 0xffff0000, v230
    v_mfma_f32_16x16x32_bf16 v[104:107], a[16:19], a[52:55], v[104:107]
    s_add_u32 m0, s39, 30720
    v_add_f32 v234, v234, v228
    v_mfma_f32_16x16x32_bf16 v[108:111], a[16:19], a[56:59], v[108:111]
    buffer_load_dwordx4 v14, s[8:11], s36 offen lds
    v_mfma_f32_16x16x32_bf16 v[124:127], a[20:23], a[56:59], v[124:127]
    ds_read_b64_tr_b16 a[12:13], v19 offset:50240
    v_add_f32 v235, v235, v229
    v_mfma_f32_16x16x32_bf16 v[120:123], a[20:23], a[52:55], v[120:123]
    ds_read_b64_tr_b16 a[14:15], v19 offset:53312
    v_accvgpr_read_b32 v236, a133
    v_mfma_f32_16x16x32_bf16 v[116:119], a[20:23], a[48:51], v[116:119]
    s_add_u32 m0, s40, 28672
    v_lshlrev_b32 v224, 16, v236
    v_mfma_f32_16x16x32_bf16 v[112:115], a[20:23], a[44:47], v[112:115]
    buffer_load_dwordx4 v15, s[8:11], s36 offen lds
    s_waitcnt lgkmcnt(6)
    v_mfma_f32_16x16x32_bf16 v[128:131], a[24:27], a[44:47], v[128:131]
    ds_read_b64_tr_b16 a[16:17], v18 offset:50304
    v_and_b32 v225, 0xffff0000, v236
    v_mfma_f32_16x16x32_bf16 v[132:135], a[24:27], a[48:51], v[132:135]
    ds_read_b64_tr_b16 a[18:19], v18 offset:53376
    v_accvgpr_read_b32 v237, a117
    v_mfma_f32_16x16x32_bf16 v[136:139], a[24:27], a[52:55], v[136:139]
    v_lshlrev_b32 v226, 16, v237
    v_and_b32 v227, 0xffff0000, v237
    v_mfma_f32_16x16x32_bf16 v[140:143], a[24:27], a[56:59], v[140:143]
    v_mul_f32 v228, v226, v224
    v_mul_f32 v229, v227, v225
    v_mfma_f32_16x16x32_bf16 v[156:159], a[0:3], a[56:59], v[156:159]
    ds_read_b64_tr_b16 a[20:21], v19 offset:50304
    v_cvt_pk_bf16_f32 v230, v228, v229
    v_mfma_f32_16x16x32_bf16 v[152:155], a[0:3], a[52:55], v[152:155]
    ds_read_b64_tr_b16 a[22:23], v19 offset:53376
    v_lshlrev_b32 v228, 16, v230
    v_mfma_f32_16x16x32_bf16 v[148:151], a[0:3], a[48:51], v[148:151]
    s_add_u32 s36, s36, 229376
    v_and_b32 v229, 0xffff0000, v230
    v_mfma_f32_16x16x32_bf16 v[144:147], a[0:3], a[44:47], v[144:147]
    v_add_f32 v232, v232, v228
    s_waitcnt lgkmcnt(6)
    v_mfma_f32_16x16x32_bf16 v[160:163], a[4:7], a[44:47], v[160:163]
    ds_read_b64_tr_b16 a[24:25], v20 offset:56320
    v_add_f32 v233, v233, v229
    v_mfma_f32_16x16x32_bf16 v[164:167], a[4:7], a[48:51], v[164:167]
    ds_read_b64_tr_b16 a[26:27], v20 offset:56832
    v_accvgpr_read_b32 v237, a125
    v_mfma_f32_16x16x32_bf16 v[168:171], a[4:7], a[52:55], v[168:171]
    v_lshlrev_b32 v226, 16, v237
    v_and_b32 v227, 0xffff0000, v237
    v_mfma_f32_16x16x32_bf16 v[172:175], a[4:7], a[56:59], v[172:175]
    v_mul_f32 v228, v226, v224
    v_mul_f32 v229, v227, v225
    v_mfma_f32_16x16x32_bf16 v[188:191], a[8:11], a[56:59], v[188:191]
    v_cvt_pk_bf16_f32 v230, v228, v229
    v_lshlrev_b32 v228, 16, v230
    v_mfma_f32_16x16x32_bf16 v[184:187], a[8:11], a[52:55], v[184:187]
    v_and_b32 v229, 0xffff0000, v230
    v_add_f32 v234, v234, v228
    v_mfma_f32_16x16x32_bf16 v[180:183], a[8:11], a[48:51], v[180:183]
    v_add_f32 v235, v235, v229
    v_add_f32 v232, v232, v233
    v_mfma_f32_16x16x32_bf16 v[176:179], a[8:11], a[44:47], v[176:179]
    s_waitcnt vmcnt(17) lgkmcnt(0)
    s_barrier
    ds_read_b128 a[28:31], v16 offset:0
    v_mfma_f32_16x16x32_bf16 v[192:195], a[12:15], a[44:47], v[192:195]
    ds_read_b64_tr_b16 a[0:1], v18 offset:0
    v_add_f32 v234, v234, v235
    v_mfma_f32_16x16x32_bf16 v[196:199], a[12:15], a[48:51], v[196:199]
    ds_read_b64_tr_b16 a[2:3], v18 offset:3072
    v_add_f32_dpp v232, v232, v232 row_shr:1 row_mask:0xf bank_mask:0xf bound_ctrl:0
    v_mfma_f32_16x16x32_bf16 v[200:203], a[12:15], a[52:55], v[200:203]
    ds_read_b128 a[32:35], v16 offset:2048
    v_add_f32_dpp v234, v234, v234 row_shr:1 row_mask:0xf bank_mask:0xf bound_ctrl:0
    v_mfma_f32_16x16x32_bf16 v[204:207], a[12:15], a[56:59], v[204:207]
    ds_read_b128 a[36:39], v16 offset:4096
    v_add_f32_dpp v232, v232, v232 row_shr:2 row_mask:0xf bank_mask:0xf bound_ctrl:0
    v_mfma_f32_16x16x32_bf16 v[220:223], a[16:19], a[56:59], v[220:223]
    ds_read_b128 a[40:43], v16 offset:6144
    v_add_f32_dpp v234, v234, v234 row_shr:2 row_mask:0xf bank_mask:0xf bound_ctrl:0
    v_mfma_f32_16x16x32_bf16 v[216:219], a[16:19], a[52:55], v[216:219]
    ds_read_b64_tr_b16 a[4:5], v19 offset:0
    v_add_f32_dpp v232, v232, v232 row_shr:4 row_mask:0xf bank_mask:0xf bound_ctrl:0
    v_mfma_f32_16x16x32_bf16 v[212:215], a[16:19], a[48:51], v[212:215]
    ds_read_b64_tr_b16 a[6:7], v19 offset:3072
    v_add_f32_dpp v234, v234, v234 row_shr:4 row_mask:0xf bank_mask:0xf bound_ctrl:0
    v_mfma_f32_16x16x32_bf16 v[208:211], a[16:19], a[44:47], v[208:211]
    ds_read_b64_tr_b16 a[8:9], v18 offset:64
    v_mfma_f32_16x16x32_bf16 a[160:163], a[20:23], a[44:47], a[160:163]
    ds_read_b64_tr_b16 a[10:11], v18 offset:3136
    v_add_f32_dpp v232, v232, v232 row_shr:8 row_mask:0xf bank_mask:0xf bound_ctrl:0
    v_mfma_f32_16x16x32_bf16 a[164:167], a[20:23], a[48:51], a[164:167]
    ds_read_b64_tr_b16 a[12:13], v19 offset:64
    v_add_f32_dpp v234, v234, v234 row_shr:8 row_mask:0xf bank_mask:0xf bound_ctrl:0
    v_mfma_f32_16x16x32_bf16 a[168:171], a[20:23], a[52:55], a[168:171]
    ds_read_b64_tr_b16 a[14:15], v19 offset:3136
    s_add_u32 m0, s39, 43008
    v_mfma_f32_16x16x32_bf16 a[172:175], a[20:23], a[56:59], a[172:175]
    buffer_load_dwordx4 v12, s[8:11], s36 offen lds
    v_mfma_f32_16x16x32_bf16 a[188:191], a[24:27], a[56:59], a[188:191]
    ds_read_b64_tr_b16 a[16:17], v18 offset:128
    v_add_f32_dpp v232, v232, v232 row_bcast:15 row_mask:0xa bank_mask:0xf
    v_mfma_f32_16x16x32_bf16 a[184:187], a[24:27], a[52:55], a[184:187]
    ds_read_b64_tr_b16 a[18:19], v18 offset:3200
    v_add_f32_dpp v234, v234, v234 row_bcast:15 row_mask:0xa bank_mask:0xf
    v_mfma_f32_16x16x32_bf16 a[180:183], a[24:27], a[48:51], a[180:183]
    s_add_u32 m0, s39, 44032
    v_add_f32_dpp v232, v232, v232 row_bcast:31 row_mask:0xc bank_mask:0xf
    v_mfma_f32_16x16x32_bf16 a[176:179], a[24:27], a[44:47], a[176:179]
    buffer_load_dwordx4 v13, s[8:11], s36 offen lds
    s_waitcnt lgkmcnt(11)
    v_mfma_f32_16x16x32_bf16 v[32:35], a[0:3], a[28:31], v[32:35]
    ds_read_b64_tr_b16 a[20:21], v19 offset:128
    v_add_f32_dpp v234, v234, v234 row_bcast:31 row_mask:0xc bank_mask:0xf
    s_waitcnt lgkmcnt(11)
    v_mfma_f32_16x16x32_bf16 v[36:39], a[0:3], a[32:35], v[36:39]
    ds_read_b64_tr_b16 a[22:23], v19 offset:3200
    v_cvt_pk_bf16_f32 v228, v232, v234
    s_waitcnt lgkmcnt(11)
    v_mfma_f32_16x16x32_bf16 v[40:43], a[0:3], a[36:39], v[40:43]
    ds_read_b128 a[44:47], v17 offset:0
    s_add_u32 m0, s39, 45056
    s_waitcnt lgkmcnt(11)
    v_mfma_f32_16x16x32_bf16 v[44:47], a[0:3], a[40:43], v[44:47]
    buffer_load_dwordx4 v14, s[8:11], s36 offen lds
    s_waitcnt lgkmcnt(9)
    v_mfma_f32_16x16x32_bf16 v[60:63], a[4:7], a[40:43], v[60:63]
    ds_read_b64_tr_b16 a[24:25], v20 offset:6144
    v_lshlrev_b32 v232, 16, v228
    v_mfma_f32_16x16x32_bf16 v[56:59], a[4:7], a[36:39], v[56:59]
    ds_read_b64_tr_b16 a[26:27], v20 offset:6656
    v_and_b32 v234, 0xffff0000, v228
    v_mfma_f32_16x16x32_bf16 v[52:55], a[4:7], a[32:35], v[52:55]
    ds_read_b128 a[48:51], v17 offset:2048
    s_add_u32 m0, s40, 43008
    v_mfma_f32_16x16x32_bf16 v[48:51], a[4:7], a[28:31], v[48:51]
    buffer_load_dwordx4 v15, s[8:11], s36 offen lds
    s_waitcnt lgkmcnt(8)
    v_mfma_f32_16x16x32_bf16 v[64:67], a[8:11], a[28:31], v[64:67]
    ds_read_b64_tr_b16 a[0:1], v18 offset:7168
    v_mul_f32 v232, 0xbfb8aa3b, v232
    v_mfma_f32_16x16x32_bf16 v[68:71], a[8:11], a[32:35], v[68:71]
    ds_read_b64_tr_b16 a[2:3], v18 offset:10240
    v_lshrrev_b32 v25, 3, v2
    v_lshlrev_b32 v25, 11, v25
    v_and_b32 v27, 7, v2
    v_lshl_add_u32 v25, v27, 4, v25
    s_lshl_b32 s45, s32, 12
    s_add_u32 s45, s45, 140288
    s_add_u32 m0, s45, 0
    s_add_u32 s46, s48, 0
    buffer_load_dwordx4 v25, s[4:7], s46 offen lds
    s_add_u32 m0, s45, 1024
    s_add_u32 s46, s48, 16384
    buffer_load_dwordx4 v25, s[4:7], s46 offen lds
    s_add_u32 m0, s45, 2048
    s_add_u32 s46, s48, 32768
    buffer_load_dwordx4 v25, s[4:7], s46 offen lds
    s_add_u32 m0, s45, 3072
    s_add_u32 s46, s48, 49152
    buffer_load_dwordx4 v25, s[4:7], s46 offen lds
    global_load_dword v22, v28, s[94:95]
    v_mfma_f32_16x16x32_bf16 v[72:75], a[8:11], a[36:39], v[72:75]
    ds_read_b128 a[52:55], v17 offset:4096
    s_add_u32 s36, s36, 229376
    v_mfma_f32_16x16x32_bf16 v[76:79], a[8:11], a[40:43], v[76:79]
    v_mul_f32 v234, 0xbfb8aa3b, v234
    v_exp_f32 v232, v232
    v_mfma_f32_16x16x32_bf16 v[92:95], a[12:15], a[40:43], v[92:95]
    ds_read_b64_tr_b16 a[4:5], v19 offset:7168
    v_exp_f32 v234, v234
    v_mfma_f32_16x16x32_bf16 v[88:91], a[12:15], a[36:39], v[88:91]
    ds_read_b64_tr_b16 a[6:7], v19 offset:10240
    v_add_f32 v232, 1.0, v232
    v_mfma_f32_16x16x32_bf16 v[84:87], a[12:15], a[32:35], v[84:87]
    ds_read_b128 a[56:59], v17 offset:6144
    v_add_f32 v234, 1.0, v234
    v_mfma_f32_16x16x32_bf16 v[80:83], a[12:15], a[28:31], v[80:83]
    v_rcp_f32 v232, v232
    s_waitcnt lgkmcnt(10)
    v_mfma_f32_16x16x32_bf16 v[96:99], a[16:19], a[28:31], v[96:99]
    ds_read_b64_tr_b16 a[8:9], v18 offset:7232
    v_rcp_f32 v234, v234
    v_mfma_f32_16x16x32_bf16 v[100:103], a[16:19], a[32:35], v[100:103]
    ds_read_b64_tr_b16 a[10:11], v18 offset:10304
    v_cvt_pk_bf16_f32 v228, v232, v234
    v_mfma_f32_16x16x32_bf16 v[104:107], a[16:19], a[36:39], v[104:107]
    v_lshlrev_b32 v240, 16, v228
    v_and_b32 v242, 0xffff0000, v228
    v_mfma_f32_16x16x32_bf16 v[108:111], a[16:19], a[40:43], v[108:111]
    v_sub_f32 v232, 1.0, v240
    v_sub_f32 v234, 1.0, v242
    v_mfma_f32_16x16x32_bf16 v[124:127], a[20:23], a[40:43], v[124:127]
    ds_read_b64_tr_b16 a[12:13], v19 offset:7232
    v_cvt_pk_bf16_f32 v228, v232, v234
    v_mfma_f32_16x16x32_bf16 v[120:123], a[20:23], a[36:39], v[120:123]
    ds_read_b64_tr_b16 a[14:15], v19 offset:10304
    s_waitcnt lgkmcnt(4)
    v_mfma_f32_16x16x32_bf16 v[116:119], a[20:23], a[32:35], v[116:119]
    s_add_u32 m0, s38, 0
    v_lshlrev_b32 v241, 16, v228
    v_mfma_f32_16x16x32_bf16 v[112:115], a[20:23], a[28:31], v[112:115]
    buffer_load_dwordx4 v4, s[4:7], s35 offen lds
    v_mfma_f32_16x16x32_bf16 v[128:131], a[24:27], a[28:31], v[128:131]
    ds_read_b64_tr_b16 a[16:17], v18 offset:7296
    v_and_b32 v243, 0xffff0000, v228
    v_mfma_f32_16x16x32_bf16 v[132:135], a[24:27], a[32:35], v[132:135]
    ds_read_b64_tr_b16 a[18:19], v18 offset:10368
    s_lshl_b32 s96, s43, 6
    v_mfma_f32_16x16x32_bf16 v[136:139], a[24:27], a[36:39], v[136:139]
    s_add_u32 m0, s38, 1024
    s_add_u32 s96, s96, 0x1800000
    v_mfma_f32_16x16x32_bf16 v[140:143], a[24:27], a[40:43], v[140:143]
    buffer_load_dwordx4 v5, s[4:7], s35 offen lds
    v_mfma_f32_16x16x32_bf16 v[156:159], a[0:3], a[40:43], v[156:159]
    ds_read_b64_tr_b16 a[20:21], v19 offset:7296
    v_mov_b32 v228, 0
    v_mfma_f32_16x16x32_bf16 v[152:155], a[0:3], a[36:39], v[152:155]
    ds_read_b64_tr_b16 a[22:23], v19 offset:10368
    s_mov_b32 exec_lo, 0
    s_mov_b32 exec_hi, 0x80000000
    buffer_store_dwordx4 v[240:243], v228, s[12:15], s96 offen sc0 sc1
    s_mov_b64 exec, -1
    v_mfma_f32_16x16x32_bf16 v[148:151], a[0:3], a[32:35], v[148:151]
    s_add_u32 m0, s38, 2048
    v_lshlrev_b32 v250, 7, v2
    v_mfma_f32_16x16x32_bf16 v[144:147], a[0:3], a[28:31], v[144:147]
    buffer_load_dwordx4 v6, s[4:7], s35 offen lds
    s_waitcnt lgkmcnt(6)
    v_mfma_f32_16x16x32_bf16 v[160:163], a[4:7], a[28:31], v[160:163]
    ds_read_b64_tr_b16 a[24:25], v20 offset:13312
    v_and_b32 v224, 0x780, v250
    v_mfma_f32_16x16x32_bf16 v[164:167], a[4:7], a[32:35], v[164:167]
    ds_read_b64_tr_b16 a[26:27], v20 offset:13824
    v_and_b32 v250, 0xf80, v250
    v_mfma_f32_16x16x32_bf16 v[168:171], a[4:7], a[36:39], v[168:171]
    s_add_u32 m0, s38, 3072
    v_lshrrev_b32 v252, 4, v2
    v_mfma_f32_16x16x32_bf16 v[172:175], a[4:7], a[40:43], v[172:175]
    buffer_load_dwordx4 v7, s[4:7], s35 offen lds
    v_mfma_f32_16x16x32_bf16 v[188:191], a[8:11], a[40:43], v[188:191]
    v_bfe_u32 v253, v2, 1, 3
    v_xor_b32 v253, v253, v252
    v_mfma_f32_16x16x32_bf16 v[184:187], a[8:11], a[36:39], v[184:187]
    v_and_b32 v254, 1, v2
    v_lshlrev_b32 v254, 4, v254
    v_mfma_f32_16x16x32_bf16 v[180:183], a[8:11], a[32:35], v[180:183]
    v_lshl_add_u32 v253, v253, 5, v254
    v_lshl_add_u32 v253, v252, 11, v253
    v_mfma_f32_16x16x32_bf16 v[176:179], a[8:11], a[28:31], v[176:179]
    s_waitcnt vmcnt(27) lgkmcnt(0)
    s_barrier
    v_mfma_f32_16x16x32_bf16 v[192:195], a[12:15], a[28:31], v[192:195]
    ds_read_b64_tr_b16 a[0:1], v18 offset:14336
    s_lshl_b32 s96, s59, 8
    v_mfma_f32_16x16x32_bf16 v[196:199], a[12:15], a[32:35], v[196:199]
    ds_read_b64_tr_b16 a[2:3], v18 offset:17408
    v_add_u32 v226, s96, v253
    v_mfma_f32_16x16x32_bf16 v[200:203], a[12:15], a[36:39], v[200:203]
    s_cmp_eq_u32 s60, 0
    s_cbranch_scc1 L_tok_spin
L_tok_ok:
    s_and_b32 s44, s2, 15
    s_lshl_b32 s44, s44, 2
    s_add_u32 s44, s44, s32
    s_lshl_b32 s44, s44, 4
    s_lshr_b32 s45, s2, 4
    s_add_u32 s44, s44, s45
    s_lshl_b32 s44, s44, 7
    s_add_u32 s44, s44, 0x1840000
    v_mov_b32 v23, s60
    v_mov_b32 v24, 0
    s_mov_b64 exec, 1
    buffer_store_dword v23, v24, s[12:15], s44 offen sc0 sc1
    s_mov_b64 exec, -1
    v_mfma_f32_16x16x32_bf16 v[204:207], a[12:15], a[40:43], v[204:207]
    v_xor_b32 v227, 0x80, v226
    v_add_u32 v227, 0x2000, v227
    v_mfma_f32_16x16x32_bf16 v[220:223], a[16:19], a[40:43], v[220:223]
    ds_read_b64_tr_b16 a[4:5], v19 offset:14336
    v_lshrrev_b32 v252, 3, v2
    v_mfma_f32_16x16x32_bf16 v[216:219], a[16:19], a[36:39], v[216:219]
    ds_read_b64_tr_b16 a[6:7], v19 offset:17408
    v_bfe_u32 v253, v2, 4, 2
    v_mfma_f32_16x16x32_bf16 v[212:215], a[16:19], a[32:35], v[212:215]
    ds_read_b64_tr_b16 a[8:9], v18 offset:14400
    v_bfe_u32 v255, v2, 1, 2
    v_mfma_f32_16x16x32_bf16 v[208:211], a[16:19], a[28:31], v[208:211]
    ds_read_b64_tr_b16 a[10:11], v18 offset:17472
    v_mfma_f32_16x16x32_bf16 a[160:163], a[20:23], a[28:31], a[160:163]
    ds_read_b64_tr_b16 a[12:13], v19 offset:14400
    v_xor_b32 v253, v253, v255
    v_mfma_f32_16x16x32_bf16 a[164:167], a[20:23], a[32:35], a[164:167]
    ds_read_b64_tr_b16 a[14:15], v19 offset:17472
    v_lshl_add_u32 v253, v253, 5, v254
    v_mfma_f32_16x16x32_bf16 a[168:171], a[20:23], a[36:39], a[168:171]
    s_add_u32 m0, s38, 4096
    v_lshl_add_u32 v225, v252, 11, v253
    v_mfma_f32_16x16x32_bf16 a[172:175], a[20:23], a[40:43], a[172:175]
    buffer_load_dwordx4 v8, s[4:7], s35 offen lds
    v_mfma_f32_16x16x32_bf16 a[188:191], a[24:27], a[40:43], a[188:191]
    ds_read_b64_tr_b16 a[16:17], v18 offset:14464
    s_lshl_b32 s96, s57, 7
    v_mfma_f32_16x16x32_bf16 a[184:187], a[24:27], a[36:39], a[184:187]
    ds_read_b64_tr_b16 a[18:19], v18 offset:17536
    v_add_u32 v225, s96, v225
    v_mfma_f32_16x16x32_bf16 a[180:183], a[24:27], a[32:35], a[180:183]
    s_add_u32 m0, s38, 5120
    v_lshrrev_b32 v252, 2, v2
    v_mfma_f32_16x16x32_bf16 a[176:179], a[24:27], a[28:31], a[176:179]
    buffer_load_dwordx4 v9, s[4:7], s35 offen lds
    s_waitcnt lgkmcnt(8)
    v_mfma_f32_16x16x32_bf16 v[32:35], a[0:3], a[44:47], v[32:35]
    ds_read_b64_tr_b16 a[20:21], v19 offset:14464
    v_and_b32 v254, 3, v2
    v_mfma_f32_16x16x32_bf16 v[36:39], a[0:3], a[48:51], v[36:39]
    ds_read_b64_tr_b16 a[22:23], v19 offset:17536
    v_lshlrev_b32 v254, 3, v254
    v_mfma_f32_16x16x32_bf16 v[40:43], a[0:3], a[52:55], v[40:43]
    s_add_u32 m0, s38, 6144
    v_add_u32 v255, 65536, v254
    v_mfma_f32_16x16x32_bf16 v[44:47], a[0:3], a[56:59], v[44:47]
    buffer_load_dwordx4 v10, s[4:7], s35 offen lds
    s_waitcnt lgkmcnt(8)
    v_mfma_f32_16x16x32_bf16 v[60:63], a[4:7], a[56:59], v[60:63]
    ds_read_b64_tr_b16 a[24:25], v20 offset:20480
    v_lshl_add_u32 v253, v252, 8, v255
    v_mfma_f32_16x16x32_bf16 v[56:59], a[4:7], a[52:55], v[56:59]
    ds_read_b64_tr_b16 a[26:27], v20 offset:20992
    v_and_b32 v240, 7, v252
    v_mfma_f32_16x16x32_bf16 v[52:55], a[4:7], a[48:51], v[52:55]
    s_add_u32 m0, s38, 7168
    s_lshl_b32 s96, s58, 2
    v_mfma_f32_16x16x32_bf16 v[48:51], a[4:7], a[44:47], v[48:51]
    buffer_load_dwordx4 v11, s[4:7], s35 offen lds
    s_waitcnt lgkmcnt(6)
    v_mfma_f32_16x16x32_bf16 v[64:67], a[8:11], a[44:47], v[64:67]
    ds_read_b64_tr_b16 a[0:1], v18 offset:21504
    v_xor_b32 v240, s96, v240
    v_mfma_f32_16x16x32_bf16 v[68:71], a[8:11], a[48:51], v[68:71]
    ds_read_b64_tr_b16 a[2:3], v18 offset:24576
    v_xor_b32 v228, 0, v240
    v_mfma_f32_16x16x32_bf16 v[72:75], a[8:11], a[52:55], v[72:75]
    s_add_u32 s35, s35, 128
    s_add_u32 m0, s39, 0
    v_mfma_f32_16x16x32_bf16 v[76:79], a[8:11], a[56:59], v[76:79]
    buffer_load_dwordx4 v12, s[8:11], s36 offen lds
    v_mfma_f32_16x16x32_bf16 v[92:95], a[12:15], a[56:59], v[92:95]
    ds_read_b64_tr_b16 a[4:5], v19 offset:21504
    v_lshl_add_u32 v228, v228, 5, v253
    v_mfma_f32_16x16x32_bf16 v[88:91], a[12:15], a[52:55], v[88:91]
    ds_read_b64_tr_b16 a[6:7], v19 offset:24576
    v_xor_b32 v229, 1, v240
    v_mfma_f32_16x16x32_bf16 v[84:87], a[12:15], a[48:51], v[84:87]
    s_add_u32 m0, s39, 1024
    v_lshl_add_u32 v229, v229, 5, v253
    v_mfma_f32_16x16x32_bf16 v[80:83], a[12:15], a[44:47], v[80:83]
    buffer_load_dwordx4 v13, s[8:11], s36 offen lds
    s_waitcnt lgkmcnt(6)
    v_mfma_f32_16x16x32_bf16 v[96:99], a[16:19], a[44:47], v[96:99]
    ds_read_b64_tr_b16 a[8:9], v18 offset:21568
    v_xor_b32 v230, 2, v240
    v_mfma_f32_16x16x32_bf16 v[100:103], a[16:19], a[48:51], v[100:103]
    ds_read_b64_tr_b16 a[10:11], v18 offset:24640
    v_lshl_add_u32 v230, v230, 5, v253
    v_mfma_f32_16x16x32_bf16 v[104:107], a[16:19], a[52:55], v[104:107]
    s_add_u32 m0, s39, 2048
    v_xor_b32 v231, 3, v240
    v_mfma_f32_16x16x32_bf16 v[108:111], a[16:19], a[56:59], v[108:111]
    buffer_load_dwordx4 v14, s[8:11], s36 offen lds
    v_mfma_f32_16x16x32_bf16 v[124:127], a[20:23], a[56:59], v[124:127]
    ds_read_b64_tr_b16 a[12:13], v19 offset:21568
    v_lshl_add_u32 v231, v231, 5, v253
    v_mfma_f32_16x16x32_bf16 v[120:123], a[20:23], a[52:55], v[120:123]
    ds_read_b64_tr_b16 a[14:15], v19 offset:24640
    v_xor_b32 v232, 4, v240
    v_mfma_f32_16x16x32_bf16 v[116:119], a[20:23], a[48:51], v[116:119]
    s_add_u32 m0, s40, 0
    v_lshl_add_u32 v232, v232, 5, v253
    v_mfma_f32_16x16x32_bf16 v[112:115], a[20:23], a[44:47], v[112:115]
    buffer_load_dwordx4 v15, s[8:11], s36 offen lds
    s_waitcnt lgkmcnt(6)
    v_mfma_f32_16x16x32_bf16 v[128:131], a[24:27], a[44:47], v[128:131]
    ds_read_b64_tr_b16 a[16:17], v18 offset:21632
    v_xor_b32 v233, 5, v240
    v_mfma_f32_16x16x32_bf16 v[132:135], a[24:27], a[48:51], v[132:135]
    ds_read_b64_tr_b16 a[18:19], v18 offset:24704
    v_lshl_add_u32 v233, v233, 5, v253
    v_mfma_f32_16x16x32_bf16 v[136:139], a[24:27], a[52:55], v[136:139]
    v_xor_b32 v234, 6, v240
    v_lshl_add_u32 v234, v234, 5, v253
    v_mfma_f32_16x16x32_bf16 v[140:143], a[24:27], a[56:59], v[140:143]
    v_xor_b32 v235, 7, v240
    v_lshl_add_u32 v235, v235, 5, v253
    v_mfma_f32_16x16x32_bf16 v[156:159], a[0:3], a[56:59], v[156:159]
    ds_read_b64_tr_b16 a[20:21], v19 offset:21632
    v_lshl_add_u32 v253, v252, 7, v255
    v_mfma_f32_16x16x32_bf16 v[152:155], a[0:3], a[52:55], v[152:155]
    ds_read_b64_tr_b16 a[22:23], v19 offset:24704
    v_bfe_u32 v240, v2, 3, 2
    v_mfma_f32_16x16x32_bf16 v[148:151], a[0:3], a[48:51], v[148:151]
    s_add_u32 s36, s36, 229376
    v_xor_b32 v236, 0, v240
    v_mfma_f32_16x16x32_bf16 v[144:147], a[0:3], a[44:47], v[144:147]
    v_lshl_add_u32 v236, v236, 5, v253
    s_waitcnt lgkmcnt(6)
    v_mfma_f32_16x16x32_bf16 v[160:163], a[4:7], a[44:47], v[160:163]
    ds_read_b64_tr_b16 a[24:25], v20 offset:27648
    v_xor_b32 v237, 1, v240
    v_mfma_f32_16x16x32_bf16 v[164:167], a[4:7], a[48:51], v[164:167]
    ds_read_b64_tr_b16 a[26:27], v20 offset:28160
    v_lshl_add_u32 v237, v237, 5, v253
    v_mfma_f32_16x16x32_bf16 v[168:171], a[4:7], a[52:55], v[168:171]
    v_xor_b32 v238, 2, v240
    v_lshl_add_u32 v238, v238, 5, v253
    v_mfma_f32_16x16x32_bf16 v[172:175], a[4:7], a[56:59], v[172:175]
    v_xor_b32 v239, 3, v240
    v_lshl_add_u32 v239, v239, 5, v253
    v_mfma_f32_16x16x32_bf16 v[188:191], a[8:11], a[56:59], v[188:191]
    v_lshlrev_b32 v241, 12, v252
    v_lshl_add_u32 v241, v254, 1, v241
    v_mfma_f32_16x16x32_bf16 v[184:187], a[8:11], a[52:55], v[184:187]
    s_mul_i32 s96, s32, 4352
    s_add_u32 s96, s96, 122880
    v_mfma_f32_16x16x32_bf16 v[180:183], a[8:11], a[48:51], v[180:183]
    v_lshl_add_u32 v242, v252, 6, v254
    v_add_u32 v242, s96, v242
    v_mfma_f32_16x16x32_bf16 v[176:179], a[8:11], a[44:47], v[176:179]
    s_waitcnt vmcnt(22) lgkmcnt(0)
    s_barrier
    ds_read_b128 a[28:31], v16 offset:8192
    v_mfma_f32_16x16x32_bf16 v[192:195], a[12:15], a[44:47], v[192:195]
    ds_read_b64_tr_b16 a[0:1], v18 offset:28672
    v_and_b32 v252, 15, v2
    v_mfma_f32_16x16x32_bf16 v[196:199], a[12:15], a[48:51], v[196:199]
    ds_read_b64_tr_b16 a[2:3], v18 offset:31744
    v_lshrrev_b32 v253, 4, v2
    v_mfma_f32_16x16x32_bf16 v[200:203], a[12:15], a[52:55], v[200:203]
    ds_read_b128 a[32:35], v16 offset:10240
    v_and_b32 v254, 1, v253
    v_mfma_f32_16x16x32_bf16 v[204:207], a[12:15], a[56:59], v[204:207]
    ds_read_b128 a[36:39], v16 offset:12288
    v_lshlrev_b32 v254, 5, v254
    v_mfma_f32_16x16x32_bf16 v[220:223], a[16:19], a[56:59], v[220:223]
    ds_read_b128 a[40:43], v16 offset:14336
    v_lshrrev_b32 v255, 1, v253
    v_mfma_f32_16x16x32_bf16 v[216:219], a[16:19], a[52:55], v[216:219]
    ds_read_b64_tr_b16 a[4:5], v19 offset:28672
    v_lshl_add_u32 v254, v255, 4, v254
    v_mfma_f32_16x16x32_bf16 v[212:215], a[16:19], a[48:51], v[212:215]
    ds_read_b64_tr_b16 a[6:7], v19 offset:31744
    v_lshl_add_u32 v240, v252, 11, v254
    v_mfma_f32_16x16x32_bf16 v[208:211], a[16:19], a[44:47], v[208:211]
    ds_read_b64_tr_b16 a[8:9], v18 offset:28736
    v_mfma_f32_16x16x32_bf16 a[160:163], a[20:23], a[44:47], a[160:163]
    ds_read_b64_tr_b16 a[10:11], v18 offset:31808
    v_lshrrev_b32 v243, 1, v252
    v_mfma_f32_16x16x32_bf16 a[164:167], a[20:23], a[48:51], a[164:167]
    ds_read_b64_tr_b16 a[12:13], v19 offset:28736
    v_lshlrev_b32 v243, 7, v243
    v_mfma_f32_16x16x32_bf16 a[168:171], a[20:23], a[52:55], a[168:171]
    ds_read_b64_tr_b16 a[14:15], v19 offset:31808
    s_add_u32 m0, s39, 14336
    v_mfma_f32_16x16x32_bf16 a[172:175], a[20:23], a[56:59], a[172:175]
    buffer_load_dwordx4 v12, s[8:11], s36 offen lds
    v_mfma_f32_16x16x32_bf16 a[188:191], a[24:27], a[56:59], a[188:191]
    ds_read_b64_tr_b16 a[16:17], v18 offset:28800
    v_and_b32 v255, 1, v252
    v_mfma_f32_16x16x32_bf16 a[184:187], a[24:27], a[52:55], a[184:187]
    ds_read_b64_tr_b16 a[18:19], v18 offset:31872
    v_lshl_add_u32 v243, v255, 3, v243
    v_mfma_f32_16x16x32_bf16 a[180:183], a[24:27], a[48:51], a[180:183]
    s_add_u32 m0, s39, 15360
    v_lshl_add_u32 v254, v253, 3, v252
    v_mfma_f32_16x16x32_bf16 a[176:179], a[24:27], a[44:47], a[176:179]
    buffer_load_dwordx4 v13, s[8:11], s36 offen lds
    s_waitcnt lgkmcnt(11)
    v_mfma_f32_16x16x32_bf16 v[32:35], a[0:3], a[28:31], v[32:35]
    ds_read_b64_tr_b16 a[20:21], v19 offset:28800
    v_add_u32 v244, 1, v254
    s_waitcnt lgkmcnt(11)
    v_mfma_f32_16x16x32_bf16 v[36:39], a[0:3], a[32:35], v[36:39]
    ds_read_b64_tr_b16 a[22:23], v19 offset:31872
    v_and_b32 v255, 3, v244
    s_waitcnt lgkmcnt(11)
    v_mfma_f32_16x16x32_bf16 v[40:43], a[0:3], a[36:39], v[40:43]
    ds_read_b128 a[44:47], v17 offset:8192
    s_add_u32 m0, s39, 16384
    s_waitcnt lgkmcnt(11)
    v_mfma_f32_16x16x32_bf16 v[44:47], a[0:3], a[40:43], v[44:47]
    buffer_load_dwordx4 v14, s[8:11], s36 offen lds
    s_waitcnt lgkmcnt(9)
    v_mfma_f32_16x16x32_bf16 v[60:63], a[4:7], a[40:43], v[60:63]
    ds_read_b64_tr_b16 a[24:25], v20 offset:34816
    v_sub_u32 v244, v244, v255
    v_mfma_f32_16x16x32_bf16 v[56:59], a[4:7], a[36:39], v[56:59]
    ds_read_b64_tr_b16 a[26:27], v20 offset:35328
    v_mul_u32_u24 v245, 4160, v255
    v_mfma_f32_16x16x32_bf16 v[52:55], a[4:7], a[32:35], v[52:55]
    ds_read_b128 a[48:51], v17 offset:10240
    s_add_u32 m0, s40, 14336
    v_mfma_f32_16x16x32_bf16 v[48:51], a[4:7], a[28:31], v[48:51]
    buffer_load_dwordx4 v15, s[8:11], s36 offen lds
    s_waitcnt lgkmcnt(8)
    v_mfma_f32_16x16x32_bf16 v[64:67], a[8:11], a[28:31], v[64:67]
    ds_read_b64_tr_b16 a[0:1], v18 offset:35840
    s_sub_u32 s97, s38, 4096
    v_mfma_f32_16x16x32_bf16 v[68:71], a[8:11], a[32:35], v[68:71]
    ds_read_b64_tr_b16 a[2:3], v18 offset:38912
    v_add_u32 v245, s97, v245
    v_mfma_f32_16x16x32_bf16 v[72:75], a[8:11], a[36:39], v[72:75]
    ds_read_b128 a[52:55], v17 offset:12288
    s_add_u32 s36, s36, 229376
    v_mfma_f32_16x16x32_bf16 v[76:79], a[8:11], a[40:43], v[76:79]
    v_mov_b32 v246, s96
    v_cmp_eq_u32 vcc, 0, v255
    s_nop 1
    v_cndmask_b32 v245, v245, v246, vcc
    v_mfma_f32_16x16x32_bf16 v[92:95], a[12:15], a[40:43], v[92:95]
    ds_read_b64_tr_b16 a[4:5], v19 offset:35840
    v_lshl_add_u32 v244, v244, 1, v245
    v_mfma_f32_16x16x32_bf16 v[88:91], a[12:15], a[36:39], v[88:91]
    ds_read_b64_tr_b16 a[6:7], v19 offset:38912
    v_lshlrev_b32 v245, 5, v252
    v_mfma_f32_16x16x32_bf16 v[84:87], a[12:15], a[32:35], v[84:87]
    ds_read_b128 a[56:59], v17 offset:14336
    v_lshlrev_b32 v255, 4, v253
    v_mfma_f32_16x16x32_bf16 v[80:83], a[12:15], a[28:31], v[80:83]
    v_sub_u32 v245, v255, v245
    s_waitcnt lgkmcnt(10)
    v_mfma_f32_16x16x32_bf16 v[96:99], a[16:19], a[28:31], v[96:99]
    ds_read_b64_tr_b16 a[8:9], v18 offset:35904
    s_mul_i32 s97, s32, 4608
    v_mfma_f32_16x16x32_bf16 v[100:103], a[16:19], a[32:35], v[100:103]
    ds_read_b64_tr_b16 a[10:11], v18 offset:38976
    s_add_u32 s97, s97, 140768
    v_mfma_f32_16x16x32_bf16 v[104:107], a[16:19], a[36:39], v[104:107]
    v_add_u32 v245, s97, v245
    v_mfma_f32_16x16x32_bf16 v[108:111], a[16:19], a[40:43], v[108:111]
    v_sub_u32 v254, 15, v254
    v_and_b32 v255, 1, v254
    v_mfma_f32_16x16x32_bf16 v[124:127], a[20:23], a[40:43], v[124:127]
    ds_read_b64_tr_b16 a[12:13], v19 offset:35904
    v_lshlrev_b32 v255, 4, v255
    v_mfma_f32_16x16x32_bf16 v[120:123], a[20:23], a[36:39], v[120:123]
    ds_read_b64_tr_b16 a[14:15], v19 offset:38976
    s_waitcnt lgkmcnt(4)
    v_mfma_f32_16x16x32_bf16 v[116:119], a[20:23], a[32:35], v[116:119]
    s_add_u32 m0, s38, 8192
    v_accvgpr_read_b32 v246, a80
    v_mfma_f32_16x16x32_bf16 v[112:115], a[20:23], a[28:31], v[112:115]
    buffer_load_dwordx4 v4, s[4:7], s35 offen lds
    v_mfma_f32_16x16x32_bf16 v[128:131], a[24:27], a[28:31], v[128:131]
    ds_read_b64_tr_b16 a[16:17], v18 offset:35968
    v_lshlrev_b32 v255, v255, v246
    v_mfma_f32_16x16x32_bf16 v[132:135], a[24:27], a[32:35], v[132:135]
    ds_read_b64_tr_b16 a[18:19], v18 offset:39040
    v_lshrrev_b32 v254, 1, v254
    v_mfma_f32_16x16x32_bf16 v[136:139], a[24:27], a[36:39], v[136:139]
    s_add_u32 m0, s38, 9216
    v_cmp_eq_u32 vcc, 0, v254
    s_nop 1
    v_cndmask_b32 v246, 0, v255, vcc
    v_mfma_f32_16x16x32_bf16 v[140:143], a[24:27], a[40:43], v[140:143]
    buffer_load_dwordx4 v5, s[4:7], s35 offen lds
    v_mfma_f32_16x16x32_bf16 v[156:159], a[0:3], a[40:43], v[156:159]
    ds_read_b64_tr_b16 a[20:21], v19 offset:35968
    v_cmp_eq_u32 vcc, 1, v254
    s_nop 1
    v_cndmask_b32 v247, 0, v255, vcc
    v_mfma_f32_16x16x32_bf16 v[152:155], a[0:3], a[36:39], v[152:155]
    ds_read_b64_tr_b16 a[22:23], v19 offset:39040
    v_cmp_eq_u32 vcc, 2, v254
    s_nop 1
    v_cndmask_b32 v248, 0, v255, vcc
    v_mfma_f32_16x16x32_bf16 v[148:151], a[0:3], a[32:35], v[148:151]
    s_add_u32 m0, s38, 10240
    v_cmp_eq_u32 vcc, 3, v254
    s_nop 1
    v_cndmask_b32 v249, 0, v255, vcc
    v_mfma_f32_16x16x32_bf16 v[144:147], a[0:3], a[28:31], v[144:147]
    buffer_load_dwordx4 v6, s[4:7], s35 offen lds
    s_waitcnt lgkmcnt(6)
    v_mfma_f32_16x16x32_bf16 v[160:163], a[4:7], a[28:31], v[160:163]
    ds_read_b64_tr_b16 a[24:25], v20 offset:41984
    v_lshlrev_b32 v252, 7, v252
    v_mfma_f32_16x16x32_bf16 v[164:167], a[4:7], a[32:35], v[164:167]
    ds_read_b64_tr_b16 a[26:27], v20 offset:42496
    v_lshl_add_u32 v252, v253, 3, v252
    v_mfma_f32_16x16x32_bf16 v[168:171], a[4:7], a[36:39], v[168:171]
    s_add_u32 m0, s38, 11264
    s_lshl_b32 s96, s32, 12
    v_mfma_f32_16x16x32_bf16 v[172:175], a[4:7], a[40:43], v[172:175]
    buffer_load_dwordx4 v7, s[4:7], s35 offen lds
    v_mfma_f32_16x16x32_bf16 v[188:191], a[8:11], a[40:43], v[188:191]
    s_add_u32 s96, s96, 140288
    v_add_u32 v251, s96, v252
    v_mfma_f32_16x16x32_bf16 v[184:187], a[8:11], a[36:39], v[184:187]
    v_mfma_f32_16x16x32_bf16 v[180:183], a[8:11], a[32:35], v[180:183]
    v_mfma_f32_16x16x32_bf16 v[176:179], a[8:11], a[28:31], v[176:179]
    s_waitcnt vmcnt(26) lgkmcnt(0)
    s_barrier
    v_mfma_f32_16x16x32_bf16 v[192:195], a[12:15], a[28:31], v[192:195]
    ds_read_b64_tr_b16 a[0:1], v18 offset:43008
    v_mfma_f32_16x16x32_bf16 v[196:199], a[12:15], a[32:35], v[196:199]
    ds_read_b64_tr_b16 a[2:3], v18 offset:46080
    v_mfma_f32_16x16x32_bf16 v[200:203], a[12:15], a[36:39], v[200:203]
    v_mfma_f32_16x16x32_bf16 v[204:207], a[12:15], a[40:43], v[204:207]
    v_mfma_f32_16x16x32_bf16 v[220:223], a[16:19], a[40:43], v[220:223]
    ds_read_b64_tr_b16 a[4:5], v19 offset:43008
    v_mfma_f32_16x16x32_bf16 v[216:219], a[16:19], a[36:39], v[216:219]
    ds_read_b64_tr_b16 a[6:7], v19 offset:46080
    v_mfma_f32_16x16x32_bf16 v[212:215], a[16:19], a[32:35], v[212:215]
    ds_read_b64_tr_b16 a[8:9], v18 offset:43072
    v_mfma_f32_16x16x32_bf16 v[208:211], a[16:19], a[28:31], v[208:211]
    ds_read_b64_tr_b16 a[10:11], v18 offset:46144
    v_mfma_f32_16x16x32_bf16 a[160:163], a[20:23], a[28:31], a[160:163]
    ds_read_b64_tr_b16 a[12:13], v19 offset:43072
    v_mfma_f32_16x16x32_bf16 a[164:167], a[20:23], a[32:35], a[164:167]
    ds_read_b64_tr_b16 a[14:15], v19 offset:46144
    v_mfma_f32_16x16x32_bf16 a[168:171], a[20:23], a[36:39], a[168:171]
    s_add_u32 m0, s38, 12288
    v_mfma_f32_16x16x32_bf16 a[172:175], a[20:23], a[40:43], a[172:175]
    buffer_load_dwordx4 v8, s[4:7], s35 offen lds
    v_mfma_f32_16x16x32_bf16 a[188:191], a[24:27], a[40:43], a[188:191]
    ds_read_b64_tr_b16 a[16:17], v18 offset:43136
    v_mfma_f32_16x16x32_bf16 a[184:187], a[24:27], a[36:39], a[184:187]
    ds_read_b64_tr_b16 a[18:19], v18 offset:46208
    v_mfma_f32_16x16x32_bf16 a[180:183], a[24:27], a[32:35], a[180:183]
    s_add_u32 m0, s38, 13312
    v_mfma_f32_16x16x32_bf16 a[176:179], a[24:27], a[28:31], a[176:179]
    buffer_load_dwordx4 v9, s[4:7], s35 offen lds
    s_waitcnt lgkmcnt(8)
    v_mfma_f32_16x16x32_bf16 v[32:35], a[0:3], a[44:47], v[32:35]
    ds_read_b64_tr_b16 a[20:21], v19 offset:43136
    v_mfma_f32_16x16x32_bf16 v[36:39], a[0:3], a[48:51], v[36:39]
    ds_read_b64_tr_b16 a[22:23], v19 offset:46208
    v_mfma_f32_16x16x32_bf16 v[40:43], a[0:3], a[52:55], v[40:43]
    s_add_u32 m0, s38, 14336
    s_waitcnt vmcnt(24)
    v_mfma_f32_16x16x32_bf16 v[44:47], a[0:3], a[56:59], v[44:47]
    buffer_load_dwordx4 v10, s[4:7], s35 offen lds
    s_waitcnt lgkmcnt(8)
    v_mfma_f32_16x16x32_bf16 v[60:63], a[4:7], a[56:59], v[60:63]
    ds_read_b64_tr_b16 a[24:25], v20 offset:49152
    ds_read_b64 a[192:193], v251 offset:0
    v_mfma_f32_16x16x32_bf16 v[56:59], a[4:7], a[52:55], v[56:59]
    ds_read_b64_tr_b16 a[26:27], v20 offset:49664
    ds_read_b64 a[194:195], v251 offset:2048
    v_mfma_f32_16x16x32_bf16 v[52:55], a[4:7], a[48:51], v[52:55]
    s_add_u32 m0, s38, 15360
    ds_read_b64 a[196:197], v251 offset:32
    v_mfma_f32_16x16x32_bf16 v[48:51], a[4:7], a[44:47], v[48:51]
    buffer_load_dwordx4 v11, s[4:7], s35 offen lds
    s_waitcnt lgkmcnt(9)
    v_mfma_f32_16x16x32_bf16 v[64:67], a[8:11], a[44:47], v[64:67]
    ds_read_b64_tr_b16 a[0:1], v18 offset:50176
    ds_read_b64 a[198:199], v251 offset:2080
    v_mfma_f32_16x16x32_bf16 v[68:71], a[8:11], a[48:51], v[68:71]
    ds_read_b64_tr_b16 a[2:3], v18 offset:53248
    ds_read_b64 a[200:201], v251 offset:64
    v_mfma_f32_16x16x32_bf16 v[72:75], a[8:11], a[52:55], v[72:75]
    s_add_u32 s35, s35, 128
    s_add_u32 m0, s39, 28672
    v_mfma_f32_16x16x32_bf16 v[76:79], a[8:11], a[56:59], v[76:79]
    buffer_load_dwordx4 v12, s[8:11], s36 offen lds
    v_mfma_f32_16x16x32_bf16 v[92:95], a[12:15], a[56:59], v[92:95]
    ds_read_b64_tr_b16 a[4:5], v19 offset:50176
    ds_read_b64 a[202:203], v251 offset:2112
    s_waitcnt lgkmcnt(8)
    v_mfma_f32_16x16x32_bf16 v[88:91], a[12:15], a[52:55], v[88:91]
    ds_read_b64_tr_b16 a[6:7], v19 offset:53248
    ds_read_b64 a[204:205], v251 offset:96
    v_mfma_f32_16x16x32_bf16 v[84:87], a[12:15], a[48:51], v[84:87]
    s_add_u32 m0, s39, 29696
    ds_read_b64 a[206:207], v251 offset:2144
    v_mfma_f32_16x16x32_bf16 v[80:83], a[12:15], a[44:47], v[80:83]
    buffer_load_dwordx4 v13, s[8:11], s36 offen lds
    v_mfma_f32_16x16x32_bf16 v[96:99], a[16:19], a[44:47], v[96:99]
    ds_read_b64_tr_b16 a[8:9], v18 offset:50240
    v_mfma_f32_16x16x32_bf16 v[100:103], a[16:19], a[48:51], v[100:103]
    ds_read_b64_tr_b16 a[10:11], v18 offset:53312
    v_mfma_f32_16x16x32_bf16 v[104:107], a[16:19], a[52:55], v[104:107]
    s_add_u32 m0, s39, 30720
    v_mfma_f32_16x16x32_bf16 v[108:111], a[16:19], a[56:59], v[108:111]
    buffer_load_dwordx4 v14, s[8:11], s36 offen lds
    v_mfma_f32_16x16x32_bf16 v[124:127], a[20:23], a[56:59], v[124:127]
    ds_read_b64_tr_b16 a[12:13], v19 offset:50240
    v_mfma_f32_16x16x32_bf16 v[120:123], a[20:23], a[52:55], v[120:123]
    ds_read_b64_tr_b16 a[14:15], v19 offset:53312
    s_waitcnt lgkmcnt(8)
    v_mfma_f32_16x16x32_bf16 v[116:119], a[20:23], a[48:51], v[116:119]
    s_add_u32 m0, s40, 28672
    v_mfma_f32_16x16x32_bf16 v[112:115], a[20:23], a[44:47], v[112:115]
    buffer_load_dwordx4 v15, s[8:11], s36 offen lds
    v_mfma_f32_16x16x32_bf16 v[128:131], a[24:27], a[44:47], v[128:131]
    ds_read_b64_tr_b16 a[16:17], v18 offset:50304
    v_mfma_f32_16x16x32_bf16 v[132:135], a[24:27], a[48:51], v[132:135]
    ds_read_b64_tr_b16 a[18:19], v18 offset:53376
    v_mfma_f32_16x16x32_bf16 v[136:139], a[24:27], a[52:55], v[136:139]
    v_mfma_f32_16x16x32_bf16 v[140:143], a[24:27], a[56:59], v[140:143]
    v_mfma_f32_16x16x32_bf16 v[156:159], a[0:3], a[56:59], v[156:159]
    ds_read_b64_tr_b16 a[20:21], v19 offset:50304
    v_mfma_f32_16x16x32_bf16 v[152:155], a[0:3], a[52:55], v[152:155]
    ds_read_b64_tr_b16 a[22:23], v19 offset:53376
    v_mfma_f32_16x16x32_bf16 v[148:151], a[0:3], a[48:51], v[148:151]
    s_add_u32 s36, s36, 229376
    v_mfma_f32_16x16x32_bf16 v[144:147], a[0:3], a[44:47], v[144:147]
    s_waitcnt lgkmcnt(6)
    v_mfma_f32_16x16x32_bf16 v[160:163], a[4:7], a[44:47], v[160:163]
    ds_read_b64_tr_b16 a[24:25], v20 offset:56320
    v_mfma_f32_16x16x32_bf16 v[164:167], a[4:7], a[48:51], v[164:167]
    ds_read_b64_tr_b16 a[26:27], v20 offset:56832
    v_mfma_f32_16x16x32_bf16 v[168:171], a[4:7], a[52:55], v[168:171]
    v_mfma_f32_16x16x32_bf16 v[172:175], a[4:7], a[56:59], v[172:175]
    v_mfma_f32_16x16x32_bf16 v[188:191], a[8:11], a[56:59], v[188:191]
    v_mfma_f32_16x16x32_bf16 v[184:187], a[8:11], a[52:55], v[184:187]
    v_mfma_f32_16x16x32_bf16 v[180:183], a[8:11], a[48:51], v[180:183]
    v_mfma_f32_16x16x32_bf16 v[176:179], a[8:11], a[44:47], v[176:179]
    s_waitcnt vmcnt(16) lgkmcnt(0)
    s_barrier
    ds_read_b128 a[28:31], v16 offset:0
    v_mfma_f32_16x16x32_bf16 v[192:195], a[12:15], a[44:47], v[192:195]
    ds_read_b64_tr_b16 a[0:1], v18 offset:0
    v_mfma_f32_16x16x32_bf16 v[196:199], a[12:15], a[48:51], v[196:199]
    ds_read_b64_tr_b16 a[2:3], v18 offset:3072
    v_mfma_f32_16x16x32_bf16 v[200:203], a[12:15], a[52:55], v[200:203]
    ds_read_b128 a[32:35], v16 offset:2048
    buffer_load_dword v23, v224, s[12:15], s54 offen sc1
    v_mfma_f32_16x16x32_bf16 v[204:207], a[12:15], a[56:59], v[204:207]
    ds_read_b128 a[36:39], v16 offset:4096
    v_mfma_f32_16x16x32_bf16 v[220:223], a[16:19], a[56:59], v[220:223]
    ds_read_b128 a[40:43], v16 offset:6144
    v_mfma_f32_16x16x32_bf16 v[216:219], a[16:19], a[52:55], v[216:219]
    ds_read_b64_tr_b16 a[4:5], v19 offset:0
    v_mfma_f32_16x16x32_bf16 v[212:215], a[16:19], a[48:51], v[212:215]
    ds_read_b64_tr_b16 a[6:7], v19 offset:3072
    v_mfma_f32_16x16x32_bf16 v[208:211], a[16:19], a[44:47], v[208:211]
    ds_read_b64_tr_b16 a[8:9], v18 offset:64
    v_mfma_f32_16x16x32_bf16 a[160:163], a[20:23], a[44:47], a[160:163]
    ds_read_b64_tr_b16 a[10:11], v18 offset:3136
    v_mfma_f32_16x16x32_bf16 a[164:167], a[20:23], a[48:51], a[164:167]
    ds_read_b64_tr_b16 a[12:13], v19 offset:64
    v_mfma_f32_16x16x32_bf16 a[168:171], a[20:23], a[52:55], a[168:171]
    ds_read_b64_tr_b16 a[14:15], v19 offset:3136
    s_add_u32 m0, s39, 43008
    v_mfma_f32_16x16x32_bf16 a[172:175], a[20:23], a[56:59], a[172:175]
    buffer_load_dwordx4 v12, s[8:11], s36 offen lds
    v_mfma_f32_16x16x32_bf16 a[188:191], a[24:27], a[56:59], a[188:191]
    ds_read_b64_tr_b16 a[16:17], v18 offset:128
    v_mfma_f32_16x16x32_bf16 a[184:187], a[24:27], a[52:55], a[184:187]
    ds_read_b64_tr_b16 a[18:19], v18 offset:3200
    v_mfma_f32_16x16x32_bf16 a[180:183], a[24:27], a[48:51], a[180:183]
    s_add_u32 m0, s39, 44032
    v_mfma_f32_16x16x32_bf16 a[176:179], a[24:27], a[44:47], a[176:179]
    buffer_load_dwordx4 v13, s[8:11], s36 offen lds
    s_waitcnt lgkmcnt(11)
    v_mfma_f32_16x16x32_bf16 v[32:35], a[0:3], a[28:31], v[32:35]
    ds_read_b64_tr_b16 a[20:21], v19 offset:128
    s_waitcnt lgkmcnt(11)
    v_mfma_f32_16x16x32_bf16 v[36:39], a[0:3], a[32:35], v[36:39]
    ds_read_b64_tr_b16 a[22:23], v19 offset:3200
    s_waitcnt lgkmcnt(11)
    v_mfma_f32_16x16x32_bf16 v[40:43], a[0:3], a[36:39], v[40:43]
    ds_read_b128 a[44:47], v17 offset:0
    s_add_u32 m0, s39, 45056
    s_waitcnt lgkmcnt(11)
    v_mfma_f32_16x16x32_bf16 v[44:47], a[0:3], a[40:43], v[44:47]
    buffer_load_dwordx4 v14, s[8:11], s36 offen lds
    s_waitcnt lgkmcnt(9)
    v_mfma_f32_16x16x32_bf16 v[60:63], a[4:7], a[40:43], v[60:63]
    ds_read_b64_tr_b16 a[24:25], v20 offset:6144
    v_mfma_f32_16x16x32_bf16 v[56:59], a[4:7], a[36:39], v[56:59]
    ds_read_b64_tr_b16 a[26:27], v20 offset:6656
    v_mfma_f32_16x16x32_bf16 v[52:55], a[4:7], a[32:35], v[52:55]
    ds_read_b128 a[48:51], v17 offset:2048
    s_add_u32 m0, s40, 43008
    v_mfma_f32_16x16x32_bf16 v[48:51], a[4:7], a[28:31], v[48:51]
    buffer_load_dwordx4 v15, s[8:11], s36 offen lds
    s_waitcnt lgkmcnt(8)
    v_mfma_f32_16x16x32_bf16 v[64:67], a[8:11], a[28:31], v[64:67]
    ds_read_b64_tr_b16 a[0:1], v18 offset:7168
    v_mfma_f32_16x16x32_bf16 v[68:71], a[8:11], a[32:35], v[68:71]
    ds_read_b64_tr_b16 a[2:3], v18 offset:10240
    v_mfma_f32_16x16x32_bf16 v[72:75], a[8:11], a[36:39], v[72:75]
    ds_read_b128 a[52:55], v17 offset:4096
    s_add_u32 s36, s36, 229376
    v_mfma_f32_16x16x32_bf16 v[76:79], a[8:11], a[40:43], v[76:79]
    v_mfma_f32_16x16x32_bf16 v[92:95], a[12:15], a[40:43], v[92:95]
    ds_read_b64_tr_b16 a[4:5], v19 offset:7168
    v_mfma_f32_16x16x32_bf16 v[88:91], a[12:15], a[36:39], v[88:91]
    ds_read_b64_tr_b16 a[6:7], v19 offset:10240
    v_mfma_f32_16x16x32_bf16 v[84:87], a[12:15], a[32:35], v[84:87]
    ds_read_b128 a[56:59], v17 offset:6144
    v_mfma_f32_16x16x32_bf16 v[80:83], a[12:15], a[28:31], v[80:83]
    s_waitcnt lgkmcnt(10)
    v_mfma_f32_16x16x32_bf16 v[96:99], a[16:19], a[28:31], v[96:99]
    ds_read_b64_tr_b16 a[8:9], v18 offset:7232
    v_mfma_f32_16x16x32_bf16 v[100:103], a[16:19], a[32:35], v[100:103]
    ds_read_b64_tr_b16 a[10:11], v18 offset:10304
    v_mfma_f32_16x16x32_bf16 v[104:107], a[16:19], a[36:39], v[104:107]
    v_mfma_f32_16x16x32_bf16 v[108:111], a[16:19], a[40:43], v[108:111]
    v_mfma_f32_16x16x32_bf16 v[124:127], a[20:23], a[40:43], v[124:127]
    ds_read_b64_tr_b16 a[12:13], v19 offset:7232
    v_mfma_f32_16x16x32_bf16 v[120:123], a[20:23], a[36:39], v[120:123]
    ds_read_b64_tr_b16 a[14:15], v19 offset:10304
    s_waitcnt lgkmcnt(4)
    v_mfma_f32_16x16x32_bf16 v[116:119], a[20:23], a[32:35], v[116:119]
    v_mfma_f32_16x16x32_bf16 v[112:115], a[20:23], a[28:31], v[112:115]
    v_mfma_f32_16x16x32_bf16 v[128:131], a[24:27], a[28:31], v[128:131]
    ds_read_b64_tr_b16 a[16:17], v18 offset:7296
    v_mfma_f32_16x16x32_bf16 v[132:135], a[24:27], a[32:35], v[132:135]
    ds_read_b64_tr_b16 a[18:19], v18 offset:10368
    v_mfma_f32_16x16x32_bf16 v[136:139], a[24:27], a[36:39], v[136:139]
    v_mfma_f32_16x16x32_bf16 v[140:143], a[24:27], a[40:43], v[140:143]
    v_mfma_f32_16x16x32_bf16 v[156:159], a[0:3], a[40:43], v[156:159]
    ds_read_b64_tr_b16 a[20:21], v19 offset:7296
    v_mfma_f32_16x16x32_bf16 v[152:155], a[0:3], a[36:39], v[152:155]
    ds_read_b64_tr_b16 a[22:23], v19 offset:10368
    v_mfma_f32_16x16x32_bf16 v[148:151], a[0:3], a[32:35], v[148:151]
    v_mfma_f32_16x16x32_bf16 v[144:147], a[0:3], a[28:31], v[144:147]
    s_waitcnt lgkmcnt(6)
    v_mfma_f32_16x16x32_bf16 v[160:163], a[4:7], a[28:31], v[160:163]
    ds_read_b64_tr_b16 a[24:25], v20 offset:13312
    v_mfma_f32_16x16x32_bf16 v[164:167], a[4:7], a[32:35], v[164:167]
    ds_read_b64_tr_b16 a[26:27], v20 offset:13824
    v_mfma_f32_16x16x32_bf16 v[168:171], a[4:7], a[36:39], v[168:171]
    v_mfma_f32_16x16x32_bf16 v[172:175], a[4:7], a[40:43], v[172:175]
    v_mfma_f32_16x16x32_bf16 v[188:191], a[8:11], a[40:43], v[188:191]
    v_mfma_f32_16x16x32_bf16 v[184:187], a[8:11], a[36:39], v[184:187]
    v_mfma_f32_16x16x32_bf16 v[180:183], a[8:11], a[32:35], v[180:183]
    v_mfma_f32_16x16x32_bf16 v[176:179], a[8:11], a[28:31], v[176:179]
    s_waitcnt vmcnt(17) lgkmcnt(0)
    s_barrier
    v_mfma_f32_16x16x32_bf16 v[192:195], a[12:15], a[28:31], v[192:195]
    ds_read_b64_tr_b16 a[0:1], v18 offset:14336
    v_mfma_f32_16x16x32_bf16 v[196:199], a[12:15], a[32:35], v[196:199]
    ds_read_b64_tr_b16 a[2:3], v18 offset:17408
    v_mfma_f32_16x16x32_bf16 v[200:203], a[12:15], a[36:39], v[200:203]
    s_waitcnt vmcnt(4)
    v_cmp_ne_u32 vcc, s60, v23
    s_cbranch_vccnz L_upoll_spin
L_upoll_ok:
    s_lshl_b32 s44, s31, 12
    s_add_u32 s44, s44, 0x1000000
    buffer_load_dwordx4 a[64:67], v26, s[12:15], s44 offen offset:0 sc1
    buffer_load_dwordx4 a[68:71], v26, s[12:15], s44 offen offset:1024 sc1
    buffer_load_dwordx4 a[72:75], v26, s[12:15], s44 offen offset:2048 sc1
    buffer_load_dwordx4 a[76:79], v26, s[12:15], s44 offen offset:3072 sc1
    v_mfma_f32_16x16x32_bf16 v[204:207], a[12:15], a[40:43], v[204:207]
    v_mfma_f32_16x16x32_bf16 v[220:223], a[16:19], a[40:43], v[220:223]
    ds_read_b64_tr_b16 a[4:5], v19 offset:14336
    v_mfma_f32_16x16x32_bf16 v[216:219], a[16:19], a[36:39], v[216:219]
    ds_read_b64_tr_b16 a[6:7], v19 offset:17408
    v_mfma_f32_16x16x32_bf16 v[212:215], a[16:19], a[32:35], v[212:215]
    ds_read_b64_tr_b16 a[8:9], v18 offset:14400
    v_mov_b32 v28, -1
    v_mov_b32 v29, -1
    v_mov_b32 v30, -1
    v_mov_b32 v31, -1
    s_lshl_b32 s44, s33, 2
    s_add_u32 s44, s44, s32
    s_lshl_b32 s44, s44, 5
    s_add_u32 s44, s44, s34
    s_lshl_b32 s44, s44, 12
    s_add_u32 s44, s44, 0x1a00000
    buffer_store_dwordx4 v[28:31], v26, s[12:15], s44 offen offset:0 sc0 sc1
    buffer_store_dwordx4 v[28:31], v26, s[12:15], s44 offen offset:1024 sc0 sc1
    buffer_store_dwordx4 v[28:31], v26, s[12:15], s44 offen offset:2048 sc0 sc1
    buffer_store_dwordx4 v[28:31], v26, s[12:15], s44 offen offset:3072 sc0 sc1
    v_mfma_f32_16x16x32_bf16 v[208:211], a[16:19], a[28:31], v[208:211]
    ds_read_b64_tr_b16 a[10:11], v18 offset:17472
    v_mfma_f32_16x16x32_bf16 a[160:163], a[20:23], a[28:31], a[160:163]
    ds_read_b64_tr_b16 a[12:13], v19 offset:14400
    v_mfma_f32_16x16x32_bf16 a[164:167], a[20:23], a[32:35], a[164:167]
    ds_read_b64_tr_b16 a[14:15], v19 offset:17472
    v_mfma_f32_16x16x32_bf16 a[168:171], a[20:23], a[36:39], a[168:171]
    v_mfma_f32_16x16x32_bf16 a[172:175], a[20:23], a[40:43], a[172:175]
    v_mfma_f32_16x16x32_bf16 a[188:191], a[24:27], a[40:43], a[188:191]
    ds_read_b64_tr_b16 a[16:17], v18 offset:14464
    v_mfma_f32_16x16x32_bf16 a[184:187], a[24:27], a[36:39], a[184:187]
    ds_read_b64_tr_b16 a[18:19], v18 offset:17536
    v_mfma_f32_16x16x32_bf16 a[180:183], a[24:27], a[32:35], a[180:183]
    v_mfma_f32_16x16x32_bf16 a[176:179], a[24:27], a[28:31], a[176:179]
    s_waitcnt lgkmcnt(8)
    v_mfma_f32_16x16x32_bf16 v[32:35], a[0:3], a[44:47], v[32:35]
    ds_read_b64_tr_b16 a[20:21], v19 offset:14464
    v_mfma_f32_16x16x32_bf16 v[36:39], a[0:3], a[48:51], v[36:39]
    ds_read_b64_tr_b16 a[22:23], v19 offset:17536
    v_mfma_f32_16x16x32_bf16 v[40:43], a[0:3], a[52:55], v[40:43]
    v_mfma_f32_16x16x32_bf16 v[44:47], a[0:3], a[56:59], v[44:47]
    s_waitcnt lgkmcnt(8)
    v_mfma_f32_16x16x32_bf16 v[60:63], a[4:7], a[56:59], v[60:63]
    ds_read_b64_tr_b16 a[24:25], v20 offset:20480
    v_mfma_f32_16x16x32_bf16 v[56:59], a[4:7], a[52:55], v[56:59]
    ds_read_b64_tr_b16 a[26:27], v20 offset:20992
    v_mfma_f32_16x16x32_bf16 v[52:55], a[4:7], a[48:51], v[52:55]
    v_mfma_f32_16x16x32_bf16 v[48:51], a[4:7], a[44:47], v[48:51]
    s_waitcnt lgkmcnt(6)
    v_mfma_f32_16x16x32_bf16 v[64:67], a[8:11], a[44:47], v[64:67]
    ds_read_b64_tr_b16 a[0:1], v18 offset:21504
    v_mfma_f32_16x16x32_bf16 v[68:71], a[8:11], a[48:51], v[68:71]
    ds_read_b64_tr_b16 a[2:3], v18 offset:24576
    v_mfma_f32_16x16x32_bf16 v[72:75], a[8:11], a[52:55], v[72:75]
    v_mfma_f32_16x16x32_bf16 v[76:79], a[8:11], a[56:59], v[76:79]
    v_mfma_f32_16x16x32_bf16 v[92:95], a[12:15], a[56:59], v[92:95]
    ds_read_b64_tr_b16 a[4:5], v19 offset:21504
    v_mfma_f32_16x16x32_bf16 v[88:91], a[12:15], a[52:55], v[88:91]
    ds_read_b64_tr_b16 a[6:7], v19 offset:24576
    v_mfma_f32_16x16x32_bf16 v[84:87], a[12:15], a[48:51], v[84:87]
    v_mfma_f32_16x16x32_bf16 v[80:83], a[12:15], a[44:47], v[80:83]
    s_waitcnt lgkmcnt(6)
    v_mfma_f32_16x16x32_bf16 v[96:99], a[16:19], a[44:47], v[96:99]
    ds_read_b64_tr_b16 a[8:9], v18 offset:21568
    v_mfma_f32_16x16x32_bf16 v[100:103], a[16:19], a[48:51], v[100:103]
    ds_read_b64_tr_b16 a[10:11], v18 offset:24640
    v_mfma_f32_16x16x32_bf16 v[104:107], a[16:19], a[52:55], v[104:107]
    v_mfma_f32_16x16x32_bf16 v[108:111], a[16:19], a[56:59], v[108:111]
    v_mfma_f32_16x16x32_bf16 v[124:127], a[20:23], a[56:59], v[124:127]
    ds_read_b64_tr_b16 a[12:13], v19 offset:21568
    v_mfma_f32_16x16x32_bf16 v[120:123], a[20:23], a[52:55], v[120:123]
    ds_read_b64_tr_b16 a[14:15], v19 offset:24640
    v_mfma_f32_16x16x32_bf16 v[116:119], a[20:23], a[48:51], v[116:119]
    v_mfma_f32_16x16x32_bf16 v[112:115], a[20:23], a[44:47], v[112:115]
    s_waitcnt lgkmcnt(6)
    v_mfma_f32_16x16x32_bf16 v[128:131], a[24:27], a[44:47], v[128:131]
    ds_read_b64_tr_b16 a[16:17], v18 offset:21632
    v_mfma_f32_16x16x32_bf16 v[132:135], a[24:27], a[48:51], v[132:135]
    ds_read_b64_tr_b16 a[18:19], v18 offset:24704
    v_mfma_f32_16x16x32_bf16 v[136:139], a[24:27], a[52:55], v[136:139]
    v_mfma_f32_16x16x32_bf16 v[140:143], a[24:27], a[56:59], v[140:143]
    v_mfma_f32_16x16x32_bf16 v[156:159], a[0:3], a[56:59], v[156:159]
    ds_read_b64_tr_b16 a[20:21], v19 offset:21632
    v_mfma_f32_16x16x32_bf16 v[152:155], a[0:3], a[52:55], v[152:155]
    ds_read_b64_tr_b16 a[22:23], v19 offset:24704
    v_mfma_f32_16x16x32_bf16 v[148:151], a[0:3], a[48:51], v[148:151]
    v_mfma_f32_16x16x32_bf16 v[144:147], a[0:3], a[44:47], v[144:147]
    s_waitcnt lgkmcnt(6)
    v_mfma_f32_16x16x32_bf16 v[160:163], a[4:7], a[44:47], v[160:163]
    ds_read_b64_tr_b16 a[24:25], v20 offset:27648
    v_mfma_f32_16x16x32_bf16 v[164:167], a[4:7], a[48:51], v[164:167]
    ds_read_b64_tr_b16 a[26:27], v20 offset:28160
    v_mfma_f32_16x16x32_bf16 v[168:171], a[4:7], a[52:55], v[168:171]
    v_mfma_f32_16x16x32_bf16 v[172:175], a[4:7], a[56:59], v[172:175]
    v_mfma_f32_16x16x32_bf16 v[188:191], a[8:11], a[56:59], v[188:191]
    v_mfma_f32_16x16x32_bf16 v[184:187], a[8:11], a[52:55], v[184:187]
    v_mfma_f32_16x16x32_bf16 v[180:183], a[8:11], a[48:51], v[180:183]
    v_mfma_f32_16x16x32_bf16 v[176:179], a[8:11], a[44:47], v[176:179]
    s_waitcnt lgkmcnt(0)
    s_barrier
    ds_read_b128 a[28:31], v16 offset:8192
    v_mfma_f32_16x16x32_bf16 v[192:195], a[12:15], a[44:47], v[192:195]
    ds_read_b64_tr_b16 a[0:1], v18 offset:28672
    v_mfma_f32_16x16x32_bf16 v[196:199], a[12:15], a[48:51], v[196:199]
    ds_read_b64_tr_b16 a[2:3], v18 offset:31744
    v_mfma_f32_16x16x32_bf16 v[200:203], a[12:15], a[52:55], v[200:203]
    ds_read_b128 a[32:35], v16 offset:10240
    v_mfma_f32_16x16x32_bf16 v[204:207], a[12:15], a[56:59], v[204:207]
    ds_read_b128 a[36:39], v16 offset:12288
    v_mfma_f32_16x16x32_bf16 v[220:223], a[16:19], a[56:59], v[220:223]
    ds_read_b128 a[40:43], v16 offset:14336
    v_mfma_f32_16x16x32_bf16 v[216:219], a[16:19], a[52:55], v[216:219]
    ds_read_b64_tr_b16 a[4:5], v19 offset:28672
    v_mfma_f32_16x16x32_bf16 v[212:215], a[16:19], a[48:51], v[212:215]
    ds_read_b64_tr_b16 a[6:7], v19 offset:31744
    v_mfma_f32_16x16x32_bf16 v[208:211], a[16:19], a[44:47], v[208:211]
    ds_read_b64_tr_b16 a[8:9], v18 offset:28736
    v_mfma_f32_16x16x32_bf16 a[160:163], a[20:23], a[44:47], a[160:163]
    ds_read_b64_tr_b16 a[10:11], v18 offset:31808
    v_mfma_f32_16x16x32_bf16 a[164:167], a[20:23], a[48:51], a[164:167]
    ds_read_b64_tr_b16 a[12:13], v19 offset:28736
    v_mfma_f32_16x16x32_bf16 a[168:171], a[20:23], a[52:55], a[168:171]
    ds_read_b64_tr_b16 a[14:15], v19 offset:31808
    v_mfma_f32_16x16x32_bf16 a[172:175], a[20:23], a[56:59], a[172:175]
    v_mfma_f32_16x16x32_bf16 a[188:191], a[24:27], a[56:59], a[188:191]
    ds_read_b64_tr_b16 a[16:17], v18 offset:28800
    v_mfma_f32_16x16x32_bf16 a[184:187], a[24:27], a[52:55], a[184:187]
    ds_read_b64_tr_b16 a[18:19], v18 offset:31872
    v_mfma_f32_16x16x32_bf16 a[180:183], a[24:27], a[48:51], a[180:183]
    v_mfma_f32_16x16x32_bf16 a[176:179], a[24:27], a[44:47], a[176:179]
    s_waitcnt lgkmcnt(11)
    v_mfma_f32_16x16x32_bf16 v[32:35], a[0:3], a[28:31], v[32:35]
    ds_read_b64_tr_b16 a[20:21], v19 offset:28800
    s_waitcnt lgkmcnt(11)
    v_mfma_f32_16x16x32_bf16 v[36:39], a[0:3], a[32:35], v[36:39]
    ds_read_b64_tr_b16 a[22:23], v19 offset:31872
    s_waitcnt lgkmcnt(11)
    v_mfma_f32_16x16x32_bf16 v[40:43], a[0:3], a[36:39], v[40:43]
    ds_read_b128 a[44:47], v17 offset:8192
    s_mul_i32 s96, s32, 4608
    s_waitcnt lgkmcnt(11)
    v_mfma_f32_16x16x32_bf16 v[44:47], a[0:3], a[40:43], v[44:47]
    s_add_u32 s96, s96, 140288
    v_add_u32 v4, s96, v26
    s_waitcnt lgkmcnt(9)
    v_mfma_f32_16x16x32_bf16 v[60:63], a[4:7], a[40:43], v[60:63]
    ds_read_b64_tr_b16 a[24:25], v20 offset:34816
    v_and_b32 v5, 0x1f0, v26
    v_mfma_f32_16x16x32_bf16 v[56:59], a[4:7], a[36:39], v[56:59]
    ds_read_b64_tr_b16 a[26:27], v20 offset:35328
    v_add_u32 v5, s96, v5
    v_mfma_f32_16x16x32_bf16 v[52:55], a[4:7], a[32:35], v[52:55]
    ds_read_b128 a[48:51], v17 offset:10240
    s_mul_i32 s96, s32, 4352
    v_mfma_f32_16x16x32_bf16 v[48:51], a[4:7], a[28:31], v[48:51]
    s_add_u32 s96, s96, 122880
    s_waitcnt lgkmcnt(8)
    v_mfma_f32_16x16x32_bf16 v[64:67], a[8:11], a[28:31], v[64:67]
    ds_read_b64_tr_b16 a[0:1], v18 offset:35840
    v_min_u32 v6, 16, v26
    v_mfma_f32_16x16x32_bf16 v[68:71], a[8:11], a[32:35], v[68:71]
    ds_read_b64_tr_b16 a[2:3], v18 offset:38912
    v_add_u32 v6, s96, v6
    v_mfma_f32_16x16x32_bf16 v[72:75], a[8:11], a[36:39], v[72:75]
    ds_read_b128 a[52:55], v17 offset:12288
    v_add_u32 v7, s96, v26
    v_mfma_f32_16x16x32_bf16 v[76:79], a[8:11], a[40:43], v[76:79]
    v_mov_b32 v8, 0
    v_mov_b32 v9, 0
    v_mfma_f32_16x16x32_bf16 v[92:95], a[12:15], a[40:43], v[92:95]
    ds_read_b64_tr_b16 a[4:5], v19 offset:35840
    v_mov_b32 v10, 0
    v_mfma_f32_16x16x32_bf16 v[88:91], a[12:15], a[36:39], v[88:91]
    ds_read_b64_tr_b16 a[6:7], v19 offset:38912
    v_mov_b32 v11, 0
    v_mfma_f32_16x16x32_bf16 v[84:87], a[12:15], a[32:35], v[84:87]
    ds_read_b128 a[56:59], v17 offset:14336
    ds_write_b128 v5, v[8:11] offset:4096
    s_waitcnt lgkmcnt(8)
    v_mfma_f32_16x16x32_bf16 v[80:83], a[12:15], a[28:31], v[80:83]
    ds_write_b128 v6, v[8:11]
    v_mfma_f32_16x16x32_bf16 v[96:99], a[16:19], a[28:31], v[96:99]
    ds_read_b64_tr_b16 a[8:9], v18 offset:35904
    s_waitcnt vmcnt(4)
    v_mfma_f32_16x16x32_bf16 v[100:103], a[16:19], a[32:35], v[100:103]
    ds_read_b64_tr_b16 a[10:11], v18 offset:38976
    ds_write_b128 v4, a[64:67] offset:0
    v_mfma_f32_16x16x32_bf16 v[104:107], a[16:19], a[36:39], v[104:107]
    ds_write_b128 v4, a[68:71] offset:1024
    ds_write_b128 v4, a[72:75] offset:2048
    v_mfma_f32_16x16x32_bf16 v[108:111], a[16:19], a[40:43], v[108:111]
    ds_write_b128 v4, a[76:79] offset:3072
    s_waitcnt lgkmcnt(8)
    v_mfma_f32_16x16x32_bf16 v[124:127], a[20:23], a[40:43], v[124:127]
    ds_read_b64_tr_b16 a[12:13], v19 offset:35904
    v_mfma_f32_16x16x32_bf16 v[120:123], a[20:23], a[36:39], v[120:123]
    ds_read_b64_tr_b16 a[14:15], v19 offset:38976
    v_mfma_f32_16x16x32_bf16 v[116:119], a[20:23], a[32:35], v[116:119]
    v_add_u32 v4, s38, v26
    v_min_u32 v5, 16, v26
    v_mfma_f32_16x16x32_bf16 v[112:115], a[20:23], a[28:31], v[112:115]
    v_add_u32 v5, s38, v5
    v_mfma_f32_16x16x32_bf16 v[128:131], a[24:27], a[28:31], v[128:131]
    ds_read_b64_tr_b16 a[16:17], v18 offset:35968
    ds_read_b128 v[8:11], v7 offset:0
    ds_read_b64 v[12:13], v7 offset:16
    v_mfma_f32_16x16x32_bf16 v[132:135], a[24:27], a[32:35], v[132:135]
    ds_read_b64_tr_b16 a[18:19], v18 offset:39040
    s_nop 0
    v_mfma_f32_16x16x32_bf16 v[136:139], a[24:27], a[36:39], v[136:139]
    s_nop 0
    s_nop 0
    v_mfma_f32_16x16x32_bf16 v[140:143], a[24:27], a[40:43], v[140:143]
    s_nop 0
    s_waitcnt lgkmcnt(1)
    v_mfma_f32_16x16x32_bf16 v[156:159], a[0:3], a[40:43], v[156:159]
    ds_read_b64_tr_b16 a[20:21], v19 offset:35968
    v_alignbit_b32 v28, v9, v8, 16
    v_mfma_f32_16x16x32_bf16 v[152:155], a[0:3], a[36:39], v[152:155]
    ds_read_b64_tr_b16 a[22:23], v19 offset:39040
    v_alignbit_b32 v29, v10, v9, 16
    v_mfma_f32_16x16x32_bf16 v[148:151], a[0:3], a[32:35], v[148:151]
    v_alignbit_b32 v30, v11, v10, 16
    v_alignbit_b32 v31, v12, v11, 16
    v_mfma_f32_16x16x32_bf16 v[144:147], a[0:3], a[28:31], v[144:147]
    v_mov_b32 v22, v9
    v_mfma_f32_16x16x32_bf16 v[160:163], a[4:7], a[28:31], v[160:163]
    ds_read_b64_tr_b16 a[24:25], v20 offset:41984
    v_mov_b32 v23, v10
    v_mfma_f32_16x16x32_bf16 v[164:167], a[4:7], a[32:35], v[164:167]
    ds_read_b64_tr_b16 a[26:27], v20 offset:42496
    v_mov_b32 v24, v11
    v_mfma_f32_16x16x32_bf16 v[168:171], a[4:7], a[36:39], v[168:171]
    v_mov_b32 v25, v12
    v_alignbit_b32 v252, v10, v9, 16
    v_mfma_f32_16x16x32_bf16 v[172:175], a[4:7], a[40:43], v[172:175]
    v_alignbit_b32 v253, v11, v10, 16
    v_alignbit_b32 v254, v12, v11, 16
    v_mfma_f32_16x16x32_bf16 v[188:191], a[8:11], a[40:43], v[188:191]
    v_alignbit_b32 v255, v13, v12, 16
    ds_write_b128 v4, v[28:31] offset:64
    v_mfma_f32_16x16x32_bf16 v[184:187], a[8:11], a[36:39], v[184:187]
    ds_write_b128 v4, v[22:25] offset:4224
    ds_write_b128 v4, v[252:255] offset:8384
    v_mfma_f32_16x16x32_bf16 v[180:183], a[8:11], a[32:35], v[180:183]
    ds_read_b128 v[8:11], v7 offset:1024
    ds_read_b64 v[12:13], v7 offset:1040
    s_nop 0
    v_mfma_f32_16x16x32_bf16 v[176:179], a[8:11], a[28:31], v[176:179]
    s_waitcnt lgkmcnt(0)
    s_barrier
    v_mfma_f32_16x16x32_bf16 v[192:195], a[12:15], a[28:31], v[192:195]
    ds_read_b64_tr_b16 a[0:1], v18 offset:43008
    s_nop 0
    v_mfma_f32_16x16x32_bf16 v[196:199], a[12:15], a[32:35], v[196:199]
    ds_read_b64_tr_b16 a[2:3], v18 offset:46080
    s_nop 0
    v_mfma_f32_16x16x32_bf16 v[200:203], a[12:15], a[36:39], v[200:203]
    s_nop 0
    v_mfma_f32_16x16x32_bf16 v[204:207], a[12:15], a[40:43], v[204:207]
    v_alignbit_b32 v28, v9, v8, 16
    v_alignbit_b32 v29, v10, v9, 16
    v_mfma_f32_16x16x32_bf16 v[220:223], a[16:19], a[40:43], v[220:223]
    ds_read_b64_tr_b16 a[4:5], v19 offset:43008
    v_alignbit_b32 v30, v11, v10, 16
    v_mfma_f32_16x16x32_bf16 v[216:219], a[16:19], a[36:39], v[216:219]
    ds_read_b64_tr_b16 a[6:7], v19 offset:46080
    v_alignbit_b32 v31, v12, v11, 16
    v_mfma_f32_16x16x32_bf16 v[212:215], a[16:19], a[32:35], v[212:215]
    ds_read_b64_tr_b16 a[8:9], v18 offset:43072
    v_mov_b32 v22, v9
    v_mfma_f32_16x16x32_bf16 v[208:211], a[16:19], a[28:31], v[208:211]
    ds_read_b64_tr_b16 a[10:11], v18 offset:46144
    v_mfma_f32_16x16x32_bf16 a[160:163], a[20:23], a[28:31], a[160:163]
    ds_read_b64_tr_b16 a[12:13], v19 offset:43072
    v_mov_b32 v23, v10
    v_mfma_f32_16x16x32_bf16 a[164:167], a[20:23], a[32:35], a[164:167]
    ds_read_b64_tr_b16 a[14:15], v19 offset:46144
    v_mov_b32 v24, v11
    v_mfma_f32_16x16x32_bf16 a[168:171], a[20:23], a[36:39], a[168:171]
    v_mov_b32 v25, v12
    v_alignbit_b32 v252, v10, v9, 16
    v_mfma_f32_16x16x32_bf16 a[172:175], a[20:23], a[40:43], a[172:175]
    v_alignbit_b32 v253, v11, v10, 16
    v_alignbit_b32 v254, v12, v11, 16
    v_mfma_f32_16x16x32_bf16 a[188:191], a[24:27], a[40:43], a[188:191]
    ds_read_b64_tr_b16 a[16:17], v18 offset:43136
    v_alignbit_b32 v255, v13, v12, 16
    v_mfma_f32_16x16x32_bf16 a[184:187], a[24:27], a[36:39], a[184:187]
    ds_read_b64_tr_b16 a[18:19], v18 offset:46208
    ds_write_b128 v4, v[28:31] offset:1088
    v_mfma_f32_16x16x32_bf16 a[180:183], a[24:27], a[32:35], a[180:183]
    ds_write_b128 v4, v[22:25] offset:5248
    ds_write_b128 v4, v[252:255] offset:9408
    v_mfma_f32_16x16x32_bf16 a[176:179], a[24:27], a[28:31], a[176:179]
    ds_read_b128 v[8:11], v7 offset:2048
    ds_read_b64 v[12:13], v7 offset:2064
    s_waitcnt lgkmcnt(8)
    s_nop 0
    v_mfma_f32_16x16x32_bf16 v[32:35], a[0:3], a[44:47], v[32:35]
    ds_read_b64_tr_b16 a[20:21], v19 offset:43136
    s_nop 0
    v_mfma_f32_16x16x32_bf16 v[36:39], a[0:3], a[48:51], v[36:39]
    ds_read_b64_tr_b16 a[22:23], v19 offset:46208
    s_nop 0
    v_mfma_f32_16x16x32_bf16 v[40:43], a[0:3], a[52:55], v[40:43]
    s_nop 0
    s_waitcnt lgkmcnt(2)
    v_mfma_f32_16x16x32_bf16 v[44:47], a[0:3], a[56:59], v[44:47]
    v_alignbit_b32 v28, v9, v8, 16
    v_alignbit_b32 v29, v10, v9, 16
    v_mfma_f32_16x16x32_bf16 v[60:63], a[4:7], a[56:59], v[60:63]
    ds_read_b64_tr_b16 a[24:25], v20 offset:49152
    v_alignbit_b32 v30, v11, v10, 16
    v_mfma_f32_16x16x32_bf16 v[56:59], a[4:7], a[52:55], v[56:59]
    ds_read_b64_tr_b16 a[26:27], v20 offset:49664
    v_alignbit_b32 v31, v12, v11, 16
    v_mfma_f32_16x16x32_bf16 v[52:55], a[4:7], a[48:51], v[52:55]
    v_mov_b32 v22, v9
    v_mov_b32 v23, v10
    v_mfma_f32_16x16x32_bf16 v[48:51], a[4:7], a[44:47], v[48:51]
    v_mov_b32 v24, v11
    v_mfma_f32_16x16x32_bf16 v[64:67], a[8:11], a[44:47], v[64:67]
    ds_read_b64_tr_b16 a[0:1], v18 offset:50176
    v_mov_b32 v25, v12
    v_mfma_f32_16x16x32_bf16 v[68:71], a[8:11], a[48:51], v[68:71]
    ds_read_b64_tr_b16 a[2:3], v18 offset:53248
    v_alignbit_b32 v252, v10, v9, 16
    v_mfma_f32_16x16x32_bf16 v[72:75], a[8:11], a[52:55], v[72:75]
    v_alignbit_b32 v253, v11, v10, 16
    v_alignbit_b32 v254, v12, v11, 16
    v_mfma_f32_16x16x32_bf16 v[76:79], a[8:11], a[56:59], v[76:79]
    v_alignbit_b32 v255, v13, v12, 16
    ds_write_b128 v4, v[28:31] offset:2112
    v_mfma_f32_16x16x32_bf16 v[92:95], a[12:15], a[56:59], v[92:95]
    ds_read_b64_tr_b16 a[4:5], v19 offset:50176
    ds_write_b128 v4, v[22:25] offset:6272
    v_mfma_f32_16x16x32_bf16 v[88:91], a[12:15], a[52:55], v[88:91]
    ds_read_b64_tr_b16 a[6:7], v19 offset:53248
    ds_write_b128 v4, v[252:255] offset:10432
    v_mfma_f32_16x16x32_bf16 v[84:87], a[12:15], a[48:51], v[84:87]
    ds_read_b128 v[8:11], v7 offset:3072
    ds_read_b64 v[12:13], v7 offset:3088
    s_nop 0
    v_mfma_f32_16x16x32_bf16 v[80:83], a[12:15], a[44:47], v[80:83]
    s_nop 0
    s_waitcnt lgkmcnt(11)
    v_mfma_f32_16x16x32_bf16 v[96:99], a[16:19], a[44:47], v[96:99]
    ds_read_b64_tr_b16 a[8:9], v18 offset:50240
    s_nop 0
    v_mfma_f32_16x16x32_bf16 v[100:103], a[16:19], a[48:51], v[100:103]
    ds_read_b64_tr_b16 a[10:11], v18 offset:53312
    s_nop 0
    v_mfma_f32_16x16x32_bf16 v[104:107], a[16:19], a[52:55], v[104:107]
    s_waitcnt lgkmcnt(2)
    v_alignbit_b32 v28, v9, v8, 16
    v_mfma_f32_16x16x32_bf16 v[108:111], a[16:19], a[56:59], v[108:111]
    v_alignbit_b32 v29, v10, v9, 16
    v_alignbit_b32 v30, v11, v10, 16
    v_mfma_f32_16x16x32_bf16 v[124:127], a[20:23], a[56:59], v[124:127]
    ds_read_b64_tr_b16 a[12:13], v19 offset:50240
    v_alignbit_b32 v31, v12, v11, 16
    v_mfma_f32_16x16x32_bf16 v[120:123], a[20:23], a[52:55], v[120:123]
    ds_read_b64_tr_b16 a[14:15], v19 offset:53312
    v_mov_b32 v22, v9
    v_mfma_f32_16x16x32_bf16 v[116:119], a[20:23], a[48:51], v[116:119]
    v_mov_b32 v23, v10
    v_mov_b32 v24, v11
    v_mfma_f32_16x16x32_bf16 v[112:115], a[20:23], a[44:47], v[112:115]
    v_mov_b32 v25, v12
    v_mfma_f32_16x16x32_bf16 v[128:131], a[24:27], a[44:47], v[128:131]
    ds_read_b64_tr_b16 a[16:17], v18 offset:50304
    v_alignbit_b32 v252, v10, v9, 16
    v_mfma_f32_16x16x32_bf16 v[132:135], a[24:27], a[48:51], v[132:135]
    ds_read_b64_tr_b16 a[18:19], v18 offset:53376
    v_alignbit_b32 v253, v11, v10, 16
    v_mfma_f32_16x16x32_bf16 v[136:139], a[24:27], a[52:55], v[136:139]
    v_alignbit_b32 v254, v12, v11, 16
    v_alignbit_b32 v255, v13, v12, 16
    v_mfma_f32_16x16x32_bf16 v[140:143], a[24:27], a[56:59], v[140:143]
    ds_write_b128 v4, v[28:31] offset:3136
    ds_write_b128 v4, v[22:25] offset:7296
    v_mfma_f32_16x16x32_bf16 v[156:159], a[0:3], a[56:59], v[156:159]
    ds_read_b64_tr_b16 a[20:21], v19 offset:50304
    ds_write_b128 v4, v[252:255] offset:11456
    v_mfma_f32_16x16x32_bf16 v[152:155], a[0:3], a[52:55], v[152:155]
    ds_read_b64_tr_b16 a[22:23], v19 offset:53376
    ds_read_b128 v[8:11], v6 offset:4096
    ds_read_b64 v[12:13], v6 offset:4112
    v_mfma_f32_16x16x32_bf16 v[148:151], a[0:3], a[48:51], v[148:151]
    s_nop 0
    s_nop 0
    v_mfma_f32_16x16x32_bf16 v[144:147], a[0:3], a[44:47], v[144:147]
    s_nop 0
    s_waitcnt lgkmcnt(11)
    v_mfma_f32_16x16x32_bf16 v[160:163], a[4:7], a[44:47], v[160:163]
    ds_read_b64_tr_b16 a[24:25], v20 offset:56320
    s_nop 0
    v_mfma_f32_16x16x32_bf16 v[164:167], a[4:7], a[48:51], v[164:167]
    ds_read_b64_tr_b16 a[26:27], v20 offset:56832
    s_waitcnt lgkmcnt(2)
    v_mfma_f32_16x16x32_bf16 v[168:171], a[4:7], a[52:55], v[168:171]
    v_alignbit_b32 v28, v9, v8, 16
    v_alignbit_b32 v29, v10, v9, 16
    v_mfma_f32_16x16x32_bf16 v[172:175], a[4:7], a[56:59], v[172:175]
    v_alignbit_b32 v30, v11, v10, 16
    v_alignbit_b32 v31, v12, v11, 16
    v_mfma_f32_16x16x32_bf16 v[188:191], a[8:11], a[56:59], v[188:191]
    v_mov_b32 v22, v9
    v_mov_b32 v23, v10
    v_mfma_f32_16x16x32_bf16 v[184:187], a[8:11], a[52:55], v[184:187]
    v_mov_b32 v24, v11
    v_mov_b32 v25, v12
    v_mfma_f32_16x16x32_bf16 v[180:183], a[8:11], a[48:51], v[180:183]
    v_alignbit_b32 v252, v10, v9, 16
    v_alignbit_b32 v253, v11, v10, 16
    v_mfma_f32_16x16x32_bf16 v[176:179], a[8:11], a[44:47], v[176:179]
    v_alignbit_b32 v254, v12, v11, 16
    v_mfma_f32_16x16x32_bf16 v[192:195], a[12:15], a[44:47], v[192:195]
    v_alignbit_b32 v255, v13, v12, 16
    ds_write_b128 v5, v[28:31] offset:4160
    v_mfma_f32_16x16x32_bf16 v[196:199], a[12:15], a[48:51], v[196:199]
    ds_write_b128 v5, v[22:25] offset:8320
    ds_write_b128 v5, v[252:255] offset:12480
    v_mfma_f32_16x16x32_bf16 v[200:203], a[12:15], a[52:55], v[200:203]
    v_mfma_f32_16x16x32_bf16 v[204:207], a[12:15], a[56:59], v[204:207]
    v_mfma_f32_16x16x32_bf16 v[220:223], a[16:19], a[56:59], v[220:223]
    v_mfma_f32_16x16x32_bf16 v[216:219], a[16:19], a[52:55], v[216:219]
    v_mfma_f32_16x16x32_bf16 v[212:215], a[16:19], a[48:51], v[212:215]
    v_mfma_f32_16x16x32_bf16 v[208:211], a[16:19], a[44:47], v[208:211]
    s_waitcnt lgkmcnt(3)
    v_mfma_f32_16x16x32_bf16 a[160:163], a[20:23], a[44:47], a[160:163]
    v_mfma_f32_16x16x32_bf16 a[164:167], a[20:23], a[48:51], a[164:167]
    v_mfma_f32_16x16x32_bf16 a[168:171], a[20:23], a[52:55], a[168:171]
    v_mfma_f32_16x16x32_bf16 a[172:175], a[20:23], a[56:59], a[172:175]
    v_mfma_f32_16x16x32_bf16 a[188:191], a[24:27], a[56:59], a[188:191]
    v_mfma_f32_16x16x32_bf16 a[184:187], a[24:27], a[52:55], a[184:187]
    v_mfma_f32_16x16x32_bf16 a[180:183], a[24:27], a[48:51], a[180:183]
    v_mfma_f32_16x16x32_bf16 a[176:179], a[24:27], a[44:47], a[176:179]
    s_lshr_b32 s35, s34, 1
    s_mul_i32 s35, s35, 7
    s_and_b32 s40, s34, 1
    s_add_u32 s39, s35, 3
    s_lshl_b32 s41, s40, 2
    s_add_u32 s35, s35, s41
    s_lshl_b32 s41, s33, 4
    s_lshl_b32 s42, s32, 2
    s_add_u32 s41, s41, s42
    s_lshl_b32 s41, s41, 10
    s_lshl_b32 s35, s35, 17
    s_add_u32 s35, s35, s41
    s_add_u32 s36, s35, 0x20000
    s_add_u32 s38, s35, 0x40000
    s_lshl_b32 s39, s39, 17
    s_add_u32 s39, s39, s41
    s_lshl_b32 s40, s40, 9
    s_add_u32 s39, s39, s40
    v_and_b32 v1, 31, v2
    v_lshlrev_b32 v1, 4, v1
    v_lshrrev_b32 v3, 5, v2
    v_lshl_add_u32 v1, v3, 10, v1
    s_barrier
    s_mov_b32 s46, 0xbfb8aa3b
    s_mov_b32 s47, 0xbfb8aa3b
    v_pk_mul_f32 v[4:5], v[32:33], s[46:47]
    v_pk_mul_f32 v[6:7], v[34:35], s[46:47]
    v_exp_f32 v4, v4
    v_exp_f32 v5, v5
    v_exp_f32 v6, v6
    v_exp_f32 v7, v7
    v_pk_mul_f32 v[144:145], v[144:145], v[32:33]
    v_pk_mul_f32 v[146:147], v[146:147], v[34:35]
    v_pk_add_f32 v[4:5], v[4:5], 1.0 op_sel_hi:[1,0]
    v_pk_add_f32 v[6:7], v[6:7], 1.0 op_sel_hi:[1,0]
    v_rcp_f32 v4, v4
    v_rcp_f32 v5, v5
    v_rcp_f32 v6, v6
    v_rcp_f32 v7, v7
    v_pk_mul_f32 v[144:145], v[144:145], v[4:5]
    v_pk_mul_f32 v[146:147], v[146:147], v[6:7]
    v_cvt_pk_bf16_f32 v12, v144, v145
    v_cvt_pk_bf16_f32 v13, v146, v147
    v_pk_mul_f32 v[8:9], v[48:49], s[46:47]
    v_pk_mul_f32 v[10:11], v[50:51], s[46:47]
    v_exp_f32 v8, v8
    v_exp_f32 v9, v9
    v_exp_f32 v10, v10
    v_exp_f32 v11, v11
    v_pk_mul_f32 v[160:161], v[160:161], v[48:49]
    v_pk_mul_f32 v[162:163], v[162:163], v[50:51]
    v_pk_add_f32 v[8:9], v[8:9], 1.0 op_sel_hi:[1,0]
    v_pk_add_f32 v[10:11], v[10:11], 1.0 op_sel_hi:[1,0]
    v_rcp_f32 v8, v8
    v_rcp_f32 v9, v9
    v_rcp_f32 v10, v10
    v_rcp_f32 v11, v11
    v_pk_mul_f32 v[160:161], v[160:161], v[8:9]
    v_pk_mul_f32 v[162:163], v[162:163], v[10:11]
    v_cvt_pk_bf16_f32 v14, v160, v161
    v_cvt_pk_bf16_f32 v15, v162, v163
    buffer_store_dwordx4 v[12:15], v26, s[12:15], s35 offen offset:0 sc0 sc1
    v_pk_mul_f32 v[4:5], v[36:37], s[46:47]
    v_pk_mul_f32 v[6:7], v[38:39], s[46:47]
    v_exp_f32 v4, v4
    v_exp_f32 v5, v5
    v_exp_f32 v6, v6
    v_exp_f32 v7, v7
    v_pk_mul_f32 v[148:149], v[148:149], v[36:37]
    v_pk_mul_f32 v[150:151], v[150:151], v[38:39]
    v_pk_add_f32 v[4:5], v[4:5], 1.0 op_sel_hi:[1,0]
    v_pk_add_f32 v[6:7], v[6:7], 1.0 op_sel_hi:[1,0]
    v_rcp_f32 v4, v4
    v_rcp_f32 v5, v5
    v_rcp_f32 v6, v6
    v_rcp_f32 v7, v7
    v_pk_mul_f32 v[148:149], v[148:149], v[4:5]
    v_pk_mul_f32 v[150:151], v[150:151], v[6:7]
    v_cvt_pk_bf16_f32 v16, v148, v149
    v_cvt_pk_bf16_f32 v17, v150, v151
    v_pk_mul_f32 v[8:9], v[52:53], s[46:47]
    v_pk_mul_f32 v[10:11], v[54:55], s[46:47]
    v_exp_f32 v8, v8
    v_exp_f32 v9, v9
    v_exp_f32 v10, v10
    v_exp_f32 v11, v11
    v_pk_mul_f32 v[164:165], v[164:165], v[52:53]
    v_pk_mul_f32 v[166:167], v[166:167], v[54:55]
    v_pk_add_f32 v[8:9], v[8:9], 1.0 op_sel_hi:[1,0]
    v_pk_add_f32 v[10:11], v[10:11], 1.0 op_sel_hi:[1,0]
    v_rcp_f32 v8, v8
    v_rcp_f32 v9, v9
    v_rcp_f32 v10, v10
    v_rcp_f32 v11, v11
    v_pk_mul_f32 v[164:165], v[164:165], v[8:9]
    v_pk_mul_f32 v[166:167], v[166:167], v[10:11]
    v_cvt_pk_bf16_f32 v18, v164, v165
    v_cvt_pk_bf16_f32 v19, v166, v167
    buffer_store_dwordx4 v[16:19], v26, s[12:15], s35 offen offset:1024 sc0 sc1
    v_pk_mul_f32 v[4:5], v[40:41], s[46:47]
    v_pk_mul_f32 v[6:7], v[42:43], s[46:47]
    v_exp_f32 v4, v4
    v_exp_f32 v5, v5
    v_exp_f32 v6, v6
    v_exp_f32 v7, v7
    v_pk_mul_f32 v[152:153], v[152:153], v[40:41]
    v_pk_mul_f32 v[154:155], v[154:155], v[42:43]
    v_pk_add_f32 v[4:5], v[4:5], 1.0 op_sel_hi:[1,0]
    v_pk_add_f32 v[6:7], v[6:7], 1.0 op_sel_hi:[1,0]
    v_rcp_f32 v4, v4
    v_rcp_f32 v5, v5
    v_rcp_f32 v6, v6
    v_rcp_f32 v7, v7
    v_pk_mul_f32 v[152:153], v[152:153], v[4:5]
    v_pk_mul_f32 v[154:155], v[154:155], v[6:7]
    v_cvt_pk_bf16_f32 v12, v152, v153
    v_cvt_pk_bf16_f32 v13, v154, v155
    v_pk_mul_f32 v[8:9], v[56:57], s[46:47]
    v_pk_mul_f32 v[10:11], v[58:59], s[46:47]
    v_exp_f32 v8, v8
    v_exp_f32 v9, v9
    v_exp_f32 v10, v10
    v_exp_f32 v11, v11
    v_pk_mul_f32 v[168:169], v[168:169], v[56:57]
    v_pk_mul_f32 v[170:171], v[170:171], v[58:59]
    v_pk_add_f32 v[8:9], v[8:9], 1.0 op_sel_hi:[1,0]
    v_pk_add_f32 v[10:11], v[10:11], 1.0 op_sel_hi:[1,0]
    v_rcp_f32 v8, v8
    v_rcp_f32 v9, v9
    v_rcp_f32 v10, v10
    v_rcp_f32 v11, v11
    v_pk_mul_f32 v[168:169], v[168:169], v[8:9]
    v_pk_mul_f32 v[170:171], v[170:171], v[10:11]
    v_cvt_pk_bf16_f32 v14, v168, v169
    v_cvt_pk_bf16_f32 v15, v170, v171
    buffer_store_dwordx4 v[12:15], v26, s[12:15], s35 offen offset:2048 sc0 sc1
    v_pk_mul_f32 v[4:5], v[44:45], s[46:47]
    v_pk_mul_f32 v[6:7], v[46:47], s[46:47]
    v_exp_f32 v4, v4
    v_exp_f32 v5, v5
    v_exp_f32 v6, v6
    v_exp_f32 v7, v7
    v_pk_mul_f32 v[156:157], v[156:157], v[44:45]
    v_pk_mul_f32 v[158:159], v[158:159], v[46:47]
    v_pk_add_f32 v[4:5], v[4:5], 1.0 op_sel_hi:[1,0]
    v_pk_add_f32 v[6:7], v[6:7], 1.0 op_sel_hi:[1,0]
    v_rcp_f32 v4, v4
    v_rcp_f32 v5, v5
    v_rcp_f32 v6, v6
    v_rcp_f32 v7, v7
    v_pk_mul_f32 v[156:157], v[156:157], v[4:5]
    v_pk_mul_f32 v[158:159], v[158:159], v[6:7]
    v_cvt_pk_bf16_f32 v16, v156, v157
    v_cvt_pk_bf16_f32 v17, v158, v159
    v_pk_mul_f32 v[8:9], v[60:61], s[46:47]
    v_pk_mul_f32 v[10:11], v[62:63], s[46:47]
    v_exp_f32 v8, v8
    v_exp_f32 v9, v9
    v_exp_f32 v10, v10
    v_exp_f32 v11, v11
    v_pk_mul_f32 v[172:173], v[172:173], v[60:61]
    v_pk_mul_f32 v[174:175], v[174:175], v[62:63]
    v_pk_add_f32 v[8:9], v[8:9], 1.0 op_sel_hi:[1,0]
    v_pk_add_f32 v[10:11], v[10:11], 1.0 op_sel_hi:[1,0]
    v_rcp_f32 v8, v8
    v_rcp_f32 v9, v9
    v_rcp_f32 v10, v10
    v_rcp_f32 v11, v11
    v_pk_mul_f32 v[172:173], v[172:173], v[8:9]
    v_pk_mul_f32 v[174:175], v[174:175], v[10:11]
    v_cvt_pk_bf16_f32 v18, v172, v173
    v_cvt_pk_bf16_f32 v19, v174, v175
    buffer_store_dwordx4 v[16:19], v26, s[12:15], s35 offen offset:3072 sc0 sc1
    s_mov_b32 s46, 0xbfb8aa3b
    s_mov_b32 s47, 0xbfb8aa3b
    v_pk_mul_f32 v[4:5], v[64:65], s[46:47]
    v_pk_mul_f32 v[6:7], v[66:67], s[46:47]
    v_exp_f32 v4, v4
    v_exp_f32 v5, v5
    v_exp_f32 v6, v6
    v_exp_f32 v7, v7
    v_pk_mul_f32 v[176:177], v[176:177], v[64:65]
    v_pk_mul_f32 v[178:179], v[178:179], v[66:67]
    v_pk_add_f32 v[4:5], v[4:5], 1.0 op_sel_hi:[1,0]
    v_pk_add_f32 v[6:7], v[6:7], 1.0 op_sel_hi:[1,0]
    v_rcp_f32 v4, v4
    v_rcp_f32 v5, v5
    v_rcp_f32 v6, v6
    v_rcp_f32 v7, v7
    v_pk_mul_f32 v[176:177], v[176:177], v[4:5]
    v_pk_mul_f32 v[178:179], v[178:179], v[6:7]
    v_cvt_pk_bf16_f32 v12, v176, v177
    v_cvt_pk_bf16_f32 v13, v178, v179
    v_pk_mul_f32 v[8:9], v[80:81], s[46:47]
    v_pk_mul_f32 v[10:11], v[82:83], s[46:47]
    v_exp_f32 v8, v8
    v_exp_f32 v9, v9
    v_exp_f32 v10, v10
    v_exp_f32 v11, v11
    v_pk_mul_f32 v[192:193], v[192:193], v[80:81]
    v_pk_mul_f32 v[194:195], v[194:195], v[82:83]
    v_pk_add_f32 v[8:9], v[8:9], 1.0 op_sel_hi:[1,0]
    v_pk_add_f32 v[10:11], v[10:11], 1.0 op_sel_hi:[1,0]
    v_rcp_f32 v8, v8
    v_rcp_f32 v9, v9
    v_rcp_f32 v10, v10
    v_rcp_f32 v11, v11
    v_pk_mul_f32 v[192:193], v[192:193], v[8:9]
    v_pk_mul_f32 v[194:195], v[194:195], v[10:11]
    v_cvt_pk_bf16_f32 v14, v192, v193
    v_cvt_pk_bf16_f32 v15, v194, v195
    buffer_store_dwordx4 v[12:15], v26, s[12:15], s36 offen offset:0 sc0 sc1
    v_pk_mul_f32 v[4:5], v[68:69], s[46:47]
    v_pk_mul_f32 v[6:7], v[70:71], s[46:47]
    v_exp_f32 v4, v4
    v_exp_f32 v5, v5
    v_exp_f32 v6, v6
    v_exp_f32 v7, v7
    v_pk_mul_f32 v[180:181], v[180:181], v[68:69]
    v_pk_mul_f32 v[182:183], v[182:183], v[70:71]
    v_pk_add_f32 v[4:5], v[4:5], 1.0 op_sel_hi:[1,0]
    v_pk_add_f32 v[6:7], v[6:7], 1.0 op_sel_hi:[1,0]
    v_rcp_f32 v4, v4
    v_rcp_f32 v5, v5
    v_rcp_f32 v6, v6
    v_rcp_f32 v7, v7
    v_pk_mul_f32 v[180:181], v[180:181], v[4:5]
    v_pk_mul_f32 v[182:183], v[182:183], v[6:7]
    v_cvt_pk_bf16_f32 v16, v180, v181
    v_cvt_pk_bf16_f32 v17, v182, v183
    v_pk_mul_f32 v[8:9], v[84:85], s[46:47]
    v_pk_mul_f32 v[10:11], v[86:87], s[46:47]
    v_exp_f32 v8, v8
    v_exp_f32 v9, v9
    v_exp_f32 v10, v10
    v_exp_f32 v11, v11
    v_pk_mul_f32 v[196:197], v[196:197], v[84:85]
    v_pk_mul_f32 v[198:199], v[198:199], v[86:87]
    v_pk_add_f32 v[8:9], v[8:9], 1.0 op_sel_hi:[1,0]
    v_pk_add_f32 v[10:11], v[10:11], 1.0 op_sel_hi:[1,0]
    v_rcp_f32 v8, v8
    v_rcp_f32 v9, v9
    v_rcp_f32 v10, v10
    v_rcp_f32 v11, v11
    v_pk_mul_f32 v[196:197], v[196:197], v[8:9]
    v_pk_mul_f32 v[198:199], v[198:199], v[10:11]
    v_cvt_pk_bf16_f32 v18, v196, v197
    v_cvt_pk_bf16_f32 v19, v198, v199
    buffer_store_dwordx4 v[16:19], v26, s[12:15], s36 offen offset:1024 sc0 sc1
    v_pk_mul_f32 v[4:5], v[72:73], s[46:47]
    v_pk_mul_f32 v[6:7], v[74:75], s[46:47]
    v_exp_f32 v4, v4
    v_exp_f32 v5, v5
    v_exp_f32 v6, v6
    v_exp_f32 v7, v7
    v_pk_mul_f32 v[184:185], v[184:185], v[72:73]
    v_pk_mul_f32 v[186:187], v[186:187], v[74:75]
    v_pk_add_f32 v[4:5], v[4:5], 1.0 op_sel_hi:[1,0]
    v_pk_add_f32 v[6:7], v[6:7], 1.0 op_sel_hi:[1,0]
    v_rcp_f32 v4, v4
    v_rcp_f32 v5, v5
    v_rcp_f32 v6, v6
    v_rcp_f32 v7, v7
    v_pk_mul_f32 v[184:185], v[184:185], v[4:5]
    v_pk_mul_f32 v[186:187], v[186:187], v[6:7]
    v_cvt_pk_bf16_f32 v12, v184, v185
    v_cvt_pk_bf16_f32 v13, v186, v187
    v_pk_mul_f32 v[8:9], v[88:89], s[46:47]
    v_pk_mul_f32 v[10:11], v[90:91], s[46:47]
    v_exp_f32 v8, v8
    v_exp_f32 v9, v9
    v_exp_f32 v10, v10
    v_exp_f32 v11, v11
    v_pk_mul_f32 v[200:201], v[200:201], v[88:89]
    v_pk_mul_f32 v[202:203], v[202:203], v[90:91]
    v_pk_add_f32 v[8:9], v[8:9], 1.0 op_sel_hi:[1,0]
    v_pk_add_f32 v[10:11], v[10:11], 1.0 op_sel_hi:[1,0]
    v_rcp_f32 v8, v8
    v_rcp_f32 v9, v9
    v_rcp_f32 v10, v10
    v_rcp_f32 v11, v11
    v_pk_mul_f32 v[200:201], v[200:201], v[8:9]
    v_pk_mul_f32 v[202:203], v[202:203], v[10:11]
    v_cvt_pk_bf16_f32 v14, v200, v201
    v_cvt_pk_bf16_f32 v15, v202, v203
    buffer_store_dwordx4 v[12:15], v26, s[12:15], s36 offen offset:2048 sc0 sc1
    v_pk_mul_f32 v[4:5], v[76:77], s[46:47]
    v_pk_mul_f32 v[6:7], v[78:79], s[46:47]
    v_exp_f32 v4, v4
    v_exp_f32 v5, v5
    v_exp_f32 v6, v6
    v_exp_f32 v7, v7
    v_pk_mul_f32 v[188:189], v[188:189], v[76:77]
    v_pk_mul_f32 v[190:191], v[190:191], v[78:79]
    v_pk_add_f32 v[4:5], v[4:5], 1.0 op_sel_hi:[1,0]
    v_pk_add_f32 v[6:7], v[6:7], 1.0 op_sel_hi:[1,0]
    v_rcp_f32 v4, v4
    v_rcp_f32 v5, v5
    v_rcp_f32 v6, v6
    v_rcp_f32 v7, v7
    v_pk_mul_f32 v[188:189], v[188:189], v[4:5]
    v_pk_mul_f32 v[190:191], v[190:191], v[6:7]
    v_cvt_pk_bf16_f32 v16, v188, v189
    v_cvt_pk_bf16_f32 v17, v190, v191
    v_pk_mul_f32 v[8:9], v[92:93], s[46:47]
    v_pk_mul_f32 v[10:11], v[94:95], s[46:47]
    v_exp_f32 v8, v8
    v_exp_f32 v9, v9
    v_exp_f32 v10, v10
    v_exp_f32 v11, v11
    v_pk_mul_f32 v[204:205], v[204:205], v[92:93]
    v_pk_mul_f32 v[206:207], v[206:207], v[94:95]
    v_pk_add_f32 v[8:9], v[8:9], 1.0 op_sel_hi:[1,0]
    v_pk_add_f32 v[10:11], v[10:11], 1.0 op_sel_hi:[1,0]
    v_rcp_f32 v8, v8
    v_rcp_f32 v9, v9
    v_rcp_f32 v10, v10
    v_rcp_f32 v11, v11
    v_pk_mul_f32 v[204:205], v[204:205], v[8:9]
    v_pk_mul_f32 v[206:207], v[206:207], v[10:11]
    v_cvt_pk_bf16_f32 v18, v204, v205
    v_cvt_pk_bf16_f32 v19, v206, v207
    buffer_store_dwordx4 v[16:19], v26, s[12:15], s36 offen offset:3072 sc0 sc1
    v_accvgpr_read_b32 v32, a160
    v_accvgpr_read_b32 v33, a161
    v_accvgpr_read_b32 v34, a162
    v_accvgpr_read_b32 v35, a163
    v_accvgpr_read_b32 v36, a164
    v_accvgpr_read_b32 v37, a165
    v_accvgpr_read_b32 v38, a166
    v_accvgpr_read_b32 v39, a167
    v_accvgpr_read_b32 v40, a168
    v_accvgpr_read_b32 v41, a169
    v_accvgpr_read_b32 v42, a170
    v_accvgpr_read_b32 v43, a171
    v_accvgpr_read_b32 v44, a172
    v_accvgpr_read_b32 v45, a173
    v_accvgpr_read_b32 v46, a174
    v_accvgpr_read_b32 v47, a175
    v_accvgpr_read_b32 v48, a176
    v_accvgpr_read_b32 v49, a177
    v_accvgpr_read_b32 v50, a178
    v_accvgpr_read_b32 v51, a179
    v_accvgpr_read_b32 v52, a180
    v_accvgpr_read_b32 v53, a181
    v_accvgpr_read_b32 v54, a182
    v_accvgpr_read_b32 v55, a183
    v_accvgpr_read_b32 v56, a184
    v_accvgpr_read_b32 v57, a185
    v_accvgpr_read_b32 v58, a186
    v_accvgpr_read_b32 v59, a187
    v_accvgpr_read_b32 v60, a188
    v_accvgpr_read_b32 v61, a189
    v_accvgpr_read_b32 v62, a190
    v_accvgpr_read_b32 v63, a191
    s_mov_b32 s46, 0xbfb8aa3b
    s_mov_b32 s47, 0xbfb8aa3b
    v_pk_mul_f32 v[4:5], v[96:97], s[46:47]
    v_pk_mul_f32 v[6:7], v[98:99], s[46:47]
    v_exp_f32 v4, v4
    v_exp_f32 v5, v5
    v_exp_f32 v6, v6
    v_exp_f32 v7, v7
    v_pk_mul_f32 v[208:209], v[208:209], v[96:97]
    v_pk_mul_f32 v[210:211], v[210:211], v[98:99]
    v_pk_add_f32 v[4:5], v[4:5], 1.0 op_sel_hi:[1,0]
    v_pk_add_f32 v[6:7], v[6:7], 1.0 op_sel_hi:[1,0]
    v_rcp_f32 v4, v4
    v_rcp_f32 v5, v5
    v_rcp_f32 v6, v6
    v_rcp_f32 v7, v7
    v_pk_mul_f32 v[208:209], v[208:209], v[4:5]
    v_pk_mul_f32 v[210:211], v[210:211], v[6:7]
    v_cvt_pk_bf16_f32 v12, v208, v209
    v_cvt_pk_bf16_f32 v13, v210, v211
    v_pk_mul_f32 v[8:9], v[112:113], s[46:47]
    v_pk_mul_f32 v[10:11], v[114:115], s[46:47]
    v_exp_f32 v8, v8
    v_exp_f32 v9, v9
    v_exp_f32 v10, v10
    v_exp_f32 v11, v11
    v_pk_mul_f32 v[32:33], v[32:33], v[112:113]
    v_pk_mul_f32 v[34:35], v[34:35], v[114:115]
    v_pk_add_f32 v[8:9], v[8:9], 1.0 op_sel_hi:[1,0]
    v_pk_add_f32 v[10:11], v[10:11], 1.0 op_sel_hi:[1,0]
    v_rcp_f32 v8, v8
    v_rcp_f32 v9, v9
    v_rcp_f32 v10, v10
    v_rcp_f32 v11, v11
    v_pk_mul_f32 v[32:33], v[32:33], v[8:9]
    v_pk_mul_f32 v[34:35], v[34:35], v[10:11]
    v_cvt_pk_bf16_f32 v14, v32, v33
    v_cvt_pk_bf16_f32 v15, v34, v35
    buffer_store_dwordx4 v[12:15], v26, s[12:15], s38 offen offset:0 sc0 sc1
    v_pk_mul_f32 v[4:5], v[100:101], s[46:47]
    v_pk_mul_f32 v[6:7], v[102:103], s[46:47]
    v_exp_f32 v4, v4
    v_exp_f32 v5, v5
    v_exp_f32 v6, v6
    v_exp_f32 v7, v7
    v_pk_mul_f32 v[212:213], v[212:213], v[100:101]
    v_pk_mul_f32 v[214:215], v[214:215], v[102:103]
    v_pk_add_f32 v[4:5], v[4:5], 1.0 op_sel_hi:[1,0]
    v_pk_add_f32 v[6:7], v[6:7], 1.0 op_sel_hi:[1,0]
    v_rcp_f32 v4, v4
    v_rcp_f32 v5, v5
    v_rcp_f32 v6, v6
    v_rcp_f32 v7, v7
    v_pk_mul_f32 v[212:213], v[212:213], v[4:5]
    v_pk_mul_f32 v[214:215], v[214:215], v[6:7]
    v_cvt_pk_bf16_f32 v16, v212, v213
    v_cvt_pk_bf16_f32 v17, v214, v215
    v_pk_mul_f32 v[8:9], v[116:117], s[46:47]
    v_pk_mul_f32 v[10:11], v[118:119], s[46:47]
    v_exp_f32 v8, v8
    v_exp_f32 v9, v9
    v_exp_f32 v10, v10
    v_exp_f32 v11, v11
    v_pk_mul_f32 v[36:37], v[36:37], v[116:117]
    v_pk_mul_f32 v[38:39], v[38:39], v[118:119]
    v_pk_add_f32 v[8:9], v[8:9], 1.0 op_sel_hi:[1,0]
    v_pk_add_f32 v[10:11], v[10:11], 1.0 op_sel_hi:[1,0]
    v_rcp_f32 v8, v8
    v_rcp_f32 v9, v9
    v_rcp_f32 v10, v10
    v_rcp_f32 v11, v11
    v_pk_mul_f32 v[36:37], v[36:37], v[8:9]
    v_pk_mul_f32 v[38:39], v[38:39], v[10:11]
    v_cvt_pk_bf16_f32 v18, v36, v37
    v_cvt_pk_bf16_f32 v19, v38, v39
    buffer_store_dwordx4 v[16:19], v26, s[12:15], s38 offen offset:1024 sc0 sc1
    v_pk_mul_f32 v[4:5], v[104:105], s[46:47]
    v_pk_mul_f32 v[6:7], v[106:107], s[46:47]
    v_exp_f32 v4, v4
    v_exp_f32 v5, v5
    v_exp_f32 v6, v6
    v_exp_f32 v7, v7
    v_pk_mul_f32 v[216:217], v[216:217], v[104:105]
    v_pk_mul_f32 v[218:219], v[218:219], v[106:107]
    v_pk_add_f32 v[4:5], v[4:5], 1.0 op_sel_hi:[1,0]
    v_pk_add_f32 v[6:7], v[6:7], 1.0 op_sel_hi:[1,0]
    v_rcp_f32 v4, v4
    v_rcp_f32 v5, v5
    v_rcp_f32 v6, v6
    v_rcp_f32 v7, v7
    v_pk_mul_f32 v[216:217], v[216:217], v[4:5]
    v_pk_mul_f32 v[218:219], v[218:219], v[6:7]
    v_cvt_pk_bf16_f32 v12, v216, v217
    v_cvt_pk_bf16_f32 v13, v218, v219
    v_pk_mul_f32 v[8:9], v[120:121], s[46:47]
    v_pk_mul_f32 v[10:11], v[122:123], s[46:47]
    v_exp_f32 v8, v8
    v_exp_f32 v9, v9
    v_exp_f32 v10, v10
    v_exp_f32 v11, v11
    v_pk_mul_f32 v[40:41], v[40:41], v[120:121]
    v_pk_mul_f32 v[42:43], v[42:43], v[122:123]
    v_pk_add_f32 v[8:9], v[8:9], 1.0 op_sel_hi:[1,0]
    v_pk_add_f32 v[10:11], v[10:11], 1.0 op_sel_hi:[1,0]
    v_rcp_f32 v8, v8
    v_rcp_f32 v9, v9
    v_rcp_f32 v10, v10
    v_rcp_f32 v11, v11
    v_pk_mul_f32 v[40:41], v[40:41], v[8:9]
    v_pk_mul_f32 v[42:43], v[42:43], v[10:11]
    v_cvt_pk_bf16_f32 v14, v40, v41
    v_cvt_pk_bf16_f32 v15, v42, v43
    buffer_store_dwordx4 v[12:15], v26, s[12:15], s38 offen offset:2048 sc0 sc1
    v_pk_mul_f32 v[4:5], v[108:109], s[46:47]
    v_pk_mul_f32 v[6:7], v[110:111], s[46:47]
    v_exp_f32 v4, v4
    v_exp_f32 v5, v5
    v_exp_f32 v6, v6
    v_exp_f32 v7, v7
    v_pk_mul_f32 v[220:221], v[220:221], v[108:109]
    v_pk_mul_f32 v[222:223], v[222:223], v[110:111]
    v_pk_add_f32 v[4:5], v[4:5], 1.0 op_sel_hi:[1,0]
    v_pk_add_f32 v[6:7], v[6:7], 1.0 op_sel_hi:[1,0]
    v_rcp_f32 v4, v4
    v_rcp_f32 v5, v5
    v_rcp_f32 v6, v6
    v_rcp_f32 v7, v7
    v_pk_mul_f32 v[220:221], v[220:221], v[4:5]
    v_pk_mul_f32 v[222:223], v[222:223], v[6:7]
    v_cvt_pk_bf16_f32 v16, v220, v221
    v_cvt_pk_bf16_f32 v17, v222, v223
    v_pk_mul_f32 v[8:9], v[124:125], s[46:47]
    v_pk_mul_f32 v[10:11], v[126:127], s[46:47]
    v_exp_f32 v8, v8
    v_exp_f32 v9, v9
    v_exp_f32 v10, v10
    v_exp_f32 v11, v11
    v_pk_mul_f32 v[44:45], v[44:45], v[124:125]
    v_pk_mul_f32 v[46:47], v[46:47], v[126:127]
    v_pk_add_f32 v[8:9], v[8:9], 1.0 op_sel_hi:[1,0]
    v_pk_add_f32 v[10:11], v[10:11], 1.0 op_sel_hi:[1,0]
    v_rcp_f32 v8, v8
    v_rcp_f32 v9, v9
    v_rcp_f32 v10, v10
    v_rcp_f32 v11, v11
    v_pk_mul_f32 v[44:45], v[44:45], v[8:9]
    v_pk_mul_f32 v[46:47], v[46:47], v[10:11]
    v_cvt_pk_bf16_f32 v18, v44, v45
    v_cvt_pk_bf16_f32 v19, v46, v47
    buffer_store_dwordx4 v[16:19], v26, s[12:15], s38 offen offset:3072 sc0 sc1
    s_mov_b32 s46, 0xbfb8aa3b
    s_mov_b32 s47, 0xbfb8aa3b
    v_pk_mul_f32 v[4:5], v[128:129], s[46:47]
    v_pk_mul_f32 v[6:7], v[130:131], s[46:47]
    v_exp_f32 v4, v4
    v_exp_f32 v5, v5
    v_exp_f32 v6, v6
    v_exp_f32 v7, v7
    v_pk_mul_f32 v[48:49], v[48:49], v[128:129]
    v_pk_mul_f32 v[50:51], v[50:51], v[130:131]
    v_pk_add_f32 v[4:5], v[4:5], 1.0 op_sel_hi:[1,0]
    v_pk_add_f32 v[6:7], v[6:7], 1.0 op_sel_hi:[1,0]
    v_rcp_f32 v4, v4
    v_rcp_f32 v5, v5
    v_rcp_f32 v6, v6
    v_rcp_f32 v7, v7
    v_pk_mul_f32 v[48:49], v[48:49], v[4:5]
    v_pk_mul_f32 v[50:51], v[50:51], v[6:7]
    v_cvt_pk_bf16_f32 v12, v48, v49
    v_cvt_pk_bf16_f32 v13, v50, v51
    v_pk_mul_f32 v[8:9], v[132:133], s[46:47]
    v_pk_mul_f32 v[10:11], v[134:135], s[46:47]
    v_exp_f32 v8, v8
    v_exp_f32 v9, v9
    v_exp_f32 v10, v10
    v_exp_f32 v11, v11
    v_pk_mul_f32 v[52:53], v[52:53], v[132:133]
    v_pk_mul_f32 v[54:55], v[54:55], v[134:135]
    v_pk_add_f32 v[8:9], v[8:9], 1.0 op_sel_hi:[1,0]
    v_pk_add_f32 v[10:11], v[10:11], 1.0 op_sel_hi:[1,0]
    v_rcp_f32 v8, v8
    v_rcp_f32 v9, v9
    v_rcp_f32 v10, v10
    v_rcp_f32 v11, v11
    v_pk_mul_f32 v[52:53], v[52:53], v[8:9]
    v_pk_mul_f32 v[54:55], v[54:55], v[10:11]
    v_cvt_pk_bf16_f32 v14, v52, v53
    v_cvt_pk_bf16_f32 v15, v54, v55
    s_nop 0
    v_permlane32_swap_b32 v12, v14
    v_permlane32_swap_b32 v13, v15
    buffer_store_dwordx4 v[12:15], v1, s[12:15], s39 offen offset:0 sc0 sc1
    v_pk_mul_f32 v[4:5], v[136:137], s[46:47]
    v_pk_mul_f32 v[6:7], v[138:139], s[46:47]
    v_exp_f32 v4, v4
    v_exp_f32 v5, v5
    v_exp_f32 v6, v6
    v_exp_f32 v7, v7
    v_pk_mul_f32 v[56:57], v[56:57], v[136:137]
    v_pk_mul_f32 v[58:59], v[58:59], v[138:139]
    v_pk_add_f32 v[4:5], v[4:5], 1.0 op_sel_hi:[1,0]
    v_pk_add_f32 v[6:7], v[6:7], 1.0 op_sel_hi:[1,0]
    v_rcp_f32 v4, v4
    v_rcp_f32 v5, v5
    v_rcp_f32 v6, v6
    v_rcp_f32 v7, v7
    v_pk_mul_f32 v[56:57], v[56:57], v[4:5]
    v_pk_mul_f32 v[58:59], v[58:59], v[6:7]
    v_cvt_pk_bf16_f32 v16, v56, v57
    v_cvt_pk_bf16_f32 v17, v58, v59
    v_pk_mul_f32 v[8:9], v[140:141], s[46:47]
    v_pk_mul_f32 v[10:11], v[142:143], s[46:47]
    v_exp_f32 v8, v8
    v_exp_f32 v9, v9
    v_exp_f32 v10, v10
    v_exp_f32 v11, v11
    v_pk_mul_f32 v[60:61], v[60:61], v[140:141]
    v_pk_mul_f32 v[62:63], v[62:63], v[142:143]
    v_pk_add_f32 v[8:9], v[8:9], 1.0 op_sel_hi:[1,0]
    v_pk_add_f32 v[10:11], v[10:11], 1.0 op_sel_hi:[1,0]
    v_rcp_f32 v8, v8
    v_rcp_f32 v9, v9
    v_rcp_f32 v10, v10
    v_rcp_f32 v11, v11
    v_pk_mul_f32 v[60:61], v[60:61], v[8:9]
    v_pk_mul_f32 v[62:63], v[62:63], v[10:11]
    v_cvt_pk_bf16_f32 v18, v60, v61
    v_cvt_pk_bf16_f32 v19, v62, v63
    s_nop 0
    v_permlane32_swap_b32 v16, v18
    v_permlane32_swap_b32 v17, v19
    buffer_store_dwordx4 v[16:19], v1, s[12:15], s39 offen offset:2048 sc0 sc1
    v_lshlrev_b32 v8, 7, v0
    s_lshl_b32 s44, s2, 15
    buffer_load_dword v255, v8, s[68:71], s44 offen
    s_waitcnt lgkmcnt(0)
    ds_read_b128 a[32:35], v245 offset:3584
    ds_read_b64 a[0:1], v244 offset:0
    ds_read_b64 a[2:3], v244 offset:8
    ds_read_b128 a[36:39], v245 offset:3072
    ds_read_b64 a[4:5], v244 offset:512
    ds_read_b64 a[6:7], v244 offset:520
    ds_read_b128 a[40:43], v245 offset:2560
    ds_read_b64 a[8:9], v244 offset:1024
    ds_read_b64 a[10:11], v244 offset:1032
    ds_read_b128 a[44:47], v245 offset:2048
    ds_read_b64 a[12:13], v244 offset:1536
    ds_read_b64 a[14:15], v244 offset:1544
    s_waitcnt lgkmcnt(9)
    v_mfma_f32_16x16x32_bf16 v[32:35], v[246:249], a[32:35], 0
    v_mfma_f32_16x16x32_bf16 v[32:35], a[0:3], a[32:35], v[32:35]
    ds_read_b128 a[48:51], v245 offset:1536
    s_waitcnt lgkmcnt(9)
    v_mfma_f32_16x16x32_bf16 v[36:39], v[246:249], a[36:39], 0
    v_mfma_f32_16x16x32_bf16 v[36:39], a[0:3], a[36:39], v[36:39]
    ds_read_b64 a[16:17], v244 offset:2048
    s_waitcnt lgkmcnt(8)
    v_mfma_f32_16x16x32_bf16 v[36:39], a[4:7], a[32:35], v[36:39]
    ds_read_b64 a[18:19], v244 offset:2056
    v_mfma_f32_16x16x32_bf16 v[40:43], a[4:7], a[36:39], 0
    ds_read_b128 a[52:55], v245 offset:1024
    s_waitcnt lgkmcnt(9)
    v_mfma_f32_16x16x32_bf16 v[40:43], v[246:249], a[40:43], v[40:43]
    v_mfma_f32_16x16x32_bf16 v[40:43], a[0:3], a[40:43], v[40:43]
    ds_read_b64 a[20:21], v244 offset:2560
    v_mfma_f32_16x16x32_bf16 v[44:47], a[4:7], a[40:43], 0
    ds_read_b64 a[22:23], v244 offset:2568
    s_waitcnt lgkmcnt(9)
    v_mfma_f32_16x16x32_bf16 v[40:43], a[8:11], a[32:35], v[40:43]
    ds_read_b128 a[56:59], v245 offset:512
    v_mfma_f32_16x16x32_bf16 v[44:47], a[8:11], a[36:39], v[44:47]
    ds_read_b64 a[24:25], v244 offset:3072
    v_mfma_f32_16x16x32_bf16 v[48:51], a[8:11], a[40:43], 0
    ds_read_b64 a[26:27], v244 offset:3080
    s_waitcnt lgkmcnt(11)
    v_mfma_f32_16x16x32_bf16 v[44:47], v[246:249], a[44:47], v[44:47]
    v_mfma_f32_16x16x32_bf16 v[44:47], a[0:3], a[44:47], v[44:47]
    ds_read_b128 a[60:63], v245 offset:0
    v_mfma_f32_16x16x32_bf16 v[48:51], a[4:7], a[44:47], v[48:51]
    ds_read_b64 a[28:29], v244 offset:3584
    v_mfma_f32_16x16x32_bf16 v[52:55], a[8:11], a[44:47], 0
    ds_read_b64 a[30:31], v244 offset:3592
    s_waitcnt lgkmcnt(12)
    v_mfma_f32_16x16x32_bf16 v[44:47], a[12:15], a[32:35], v[44:47]
    ds_read_b128 a[96:99], v245 offset:3648
    v_mfma_f32_16x16x32_bf16 v[48:51], a[12:15], a[36:39], v[48:51]
    ds_read_b64 a[64:65], v244 offset:64
    v_mfma_f32_16x16x32_bf16 v[52:55], a[12:15], a[40:43], v[52:55]
    ds_read_b64 a[66:67], v244 offset:72
    s_waitcnt lgkmcnt(8)
    v_mfma_f32_16x16x32_bf16 v[56:59], a[12:15], a[44:47], 0
    ds_read_b128 a[100:103], v245 offset:3136
    v_mfma_f32_16x16x32_bf16 v[48:51], v[246:249], a[48:51], v[48:51]
    v_mfma_f32_16x16x32_bf16 v[48:51], a[0:3], a[48:51], v[48:51]
    ds_read_b64 a[68:69], v244 offset:576
    v_mfma_f32_16x16x32_bf16 v[52:55], a[4:7], a[48:51], v[52:55]
    ds_read_b64 a[70:71], v244 offset:584
    v_mfma_f32_16x16x32_bf16 v[56:59], a[8:11], a[48:51], v[56:59]
    ds_read_b128 a[104:107], v245 offset:2624
    v_mfma_f32_16x16x32_bf16 v[60:63], a[12:15], a[48:51], 0
    ds_read_b64 a[72:73], v244 offset:1088
    v_mfma_f32_16x16x32_bf16 v[48:51], a[16:19], a[32:35], v[48:51]
    ds_read_b64 a[74:75], v244 offset:1096
    v_mfma_f32_16x16x32_bf16 v[52:55], a[16:19], a[36:39], v[52:55]
    ds_read_b128 a[108:111], v245 offset:2112
    s_waitcnt lgkmcnt(8)
    v_mfma_f32_16x16x32_bf16 v[56:59], a[16:19], a[40:43], v[56:59]
    ds_read_b64 a[76:77], v244 offset:1600
    v_mfma_f32_16x16x32_bf16 v[60:63], a[16:19], a[44:47], v[60:63]
    ds_read_b64 a[78:79], v244 offset:1608
    v_mfma_f32_16x16x32_bf16 v[52:55], v[246:249], a[52:55], v[52:55]
    v_mfma_f32_16x16x32_bf16 v[52:55], a[0:3], a[52:55], v[52:55]
    v_mfma_f32_16x16x32_bf16 v[56:59], a[4:7], a[52:55], v[56:59]
    v_mfma_f32_16x16x32_bf16 v[60:63], a[8:11], a[52:55], v[60:63]
    v_mfma_f32_16x16x32_bf16 v[52:55], a[20:23], a[32:35], v[52:55]
    v_mfma_f32_16x16x32_bf16 v[56:59], a[20:23], a[36:39], v[56:59]
    v_mfma_f32_16x16x32_bf16 v[60:63], a[20:23], a[40:43], v[60:63]
    v_mfma_f32_16x16x32_bf16 v[56:59], v[246:249], a[56:59], v[56:59]
    v_mfma_f32_16x16x32_bf16 v[56:59], a[0:3], a[56:59], v[56:59]
    v_mfma_f32_16x16x32_bf16 v[60:63], a[4:7], a[56:59], v[60:63]
    v_mfma_f32_16x16x32_bf16 v[56:59], a[24:27], a[32:35], v[56:59]
    v_mfma_f32_16x16x32_bf16 v[60:63], a[24:27], a[36:39], v[60:63]
    v_mfma_f32_16x16x32_bf16 v[60:63], v[246:249], a[60:63], v[60:63]
    v_mfma_f32_16x16x32_bf16 v[60:63], a[0:3], a[60:63], v[60:63]
    v_mfma_f32_16x16x32_bf16 v[60:63], a[28:31], a[32:35], v[60:63]
    s_waitcnt lgkmcnt(9)
    v_mfma_f32_16x16x32_bf16 v[32:35], a[64:67], a[96:99], v[32:35]
    ds_read_b128 a[112:115], v245 offset:1600
    s_waitcnt lgkmcnt(9)
    v_mfma_f32_16x16x32_bf16 v[36:39], a[64:67], a[100:103], v[36:39]
    ds_read_b64 a[80:81], v244 offset:2112
    s_waitcnt lgkmcnt(8)
    v_mfma_f32_16x16x32_bf16 v[36:39], a[68:71], a[96:99], v[36:39]
    ds_read_b64 a[82:83], v244 offset:2120
    v_mfma_f32_16x16x32_bf16 v[40:43], a[68:71], a[100:103], v[40:43]
    ds_read_b128 a[116:119], v245 offset:1088
    s_waitcnt lgkmcnt(9)
    v_mfma_f32_16x16x32_bf16 v[40:43], a[64:67], a[104:107], v[40:43]
    ds_read_b64 a[84:85], v244 offset:2624
    v_mfma_f32_16x16x32_bf16 v[44:47], a[68:71], a[104:107], v[44:47]
    ds_read_b64 a[86:87], v244 offset:2632
    s_waitcnt lgkmcnt(9)
    v_mfma_f32_16x16x32_bf16 v[40:43], a[72:75], a[96:99], v[40:43]
    ds_read_b128 a[120:123], v245 offset:576
    v_mfma_f32_16x16x32_bf16 v[44:47], a[72:75], a[100:103], v[44:47]
    ds_read_b64 a[88:89], v244 offset:3136
    v_mfma_f32_16x16x32_bf16 v[48:51], a[72:75], a[104:107], v[48:51]
    ds_read_b64 a[90:91], v244 offset:3144
    s_waitcnt lgkmcnt(11)
    v_mfma_f32_16x16x32_bf16 v[44:47], a[64:67], a[108:111], v[44:47]
    ds_read_b128 a[124:127], v245 offset:64
    v_mfma_f32_16x16x32_bf16 v[48:51], a[68:71], a[108:111], v[48:51]
    ds_read_b64 a[92:93], v244 offset:3648
    v_mfma_f32_16x16x32_bf16 v[52:55], a[72:75], a[108:111], v[52:55]
    ds_read_b64 a[94:95], v244 offset:3656
    s_waitcnt lgkmcnt(12)
    v_mfma_f32_16x16x32_bf16 v[44:47], a[76:79], a[96:99], v[44:47]
    ds_read_b128 a[32:35], v245 offset:3712
    v_mfma_f32_16x16x32_bf16 v[48:51], a[76:79], a[100:103], v[48:51]
    ds_read_b64 a[0:1], v244 offset:128
    v_mfma_f32_16x16x32_bf16 v[52:55], a[76:79], a[104:107], v[52:55]
    ds_read_b64 a[2:3], v244 offset:136
    s_waitcnt lgkmcnt(8)
    v_mfma_f32_16x16x32_bf16 v[56:59], a[76:79], a[108:111], v[56:59]
    ds_read_b128 a[36:39], v245 offset:3200
    v_mfma_f32_16x16x32_bf16 v[48:51], a[64:67], a[112:115], v[48:51]
    ds_read_b64 a[4:5], v244 offset:640
    v_mfma_f32_16x16x32_bf16 v[52:55], a[68:71], a[112:115], v[52:55]
    ds_read_b64 a[6:7], v244 offset:648
    v_mfma_f32_16x16x32_bf16 v[56:59], a[72:75], a[112:115], v[56:59]
    ds_read_b128 a[40:43], v245 offset:2688
    v_mfma_f32_16x16x32_bf16 v[60:63], a[76:79], a[112:115], v[60:63]
    ds_read_b64 a[8:9], v244 offset:1152
    v_mfma_f32_16x16x32_bf16 v[48:51], a[80:83], a[96:99], v[48:51]
    ds_read_b64 a[10:11], v244 offset:1160
    v_mfma_f32_16x16x32_bf16 v[52:55], a[80:83], a[100:103], v[52:55]
    ds_read_b128 a[44:47], v245 offset:2176
    s_waitcnt lgkmcnt(8)
    v_mfma_f32_16x16x32_bf16 v[56:59], a[80:83], a[104:107], v[56:59]
    ds_read_b64 a[12:13], v244 offset:1664
    v_mfma_f32_16x16x32_bf16 v[60:63], a[80:83], a[108:111], v[60:63]
    ds_read_b64 a[14:15], v244 offset:1672
    v_mfma_f32_16x16x32_bf16 v[52:55], a[64:67], a[116:119], v[52:55]
    v_mfma_f32_16x16x32_bf16 v[56:59], a[68:71], a[116:119], v[56:59]
    v_mfma_f32_16x16x32_bf16 v[60:63], a[72:75], a[116:119], v[60:63]
    v_mfma_f32_16x16x32_bf16 v[52:55], a[84:87], a[96:99], v[52:55]
    v_mfma_f32_16x16x32_bf16 v[56:59], a[84:87], a[100:103], v[56:59]
    v_mfma_f32_16x16x32_bf16 v[60:63], a[84:87], a[104:107], v[60:63]
    v_mfma_f32_16x16x32_bf16 v[56:59], a[64:67], a[120:123], v[56:59]
    v_mfma_f32_16x16x32_bf16 v[60:63], a[68:71], a[120:123], v[60:63]
    v_mfma_f32_16x16x32_bf16 v[56:59], a[88:91], a[96:99], v[56:59]
    v_mfma_f32_16x16x32_bf16 v[60:63], a[88:91], a[100:103], v[60:63]
    v_mfma_f32_16x16x32_bf16 v[60:63], a[64:67], a[124:127], v[60:63]
    v_mfma_f32_16x16x32_bf16 v[60:63], a[92:95], a[96:99], v[60:63]
    s_waitcnt lgkmcnt(9)
    v_mfma_f32_16x16x32_bf16 v[32:35], a[0:3], a[32:35], v[32:35]
    ds_read_b128 a[48:51], v245 offset:1664
    s_waitcnt lgkmcnt(9)
    v_mfma_f32_16x16x32_bf16 v[36:39], a[0:3], a[36:39], v[36:39]
    ds_read_b64 a[16:17], v244 offset:2176
    s_waitcnt lgkmcnt(8)
    v_mfma_f32_16x16x32_bf16 v[36:39], a[4:7], a[32:35], v[36:39]
    ds_read_b64 a[18:19], v244 offset:2184
    v_mfma_f32_16x16x32_bf16 v[40:43], a[4:7], a[36:39], v[40:43]
    ds_read_b128 a[52:55], v245 offset:1152
    s_waitcnt lgkmcnt(9)
    v_mfma_f32_16x16x32_bf16 v[40:43], a[0:3], a[40:43], v[40:43]
    ds_read_b64 a[20:21], v244 offset:2688
    v_mfma_f32_16x16x32_bf16 v[44:47], a[4:7], a[40:43], v[44:47]
    ds_read_b64 a[22:23], v244 offset:2696
    s_waitcnt lgkmcnt(9)
    v_mfma_f32_16x16x32_bf16 v[40:43], a[8:11], a[32:35], v[40:43]
    ds_read_b128 a[56:59], v245 offset:640
    v_mfma_f32_16x16x32_bf16 v[44:47], a[8:11], a[36:39], v[44:47]
    ds_read_b64 a[24:25], v244 offset:3200
    v_mfma_f32_16x16x32_bf16 v[48:51], a[8:11], a[40:43], v[48:51]
    ds_read_b64 a[26:27], v244 offset:3208
    s_waitcnt lgkmcnt(11)
    v_mfma_f32_16x16x32_bf16 v[44:47], a[0:3], a[44:47], v[44:47]
    ds_read_b128 a[60:63], v245 offset:128
    v_mfma_f32_16x16x32_bf16 v[48:51], a[4:7], a[44:47], v[48:51]
    ds_read_b64 a[28:29], v244 offset:3712
    v_mfma_f32_16x16x32_bf16 v[52:55], a[8:11], a[44:47], v[52:55]
    ds_read_b64 a[30:31], v244 offset:3720
    s_waitcnt lgkmcnt(12)
    v_mfma_f32_16x16x32_bf16 v[44:47], a[12:15], a[32:35], v[44:47]
    ds_read_b128 a[96:99], v245 offset:3776
    v_mfma_f32_16x16x32_bf16 v[48:51], a[12:15], a[36:39], v[48:51]
    ds_read_b64 a[64:65], v244 offset:192
    v_mfma_f32_16x16x32_bf16 v[52:55], a[12:15], a[40:43], v[52:55]
    ds_read_b64 a[66:67], v244 offset:200
    s_waitcnt lgkmcnt(8)
    v_mfma_f32_16x16x32_bf16 v[56:59], a[12:15], a[44:47], v[56:59]
    ds_read_b128 a[100:103], v245 offset:3264
    v_mfma_f32_16x16x32_bf16 v[48:51], a[0:3], a[48:51], v[48:51]
    ds_read_b64 a[68:69], v244 offset:704
    v_mfma_f32_16x16x32_bf16 v[52:55], a[4:7], a[48:51], v[52:55]
    ds_read_b64 a[70:71], v244 offset:712
    v_mfma_f32_16x16x32_bf16 v[56:59], a[8:11], a[48:51], v[56:59]
    ds_read_b128 a[104:107], v245 offset:2752
    v_mfma_f32_16x16x32_bf16 v[60:63], a[12:15], a[48:51], v[60:63]
    ds_read_b64 a[72:73], v244 offset:1216
    v_mfma_f32_16x16x32_bf16 v[48:51], a[16:19], a[32:35], v[48:51]
    ds_read_b64 a[74:75], v244 offset:1224
    v_mfma_f32_16x16x32_bf16 v[52:55], a[16:19], a[36:39], v[52:55]
    ds_read_b128 a[108:111], v245 offset:2240
    s_waitcnt lgkmcnt(8)
    v_mfma_f32_16x16x32_bf16 v[56:59], a[16:19], a[40:43], v[56:59]
    ds_read_b64 a[76:77], v244 offset:1728
    v_mfma_f32_16x16x32_bf16 v[60:63], a[16:19], a[44:47], v[60:63]
    ds_read_b64 a[78:79], v244 offset:1736
    v_mfma_f32_16x16x32_bf16 v[52:55], a[0:3], a[52:55], v[52:55]
    v_mfma_f32_16x16x32_bf16 v[56:59], a[4:7], a[52:55], v[56:59]
    v_mfma_f32_16x16x32_bf16 v[60:63], a[8:11], a[52:55], v[60:63]
    v_mfma_f32_16x16x32_bf16 v[52:55], a[20:23], a[32:35], v[52:55]
    v_mfma_f32_16x16x32_bf16 v[56:59], a[20:23], a[36:39], v[56:59]
    v_mfma_f32_16x16x32_bf16 v[60:63], a[20:23], a[40:43], v[60:63]
    v_mfma_f32_16x16x32_bf16 v[56:59], a[0:3], a[56:59], v[56:59]
    v_mfma_f32_16x16x32_bf16 v[60:63], a[4:7], a[56:59], v[60:63]
    v_mfma_f32_16x16x32_bf16 v[56:59], a[24:27], a[32:35], v[56:59]
    v_mfma_f32_16x16x32_bf16 v[60:63], a[24:27], a[36:39], v[60:63]
    v_mfma_f32_16x16x32_bf16 v[60:63], a[0:3], a[60:63], v[60:63]
    v_mfma_f32_16x16x32_bf16 v[60:63], a[28:31], a[32:35], v[60:63]
    s_waitcnt lgkmcnt(9)
    v_mfma_f32_16x16x32_bf16 v[32:35], a[64:67], a[96:99], v[32:35]
    ds_read_b128 a[112:115], v245 offset:1728
    s_waitcnt lgkmcnt(9)
    v_mfma_f32_16x16x32_bf16 v[36:39], a[64:67], a[100:103], v[36:39]
    ds_read_b64 a[80:81], v244 offset:2240
    s_waitcnt lgkmcnt(8)
    v_mfma_f32_16x16x32_bf16 v[36:39], a[68:71], a[96:99], v[36:39]
    ds_read_b64 a[82:83], v244 offset:2248
    v_mfma_f32_16x16x32_bf16 v[40:43], a[68:71], a[100:103], v[40:43]
    ds_read_b128 a[116:119], v245 offset:1216
    s_waitcnt lgkmcnt(9)
    v_mfma_f32_16x16x32_bf16 v[40:43], a[64:67], a[104:107], v[40:43]
    ds_read_b64 a[84:85], v244 offset:2752
    v_mfma_f32_16x16x32_bf16 v[44:47], a[68:71], a[104:107], v[44:47]
    ds_read_b64 a[86:87], v244 offset:2760
    s_waitcnt lgkmcnt(9)
    v_mfma_f32_16x16x32_bf16 v[40:43], a[72:75], a[96:99], v[40:43]
    ds_read_b128 a[120:123], v245 offset:704
    v_mfma_f32_16x16x32_bf16 v[44:47], a[72:75], a[100:103], v[44:47]
    ds_read_b64 a[88:89], v244 offset:3264
    v_mfma_f32_16x16x32_bf16 v[48:51], a[72:75], a[104:107], v[48:51]
    ds_read_b64 a[90:91], v244 offset:3272
    s_waitcnt lgkmcnt(11)
    v_mfma_f32_16x16x32_bf16 v[44:47], a[64:67], a[108:111], v[44:47]
    ds_read_b128 a[124:127], v245 offset:192
    v_mfma_f32_16x16x32_bf16 v[48:51], a[68:71], a[108:111], v[48:51]
    ds_read_b64 a[92:93], v244 offset:3776
    v_mfma_f32_16x16x32_bf16 v[52:55], a[72:75], a[108:111], v[52:55]
    ds_read_b64 a[94:95], v244 offset:3784
    s_waitcnt lgkmcnt(12)
    v_mfma_f32_16x16x32_bf16 v[44:47], a[76:79], a[96:99], v[44:47]
    ds_read_b128 a[32:35], v245 offset:3840
    v_mfma_f32_16x16x32_bf16 v[48:51], a[76:79], a[100:103], v[48:51]
    ds_read_b64 a[0:1], v244 offset:256
    v_mfma_f32_16x16x32_bf16 v[52:55], a[76:79], a[104:107], v[52:55]
    ds_read_b64 a[2:3], v244 offset:264
    s_waitcnt lgkmcnt(8)
    v_mfma_f32_16x16x32_bf16 v[56:59], a[76:79], a[108:111], v[56:59]
    ds_read_b128 a[36:39], v245 offset:3328
    v_mfma_f32_16x16x32_bf16 v[48:51], a[64:67], a[112:115], v[48:51]
    ds_read_b64 a[4:5], v244 offset:768
    v_mfma_f32_16x16x32_bf16 v[52:55], a[68:71], a[112:115], v[52:55]
    ds_read_b64 a[6:7], v244 offset:776
    v_mfma_f32_16x16x32_bf16 v[56:59], a[72:75], a[112:115], v[56:59]
    ds_read_b128 a[40:43], v245 offset:2816
    v_mfma_f32_16x16x32_bf16 v[60:63], a[76:79], a[112:115], v[60:63]
    ds_read_b64 a[8:9], v244 offset:1280
    v_mfma_f32_16x16x32_bf16 v[48:51], a[80:83], a[96:99], v[48:51]
    ds_read_b64 a[10:11], v244 offset:1288
    v_mfma_f32_16x16x32_bf16 v[52:55], a[80:83], a[100:103], v[52:55]
    ds_read_b128 a[44:47], v245 offset:2304
    s_waitcnt lgkmcnt(8)
    v_mfma_f32_16x16x32_bf16 v[56:59], a[80:83], a[104:107], v[56:59]
    ds_read_b64 a[12:13], v244 offset:1792
    v_mfma_f32_16x16x32_bf16 v[60:63], a[80:83], a[108:111], v[60:63]
    ds_read_b64 a[14:15], v244 offset:1800
    v_mfma_f32_16x16x32_bf16 v[52:55], a[64:67], a[116:119], v[52:55]
    s_add_u32 m0, s27, 65536
    v_mfma_f32_16x16x32_bf16 v[56:59], a[68:71], a[116:119], v[56:59]
    buffer_load_dwordx4 v226, s[68:71], s25 offen lds
    v_mfma_f32_16x16x32_bf16 v[60:63], a[72:75], a[116:119], v[60:63]
    s_add_u32 m0, s27, 66560
    v_mfma_f32_16x16x32_bf16 v[52:55], a[84:87], a[96:99], v[52:55]
    buffer_load_dwordx4 v227, s[68:71], s25 offen lds
    s_add_u32 s25, s25, 0x10000
    v_mfma_f32_16x16x32_bf16 v[56:59], a[84:87], a[100:103], v[56:59]
    s_add_u32 m0, s27, 73728
    v_mfma_f32_16x16x32_bf16 v[60:63], a[84:87], a[104:107], v[60:63]
    buffer_load_dwordx4 v226, s[68:71], s25 offen lds
    v_mfma_f32_16x16x32_bf16 v[56:59], a[64:67], a[120:123], v[56:59]
    s_add_u32 m0, s27, 74752
    s_waitcnt vmcnt(4)
    s_lshl_b32 s44, s33, 2
    s_add_u32 s44, s44, s32
    s_lshl_b32 s44, s44, 5
    s_add_u32 s44, s44, s34
    s_lshl_b32 s44, s44, 7
    s_add_u32 s44, s44, 0x1820000
    v_mov_b32 v8, s60
    v_mov_b32 v9, 0
    s_mov_b64 exec, 1
    buffer_store_dword v8, v9, s[12:15], s44 offen sc0 sc1
    s_mov_b64 exec, -1
    v_mfma_f32_16x16x32_bf16 v[60:63], a[68:71], a[120:123], v[60:63]
    buffer_load_dwordx4 v227, s[68:71], s25 offen lds
    s_add_u32 s25, s25, 0x10000
    v_mfma_f32_16x16x32_bf16 v[56:59], a[88:91], a[96:99], v[56:59]
    s_add_u32 m0, s27, 81920
    v_mfma_f32_16x16x32_bf16 v[60:63], a[88:91], a[100:103], v[60:63]
    buffer_load_dwordx4 v226, s[68:71], s25 offen lds
    v_mfma_f32_16x16x32_bf16 v[60:63], a[64:67], a[124:127], v[60:63]
    s_add_u32 m0, s27, 82944
    v_mfma_f32_16x16x32_bf16 v[60:63], a[92:95], a[96:99], v[60:63]
    buffer_load_dwordx4 v227, s[68:71], s25 offen lds
    s_add_u32 s25, s25, 0x10000
    s_waitcnt lgkmcnt(9)
    v_mfma_f32_16x16x32_bf16 v[32:35], a[0:3], a[32:35], v[32:35]
    ds_read_b128 a[48:51], v245 offset:1792
    s_waitcnt lgkmcnt(9)
    v_mfma_f32_16x16x32_bf16 v[36:39], a[0:3], a[36:39], v[36:39]
    ds_read_b64 a[16:17], v244 offset:2304
    s_waitcnt lgkmcnt(8)
    v_mfma_f32_16x16x32_bf16 v[36:39], a[4:7], a[32:35], v[36:39]
    ds_read_b64 a[18:19], v244 offset:2312
    v_mfma_f32_16x16x32_bf16 v[40:43], a[4:7], a[36:39], v[40:43]
    ds_read_b128 a[52:55], v245 offset:1280
    s_waitcnt lgkmcnt(9)
    v_mfma_f32_16x16x32_bf16 v[40:43], a[0:3], a[40:43], v[40:43]
    ds_read_b64 a[20:21], v244 offset:2816
    v_mfma_f32_16x16x32_bf16 v[44:47], a[4:7], a[40:43], v[44:47]
    ds_read_b64 a[22:23], v244 offset:2824
    s_waitcnt lgkmcnt(9)
    v_mfma_f32_16x16x32_bf16 v[40:43], a[8:11], a[32:35], v[40:43]
    ds_read_b128 a[56:59], v245 offset:768
    v_mfma_f32_16x16x32_bf16 v[44:47], a[8:11], a[36:39], v[44:47]
    ds_read_b64 a[24:25], v244 offset:3328
    v_mfma_f32_16x16x32_bf16 v[48:51], a[8:11], a[40:43], v[48:51]
    ds_read_b64 a[26:27], v244 offset:3336
    s_waitcnt lgkmcnt(11)
    v_mfma_f32_16x16x32_bf16 v[44:47], a[0:3], a[44:47], v[44:47]
    ds_read_b128 a[60:63], v245 offset:256
    v_mfma_f32_16x16x32_bf16 v[48:51], a[4:7], a[44:47], v[48:51]
    ds_read_b64 a[28:29], v244 offset:3840
    v_mfma_f32_16x16x32_bf16 v[52:55], a[8:11], a[44:47], v[52:55]
    ds_read_b64 a[30:31], v244 offset:3848
    s_waitcnt lgkmcnt(12)
    v_mfma_f32_16x16x32_bf16 v[44:47], a[12:15], a[32:35], v[44:47]
    ds_read_b128 a[96:99], v245 offset:3904
    v_mfma_f32_16x16x32_bf16 v[48:51], a[12:15], a[36:39], v[48:51]
    ds_read_b64 a[64:65], v244 offset:320
    v_mfma_f32_16x16x32_bf16 v[52:55], a[12:15], a[40:43], v[52:55]
    ds_read_b64 a[66:67], v244 offset:328
    s_waitcnt lgkmcnt(8)
    v_mfma_f32_16x16x32_bf16 v[56:59], a[12:15], a[44:47], v[56:59]
    ds_read_b128 a[100:103], v245 offset:3392
    v_mfma_f32_16x16x32_bf16 v[48:51], a[0:3], a[48:51], v[48:51]
    ds_read_b64 a[68:69], v244 offset:832
    v_mfma_f32_16x16x32_bf16 v[52:55], a[4:7], a[48:51], v[52:55]
    ds_read_b64 a[70:71], v244 offset:840
    v_mfma_f32_16x16x32_bf16 v[56:59], a[8:11], a[48:51], v[56:59]
    ds_read_b128 a[104:107], v245 offset:2880
    v_mfma_f32_16x16x32_bf16 v[60:63], a[12:15], a[48:51], v[60:63]
    ds_read_b64 a[72:73], v244 offset:1344
    v_mfma_f32_16x16x32_bf16 v[48:51], a[16:19], a[32:35], v[48:51]
    ds_read_b64 a[74:75], v244 offset:1352
    v_mfma_f32_16x16x32_bf16 v[52:55], a[16:19], a[36:39], v[52:55]
    ds_read_b128 a[108:111], v245 offset:2368
    s_waitcnt lgkmcnt(8)
    v_mfma_f32_16x16x32_bf16 v[56:59], a[16:19], a[40:43], v[56:59]
    ds_read_b64 a[76:77], v244 offset:1856
    v_mfma_f32_16x16x32_bf16 v[60:63], a[16:19], a[44:47], v[60:63]
    ds_read_b64 a[78:79], v244 offset:1864
    v_mfma_f32_16x16x32_bf16 v[52:55], a[0:3], a[52:55], v[52:55]
    s_add_u32 m0, s27, 90112
    s_add_u32 s28, s25, s26
    v_mfma_f32_16x16x32_bf16 v[56:59], a[4:7], a[52:55], v[56:59]
    buffer_load_dwordx4 v226, s[68:71], s28 offen lds
    v_mfma_f32_16x16x32_bf16 v[60:63], a[8:11], a[52:55], v[60:63]
    s_add_u32 m0, s27, 91136
    v_mfma_f32_16x16x32_bf16 v[52:55], a[20:23], a[32:35], v[52:55]
    buffer_load_dwordx4 v227, s[68:71], s28 offen lds
    s_add_u32 s25, s25, 0x10000
    v_mfma_f32_16x16x32_bf16 v[56:59], a[20:23], a[36:39], v[56:59]
    s_add_u32 m0, s27, 98304
    v_mfma_f32_16x16x32_bf16 v[60:63], a[20:23], a[40:43], v[60:63]
    buffer_load_dwordx4 v226, s[68:71], s25 offen lds
    v_mfma_f32_16x16x32_bf16 v[56:59], a[0:3], a[56:59], v[56:59]
    s_add_u32 m0, s27, 99328
    v_mfma_f32_16x16x32_bf16 v[60:63], a[4:7], a[56:59], v[60:63]
    buffer_load_dwordx4 v227, s[68:71], s25 offen lds
    s_add_u32 s25, s25, 0x10000
    v_mfma_f32_16x16x32_bf16 v[56:59], a[24:27], a[32:35], v[56:59]
    s_add_u32 m0, s27, 106496
    v_mfma_f32_16x16x32_bf16 v[60:63], a[24:27], a[36:39], v[60:63]
    buffer_load_dwordx4 v226, s[68:71], s25 offen lds
    v_mfma_f32_16x16x32_bf16 v[60:63], a[0:3], a[60:63], v[60:63]
    s_add_u32 m0, s27, 107520
    v_mfma_f32_16x16x32_bf16 v[60:63], a[28:31], a[32:35], v[60:63]
    buffer_load_dwordx4 v227, s[68:71], s25 offen lds
    s_add_u32 s25, s25, 0x10000
    s_waitcnt lgkmcnt(9)
    v_mfma_f32_16x16x32_bf16 v[32:35], a[64:67], a[96:99], v[32:35]
    ds_read_b128 a[112:115], v245 offset:1856
    s_waitcnt lgkmcnt(9)
    v_mfma_f32_16x16x32_bf16 v[36:39], a[64:67], a[100:103], v[36:39]
    ds_read_b64 a[80:81], v244 offset:2368
    s_waitcnt lgkmcnt(8)
    v_mfma_f32_16x16x32_bf16 v[36:39], a[68:71], a[96:99], v[36:39]
    ds_read_b64 a[82:83], v244 offset:2376
    v_mfma_f32_16x16x32_bf16 v[40:43], a[68:71], a[100:103], v[40:43]
    ds_read_b128 a[116:119], v245 offset:1344
    s_waitcnt lgkmcnt(9)
    v_mfma_f32_16x16x32_bf16 v[40:43], a[64:67], a[104:107], v[40:43]
    ds_read_b64 a[84:85], v244 offset:2880
    v_mfma_f32_16x16x32_bf16 v[44:47], a[68:71], a[104:107], v[44:47]
    ds_read_b64 a[86:87], v244 offset:2888
    s_waitcnt lgkmcnt(9)
    v_mfma_f32_16x16x32_bf16 v[40:43], a[72:75], a[96:99], v[40:43]
    ds_read_b128 a[120:123], v245 offset:832
    v_mfma_f32_16x16x32_bf16 v[44:47], a[72:75], a[100:103], v[44:47]
    ds_read_b64 a[88:89], v244 offset:3392
    v_mfma_f32_16x16x32_bf16 v[48:51], a[72:75], a[104:107], v[48:51]
    ds_read_b64 a[90:91], v244 offset:3400
    s_waitcnt lgkmcnt(11)
    v_mfma_f32_16x16x32_bf16 v[44:47], a[64:67], a[108:111], v[44:47]
    ds_read_b128 a[124:127], v245 offset:320
    v_mfma_f32_16x16x32_bf16 v[48:51], a[68:71], a[108:111], v[48:51]
    ds_read_b64 a[92:93], v244 offset:3904
    v_mfma_f32_16x16x32_bf16 v[52:55], a[72:75], a[108:111], v[52:55]
    ds_read_b64 a[94:95], v244 offset:3912
    s_waitcnt lgkmcnt(12)
    v_mfma_f32_16x16x32_bf16 v[44:47], a[76:79], a[96:99], v[44:47]
    ds_read_b128 a[32:35], v245 offset:3968
    v_mfma_f32_16x16x32_bf16 v[48:51], a[76:79], a[100:103], v[48:51]
    ds_read_b64 a[0:1], v244 offset:384
    v_mfma_f32_16x16x32_bf16 v[52:55], a[76:79], a[104:107], v[52:55]
    ds_read_b64 a[2:3], v244 offset:392
    s_waitcnt lgkmcnt(8)
    v_mfma_f32_16x16x32_bf16 v[56:59], a[76:79], a[108:111], v[56:59]
    ds_read_b128 a[36:39], v245 offset:3456
    v_mfma_f32_16x16x32_bf16 v[48:51], a[64:67], a[112:115], v[48:51]
    ds_read_b64 a[4:5], v244 offset:896
    v_mfma_f32_16x16x32_bf16 v[52:55], a[68:71], a[112:115], v[52:55]
    ds_read_b64 a[6:7], v244 offset:904
    v_mfma_f32_16x16x32_bf16 v[56:59], a[72:75], a[112:115], v[56:59]
    ds_read_b128 a[40:43], v245 offset:2944
    v_mfma_f32_16x16x32_bf16 v[60:63], a[76:79], a[112:115], v[60:63]
    ds_read_b64 a[8:9], v244 offset:1408
    v_mfma_f32_16x16x32_bf16 v[48:51], a[80:83], a[96:99], v[48:51]
    ds_read_b64 a[10:11], v244 offset:1416
    v_mfma_f32_16x16x32_bf16 v[52:55], a[80:83], a[100:103], v[52:55]
    ds_read_b128 a[44:47], v245 offset:2432
    s_waitcnt lgkmcnt(8)
    v_mfma_f32_16x16x32_bf16 v[56:59], a[80:83], a[104:107], v[56:59]
    ds_read_b64 a[12:13], v244 offset:1920
    v_mfma_f32_16x16x32_bf16 v[60:63], a[80:83], a[108:111], v[60:63]
    ds_read_b64 a[14:15], v244 offset:1928
    v_mfma_f32_16x16x32_bf16 v[52:55], a[64:67], a[116:119], v[52:55]
    v_mfma_f32_16x16x32_bf16 v[56:59], a[68:71], a[116:119], v[56:59]
    v_mfma_f32_16x16x32_bf16 v[60:63], a[72:75], a[116:119], v[60:63]
    v_mfma_f32_16x16x32_bf16 v[52:55], a[84:87], a[96:99], v[52:55]
    v_mfma_f32_16x16x32_bf16 v[56:59], a[84:87], a[100:103], v[56:59]
    v_mfma_f32_16x16x32_bf16 v[60:63], a[84:87], a[104:107], v[60:63]
    v_mfma_f32_16x16x32_bf16 v[56:59], a[64:67], a[120:123], v[56:59]
    v_mfma_f32_16x16x32_bf16 v[60:63], a[68:71], a[120:123], v[60:63]
    v_mfma_f32_16x16x32_bf16 v[56:59], a[88:91], a[96:99], v[56:59]
    v_mfma_f32_16x16x32_bf16 v[60:63], a[88:91], a[100:103], v[60:63]
    v_mfma_f32_16x16x32_bf16 v[60:63], a[64:67], a[124:127], v[60:63]
    v_mfma_f32_16x16x32_bf16 v[60:63], a[92:95], a[96:99], v[60:63]
    s_waitcnt lgkmcnt(9)
    v_mfma_f32_16x16x32_bf16 v[32:35], a[0:3], a[32:35], v[32:35]
    ds_read_b128 a[48:51], v245 offset:1920
    s_waitcnt lgkmcnt(9)
    v_mfma_f32_16x16x32_bf16 v[36:39], a[0:3], a[36:39], v[36:39]
    ds_read_b64 a[16:17], v244 offset:2432
    s_waitcnt lgkmcnt(8)
    v_mfma_f32_16x16x32_bf16 v[36:39], a[4:7], a[32:35], v[36:39]
    ds_read_b64 a[18:19], v244 offset:2440
    v_mfma_f32_16x16x32_bf16 v[40:43], a[4:7], a[36:39], v[40:43]
    ds_read_b128 a[52:55], v245 offset:1408
    s_waitcnt lgkmcnt(9)
    v_mfma_f32_16x16x32_bf16 v[40:43], a[0:3], a[40:43], v[40:43]
    ds_read_b64 a[20:21], v244 offset:2944
    v_mfma_f32_16x16x32_bf16 v[44:47], a[4:7], a[40:43], v[44:47]
    ds_read_b64 a[22:23], v244 offset:2952
    s_waitcnt lgkmcnt(9)
    v_mfma_f32_16x16x32_bf16 v[40:43], a[8:11], a[32:35], v[40:43]
    ds_read_b128 a[56:59], v245 offset:896
    v_mfma_f32_16x16x32_bf16 v[44:47], a[8:11], a[36:39], v[44:47]
    ds_read_b64 a[24:25], v244 offset:3456
    v_mfma_f32_16x16x32_bf16 v[48:51], a[8:11], a[40:43], v[48:51]
    ds_read_b64 a[26:27], v244 offset:3464
    s_waitcnt lgkmcnt(11)
    v_mfma_f32_16x16x32_bf16 v[44:47], a[0:3], a[44:47], v[44:47]
    ds_read_b128 a[60:63], v245 offset:384
    v_mfma_f32_16x16x32_bf16 v[48:51], a[4:7], a[44:47], v[48:51]
    ds_read_b64 a[28:29], v244 offset:3968
    v_mfma_f32_16x16x32_bf16 v[52:55], a[8:11], a[44:47], v[52:55]
    ds_read_b64 a[30:31], v244 offset:3976
    s_waitcnt lgkmcnt(12)
    v_mfma_f32_16x16x32_bf16 v[44:47], a[12:15], a[32:35], v[44:47]
    ds_read_b128 a[96:99], v245 offset:4032
    v_mfma_f32_16x16x32_bf16 v[48:51], a[12:15], a[36:39], v[48:51]
    ds_read_b64 a[64:65], v244 offset:448
    v_mfma_f32_16x16x32_bf16 v[52:55], a[12:15], a[40:43], v[52:55]
    ds_read_b64 a[66:67], v244 offset:456
    s_waitcnt lgkmcnt(8)
    v_mfma_f32_16x16x32_bf16 v[56:59], a[12:15], a[44:47], v[56:59]
    ds_read_b128 a[100:103], v245 offset:3520
    v_mfma_f32_16x16x32_bf16 v[48:51], a[0:3], a[48:51], v[48:51]
    ds_read_b64 a[68:69], v244 offset:960
    v_mfma_f32_16x16x32_bf16 v[52:55], a[4:7], a[48:51], v[52:55]
    ds_read_b64 a[70:71], v244 offset:968
    v_mfma_f32_16x16x32_bf16 v[56:59], a[8:11], a[48:51], v[56:59]
    ds_read_b128 a[104:107], v245 offset:3008
    v_mfma_f32_16x16x32_bf16 v[60:63], a[12:15], a[48:51], v[60:63]
    ds_read_b64 a[72:73], v244 offset:1472
    v_mfma_f32_16x16x32_bf16 v[48:51], a[16:19], a[32:35], v[48:51]
    ds_read_b64 a[74:75], v244 offset:1480
    v_mfma_f32_16x16x32_bf16 v[52:55], a[16:19], a[36:39], v[52:55]
    ds_read_b128 a[108:111], v245 offset:2496
    s_waitcnt lgkmcnt(8)
    v_mfma_f32_16x16x32_bf16 v[56:59], a[16:19], a[40:43], v[56:59]
    ds_read_b64 a[76:77], v244 offset:1984
    v_mfma_f32_16x16x32_bf16 v[60:63], a[16:19], a[44:47], v[60:63]
    ds_read_b64 a[78:79], v244 offset:1992
    v_mfma_f32_16x16x32_bf16 v[52:55], a[0:3], a[52:55], v[52:55]
    v_mfma_f32_16x16x32_bf16 v[56:59], a[4:7], a[52:55], v[56:59]
    v_mfma_f32_16x16x32_bf16 v[60:63], a[8:11], a[52:55], v[60:63]
    v_mfma_f32_16x16x32_bf16 v[52:55], a[20:23], a[32:35], v[52:55]
    v_mfma_f32_16x16x32_bf16 v[56:59], a[20:23], a[36:39], v[56:59]
    v_mfma_f32_16x16x32_bf16 v[60:63], a[20:23], a[40:43], v[60:63]
    v_mfma_f32_16x16x32_bf16 v[56:59], a[0:3], a[56:59], v[56:59]
    v_mfma_f32_16x16x32_bf16 v[60:63], a[4:7], a[56:59], v[60:63]
    v_mfma_f32_16x16x32_bf16 v[56:59], a[24:27], a[32:35], v[56:59]
    v_mfma_f32_16x16x32_bf16 v[60:63], a[24:27], a[36:39], v[60:63]
    v_mfma_f32_16x16x32_bf16 v[60:63], a[0:3], a[60:63], v[60:63]
    v_mfma_f32_16x16x32_bf16 v[60:63], a[28:31], a[32:35], v[60:63]
    s_waitcnt lgkmcnt(9)
    v_mfma_f32_16x16x32_bf16 v[32:35], a[64:67], a[96:99], v[32:35]
    ds_read_b128 a[112:115], v245 offset:1984
    s_waitcnt lgkmcnt(9)
    v_mfma_f32_16x16x32_bf16 v[36:39], a[64:67], a[100:103], v[36:39]
    ds_read_b64 a[80:81], v244 offset:2496
    s_waitcnt lgkmcnt(8)
    v_mfma_f32_16x16x32_bf16 v[36:39], a[68:71], a[96:99], v[36:39]
    ds_read_b64 a[82:83], v244 offset:2504
    v_mfma_f32_16x16x32_bf16 v[40:43], a[68:71], a[100:103], v[40:43]
    ds_read_b128 a[116:119], v245 offset:1472
    s_waitcnt lgkmcnt(9)
    v_mfma_f32_16x16x32_bf16 v[40:43], a[64:67], a[104:107], v[40:43]
    ds_read_b64 a[84:85], v244 offset:3008
    buffer_load_dword v251, v250, s[12:15], s55 offen sc1
    v_mfma_f32_16x16x32_bf16 v[44:47], a[68:71], a[104:107], v[44:47]
    ds_read_b64 a[86:87], v244 offset:3016
    s_waitcnt lgkmcnt(9)
    v_mfma_f32_16x16x32_bf16 v[40:43], a[72:75], a[96:99], v[40:43]
    ds_read_b128 a[120:123], v245 offset:960
    v_mfma_f32_16x16x32_bf16 v[44:47], a[72:75], a[100:103], v[44:47]
    ds_read_b64 a[88:89], v244 offset:3520
    v_mfma_f32_16x16x32_bf16 v[48:51], a[72:75], a[104:107], v[48:51]
    ds_read_b64 a[90:91], v244 offset:3528
    s_waitcnt lgkmcnt(11)
    v_mfma_f32_16x16x32_bf16 v[44:47], a[64:67], a[108:111], v[44:47]
    ds_read_b128 a[124:127], v245 offset:448
    v_mfma_f32_16x16x32_bf16 v[48:51], a[68:71], a[108:111], v[48:51]
    ds_read_b64 a[92:93], v244 offset:4032
    v_mfma_f32_16x16x32_bf16 v[52:55], a[72:75], a[108:111], v[52:55]
    ds_read_b64 a[94:95], v244 offset:4040
    s_waitcnt lgkmcnt(12)
    v_mfma_f32_16x16x32_bf16 v[44:47], a[76:79], a[96:99], v[44:47]
    v_mfma_f32_16x16x32_bf16 v[48:51], a[76:79], a[100:103], v[48:51]
    v_mfma_f32_16x16x32_bf16 v[52:55], a[76:79], a[104:107], v[52:55]
    v_mfma_f32_16x16x32_bf16 v[56:59], a[76:79], a[108:111], v[56:59]
    s_waitcnt lgkmcnt(11)
    v_mfma_f32_16x16x32_bf16 v[48:51], a[64:67], a[112:115], v[48:51]
    v_mfma_f32_16x16x32_bf16 v[52:55], a[68:71], a[112:115], v[52:55]
    v_mfma_f32_16x16x32_bf16 v[56:59], a[72:75], a[112:115], v[56:59]
    v_mfma_f32_16x16x32_bf16 v[60:63], a[76:79], a[112:115], v[60:63]
    s_waitcnt lgkmcnt(9)
    v_mfma_f32_16x16x32_bf16 v[48:51], a[80:83], a[96:99], v[48:51]
    s_waitcnt vmcnt(0)
    v_cmp_ne_u32 vcc, s60, v251
    s_cbranch_vccnz L_hpoll_spin
L_hpoll_ok:
    buffer_load_dwordx4 a[128:131], v26, s[12:15], s24 offen offset:0 sc1
    v_mfma_f32_16x16x32_bf16 v[52:55], a[80:83], a[100:103], v[52:55]
    buffer_load_dwordx4 a[132:135], v26, s[12:15], s24 offen offset:1024 sc1
    s_add_u32 s24, s24, 0x20000
    v_mfma_f32_16x16x32_bf16 v[56:59], a[80:83], a[104:107], v[56:59]
    buffer_load_dwordx4 a[136:139], v26, s[12:15], s24 offen offset:0 sc1
    v_mfma_f32_16x16x32_bf16 v[60:63], a[80:83], a[108:111], v[60:63]
    buffer_load_dwordx4 a[140:143], v26, s[12:15], s24 offen offset:1024 sc1
    s_add_u32 s24, s24, 0x20000
    s_waitcnt lgkmcnt(8)
    v_mfma_f32_16x16x32_bf16 v[52:55], a[64:67], a[116:119], v[52:55]
    buffer_load_dwordx4 a[144:147], v26, s[12:15], s24 offen offset:0 sc1
    v_mfma_f32_16x16x32_bf16 v[56:59], a[68:71], a[116:119], v[56:59]
    buffer_load_dwordx4 a[148:151], v26, s[12:15], s24 offen offset:1024 sc1
    s_add_u32 s24, s24, 0x20000
    v_mfma_f32_16x16x32_bf16 v[60:63], a[72:75], a[116:119], v[60:63]
    buffer_load_dwordx4 a[152:155], v26, s[12:15], s24 offen offset:0 sc1
    s_waitcnt lgkmcnt(6)
    v_mfma_f32_16x16x32_bf16 v[52:55], a[84:87], a[96:99], v[52:55]
    buffer_load_dwordx4 a[156:159], v26, s[12:15], s24 offen offset:1024 sc1
    s_add_u32 s24, s24, 0x20000
    v_mfma_f32_16x16x32_bf16 v[56:59], a[84:87], a[100:103], v[56:59]
    buffer_load_dwordx4 a[160:163], v26, s[12:15], s24 offen offset:0 sc1
    v_mfma_f32_16x16x32_bf16 v[60:63], a[84:87], a[104:107], v[60:63]
    buffer_load_dwordx4 a[164:167], v26, s[12:15], s24 offen offset:1024 sc1
    s_add_u32 s24, s24, 0x20000
    s_waitcnt lgkmcnt(5)
    v_mfma_f32_16x16x32_bf16 v[56:59], a[64:67], a[120:123], v[56:59]
    buffer_load_dwordx4 a[168:171], v26, s[12:15], s24 offen offset:0 sc1
    v_mfma_f32_16x16x32_bf16 v[60:63], a[68:71], a[120:123], v[60:63]
    buffer_load_dwordx4 a[172:175], v26, s[12:15], s24 offen offset:1024 sc1
    s_add_u32 s24, s24, 0x20000
    s_waitcnt lgkmcnt(3)
    v_mfma_f32_16x16x32_bf16 v[56:59], a[88:91], a[96:99], v[56:59]
    buffer_load_dwordx4 a[176:179], v26, s[12:15], s24 offen offset:0 sc1
    v_mfma_f32_16x16x32_bf16 v[60:63], a[88:91], a[100:103], v[60:63]
    buffer_load_dwordx4 a[180:183], v26, s[12:15], s24 offen offset:1024 sc1
    s_add_u32 s24, s24, 0x20000
    s_waitcnt lgkmcnt(2)
    v_mfma_f32_16x16x32_bf16 v[60:63], a[64:67], a[124:127], v[60:63]
    s_waitcnt lgkmcnt(0)
    v_mfma_f32_16x16x32_bf16 v[60:63], a[92:95], a[96:99], v[60:63]
    s_lshl_b32 s44, s56, 10
    s_add_u32 s44, s44, 0x1800000
    buffer_load_dwordx2 v[16:17], v243, s[12:15], s44 offen offset:0 sc1
    buffer_load_dwordx2 v[18:19], v243, s[12:15], s44 offen offset:1024 sc1
    v_and_b32 v11, 15, v2
    v_lshrrev_b32 v12, 4, v2
    v_and_b32 v13, 1, v12
    v_lshlrev_b32 v13, 9, v13
    v_lshl_add_u32 v13, v11, 5, v13
    v_lshrrev_b32 v14, 1, v12
    v_lshl_add_u32 v13, v14, 4, v13
    s_lshl_b32 s44, s31, 12
    s_add_u32 s44, s44, 0x1400000
    v_cvt_pk_bf16_f32 v96, v32, v33
    v_cvt_pk_bf16_f32 v97, v34, v35
    v_cvt_pk_bf16_f32 v98, v36, v37
    v_cvt_pk_bf16_f32 v99, v38, v39
    s_nop 0
    v_permlane16_swap_b32 v96, v98
    v_permlane16_swap_b32 v97, v99
    buffer_store_dwordx4 v[96:99], v13, s[12:15], s44 offen offset:0 sc0 sc1
    v_cvt_pk_bf16_f32 v100, v40, v41
    v_cvt_pk_bf16_f32 v101, v42, v43
    v_cvt_pk_bf16_f32 v102, v44, v45
    v_cvt_pk_bf16_f32 v103, v46, v47
    s_nop 0
    v_permlane16_swap_b32 v100, v102
    v_permlane16_swap_b32 v101, v103
    buffer_store_dwordx4 v[100:103], v13, s[12:15], s44 offen offset:1024 sc0 sc1
    v_cvt_pk_bf16_f32 v104, v48, v49
    v_cvt_pk_bf16_f32 v105, v50, v51
    v_cvt_pk_bf16_f32 v106, v52, v53
    v_cvt_pk_bf16_f32 v107, v54, v55
    s_nop 0
    v_permlane16_swap_b32 v104, v106
    v_permlane16_swap_b32 v105, v107
    buffer_store_dwordx4 v[104:107], v13, s[12:15], s44 offen offset:2048 sc0 sc1
    v_cvt_pk_bf16_f32 v108, v56, v57
    v_cvt_pk_bf16_f32 v109, v58, v59
    v_cvt_pk_bf16_f32 v110, v60, v61
    v_cvt_pk_bf16_f32 v111, v62, v63
    s_nop 0
    v_permlane16_swap_b32 v108, v110
    v_permlane16_swap_b32 v109, v111
    buffer_store_dwordx4 v[108:111], v13, s[12:15], s44 offen offset:3072 sc0 sc1
    s_barrier
    ds_read_b64_tr_b16 a[0:1], v228 offset:0
    ds_read_b64_tr_b16 a[2:3], v228 offset:4096
    ds_read_b64_tr_b16 a[4:5], v229 offset:0
    ds_read_b64_tr_b16 a[6:7], v229 offset:4096
    ds_read_b64_tr_b16 a[8:9], v230 offset:0
    ds_read_b64_tr_b16 a[10:11], v230 offset:4096
    ds_read_b64_tr_b16 a[12:13], v231 offset:0
    ds_read_b64_tr_b16 a[14:15], v231 offset:4096
    ds_read_b64_tr_b16 a[16:17], v232 offset:0
    ds_read_b64_tr_b16 a[18:19], v232 offset:4096
    ds_read_b64_tr_b16 a[20:21], v233 offset:0
    ds_read_b64_tr_b16 a[22:23], v233 offset:4096
    ds_read_b64_tr_b16 a[24:25], v234 offset:0
    ds_read_b64_tr_b16 a[26:27], v234 offset:4096
    ds_read_b64_tr_b16 a[28:29], v235 offset:0
    s_waitcnt lgkmcnt(8)
    ds_read_b64_tr_b16 a[30:31], v235 offset:4096
    s_waitcnt vmcnt(18)
    s_waitcnt lgkmcnt(8)
    v_mfma_f32_16x16x32_bf16 v[32:35], a[0:3], a[128:131], 0
    s_barrier
    v_mfma_f32_16x16x32_bf16 v[36:39], a[0:3], a[132:135], 0
    ds_read_b64_tr_b16 a[0:1], v228 offset:8192
    v_mfma_f32_16x16x32_bf16 v[44:47], a[4:7], a[132:135], 0
    ds_read_b64_tr_b16 a[2:3], v228 offset:12288
    s_add_u32 m0, s27, 114688
    v_mfma_f32_16x16x32_bf16 v[40:43], a[4:7], a[128:131], 0
    ds_read_b64_tr_b16 a[4:5], v229 offset:8192
    s_waitcnt lgkmcnt(7)
    v_mfma_f32_16x16x32_bf16 v[48:51], a[8:11], a[128:131], 0
    ds_read_b64_tr_b16 a[6:7], v229 offset:12288
    buffer_load_dwordx4 v226, s[68:71], s25 offen lds
    v_mfma_f32_16x16x32_bf16 v[52:55], a[8:11], a[132:135], 0
    ds_read_b64_tr_b16 a[8:9], v230 offset:8192
    v_mfma_f32_16x16x32_bf16 v[60:63], a[12:15], a[132:135], 0
    ds_read_b64_tr_b16 a[10:11], v230 offset:12288
    v_mfma_f32_16x16x32_bf16 v[56:59], a[12:15], a[128:131], 0
    ds_read_b64_tr_b16 a[12:13], v231 offset:8192
    s_waitcnt lgkmcnt(7)
    v_mfma_f32_16x16x32_bf16 v[64:67], a[16:19], a[128:131], 0
    ds_read_b64_tr_b16 a[14:15], v231 offset:12288
    s_add_u32 m0, s27, 115712
    v_mfma_f32_16x16x32_bf16 v[68:71], a[16:19], a[132:135], 0
    ds_read_b64_tr_b16 a[16:17], v232 offset:8192
    v_mfma_f32_16x16x32_bf16 v[76:79], a[20:23], a[132:135], 0
    ds_read_b64_tr_b16 a[18:19], v232 offset:12288
    buffer_load_dwordx4 v227, s[68:71], s25 offen lds
    v_mfma_f32_16x16x32_bf16 v[72:75], a[20:23], a[128:131], 0
    ds_read_b64_tr_b16 a[20:21], v233 offset:8192
    s_waitcnt lgkmcnt(7)
    v_mfma_f32_16x16x32_bf16 v[80:83], a[24:27], a[128:131], 0
    ds_read_b64_tr_b16 a[22:23], v233 offset:12288
    s_add_u32 s25, s25, 0x10000
    v_mfma_f32_16x16x32_bf16 v[84:87], a[24:27], a[132:135], 0
    ds_read_b64_tr_b16 a[24:25], v234 offset:8192
    v_mfma_f32_16x16x32_bf16 v[92:95], a[28:31], a[132:135], 0
    ds_read_b64_tr_b16 a[26:27], v234 offset:12288
    v_mfma_f32_16x16x32_bf16 v[88:91], a[28:31], a[128:131], 0
    ds_read_b64_tr_b16 a[28:29], v235 offset:8192
    ds_read_b64_tr_b16 a[30:31], v235 offset:12288
    s_waitcnt vmcnt(18)
    s_waitcnt lgkmcnt(8)
    v_mfma_f32_16x16x32_bf16 v[32:35], a[0:3], a[136:139], v[32:35]
    s_barrier
    buffer_load_dwordx4 a[128:131], v26, s[12:15], s24 offen offset:0 sc1
    v_mfma_f32_16x16x32_bf16 v[36:39], a[0:3], a[140:143], v[36:39]
    ds_read_b64_tr_b16 a[0:1], v228 offset:16384
    v_mfma_f32_16x16x32_bf16 v[44:47], a[4:7], a[140:143], v[44:47]
    ds_read_b64_tr_b16 a[2:3], v228 offset:20480
    s_add_u32 m0, s27, 65536
    v_mfma_f32_16x16x32_bf16 v[40:43], a[4:7], a[136:139], v[40:43]
    ds_read_b64_tr_b16 a[4:5], v229 offset:16384
    s_waitcnt lgkmcnt(7)
    v_mfma_f32_16x16x32_bf16 v[48:51], a[8:11], a[136:139], v[48:51]
    ds_read_b64_tr_b16 a[6:7], v229 offset:20480
    buffer_load_dwordx4 v226, s[68:71], s25 offen lds
    v_mfma_f32_16x16x32_bf16 v[52:55], a[8:11], a[140:143], v[52:55]
    ds_read_b64_tr_b16 a[8:9], v230 offset:16384
    v_mfma_f32_16x16x32_bf16 v[60:63], a[12:15], a[140:143], v[60:63]
    ds_read_b64_tr_b16 a[10:11], v230 offset:20480
    buffer_load_dwordx4 a[132:135], v26, s[12:15], s24 offen offset:1024 sc1
    v_mfma_f32_16x16x32_bf16 v[56:59], a[12:15], a[136:139], v[56:59]
    ds_read_b64_tr_b16 a[12:13], v231 offset:16384
    s_waitcnt lgkmcnt(7)
    v_mfma_f32_16x16x32_bf16 v[64:67], a[16:19], a[136:139], v[64:67]
    ds_read_b64_tr_b16 a[14:15], v231 offset:20480
    s_add_u32 m0, s27, 66560
    v_mfma_f32_16x16x32_bf16 v[68:71], a[16:19], a[140:143], v[68:71]
    ds_read_b64_tr_b16 a[16:17], v232 offset:16384
    v_mfma_f32_16x16x32_bf16 v[76:79], a[20:23], a[140:143], v[76:79]
    ds_read_b64_tr_b16 a[18:19], v232 offset:20480
    buffer_load_dwordx4 v227, s[68:71], s25 offen lds
    v_mfma_f32_16x16x32_bf16 v[72:75], a[20:23], a[136:139], v[72:75]
    ds_read_b64_tr_b16 a[20:21], v233 offset:16384
    s_waitcnt lgkmcnt(7)
    v_mfma_f32_16x16x32_bf16 v[80:83], a[24:27], a[136:139], v[80:83]
    ds_read_b64_tr_b16 a[22:23], v233 offset:20480
    s_add_u32 s25, s25, 0x10000
    v_mfma_f32_16x16x32_bf16 v[84:87], a[24:27], a[140:143], v[84:87]
    ds_read_b64_tr_b16 a[24:25], v234 offset:16384
    v_mfma_f32_16x16x32_bf16 v[92:95], a[28:31], a[140:143], v[92:95]
    ds_read_b64_tr_b16 a[26:27], v234 offset:20480
    s_add_u32 s24, s24, 0x20000
    v_mfma_f32_16x16x32_bf16 v[88:91], a[28:31], a[136:139], v[88:91]
    ds_read_b64_tr_b16 a[28:29], v235 offset:16384
    ds_read_b64_tr_b16 a[30:31], v235 offset:20480
    s_waitcnt vmcnt(20)
    s_waitcnt lgkmcnt(8)
    v_mfma_f32_16x16x32_bf16 v[32:35], a[0:3], a[144:147], v[32:35]
    s_barrier
    buffer_load_dwordx4 a[136:139], v26, s[12:15], s24 offen offset:0 sc1
    v_mfma_f32_16x16x32_bf16 v[36:39], a[0:3], a[148:151], v[36:39]
    ds_read_b64_tr_b16 a[0:1], v228 offset:24576
    v_mfma_f32_16x16x32_bf16 v[44:47], a[4:7], a[148:151], v[44:47]
    ds_read_b64_tr_b16 a[2:3], v228 offset:28672
    s_add_u32 m0, s27, 73728
    v_mfma_f32_16x16x32_bf16 v[40:43], a[4:7], a[144:147], v[40:43]
    ds_read_b64_tr_b16 a[4:5], v229 offset:24576
    s_waitcnt lgkmcnt(7)
    v_mfma_f32_16x16x32_bf16 v[48:51], a[8:11], a[144:147], v[48:51]
    ds_read_b64_tr_b16 a[6:7], v229 offset:28672
    buffer_load_dwordx4 v226, s[68:71], s25 offen lds
    v_mfma_f32_16x16x32_bf16 v[52:55], a[8:11], a[148:151], v[52:55]
    ds_read_b64_tr_b16 a[8:9], v230 offset:24576
    v_mfma_f32_16x16x32_bf16 v[60:63], a[12:15], a[148:151], v[60:63]
    ds_read_b64_tr_b16 a[10:11], v230 offset:28672
    buffer_load_dwordx4 a[140:143], v26, s[12:15], s24 offen offset:1024 sc1
    v_mfma_f32_16x16x32_bf16 v[56:59], a[12:15], a[144:147], v[56:59]
    ds_read_b64_tr_b16 a[12:13], v231 offset:24576
    s_waitcnt lgkmcnt(7)
    v_mfma_f32_16x16x32_bf16 v[64:67], a[16:19], a[144:147], v[64:67]
    ds_read_b64_tr_b16 a[14:15], v231 offset:28672
    s_add_u32 m0, s27, 74752
    v_mfma_f32_16x16x32_bf16 v[68:71], a[16:19], a[148:151], v[68:71]
    ds_read_b64_tr_b16 a[16:17], v232 offset:24576
    v_mfma_f32_16x16x32_bf16 v[76:79], a[20:23], a[148:151], v[76:79]
    ds_read_b64_tr_b16 a[18:19], v232 offset:28672
    buffer_load_dwordx4 v227, s[68:71], s25 offen lds
    v_mfma_f32_16x16x32_bf16 v[72:75], a[20:23], a[144:147], v[72:75]
    ds_read_b64_tr_b16 a[20:21], v233 offset:24576
    s_waitcnt lgkmcnt(7)
    v_mfma_f32_16x16x32_bf16 v[80:83], a[24:27], a[144:147], v[80:83]
    ds_read_b64_tr_b16 a[22:23], v233 offset:28672
    s_add_u32 s25, s25, 0x10000
    v_mfma_f32_16x16x32_bf16 v[84:87], a[24:27], a[148:151], v[84:87]
    ds_read_b64_tr_b16 a[24:25], v234 offset:24576
    v_mfma_f32_16x16x32_bf16 v[92:95], a[28:31], a[148:151], v[92:95]
    ds_read_b64_tr_b16 a[26:27], v234 offset:28672
    s_add_u32 s24, s24, 0x20000
    v_mfma_f32_16x16x32_bf16 v[88:91], a[28:31], a[144:147], v[88:91]
    ds_read_b64_tr_b16 a[28:29], v235 offset:24576
    ds_read_b64_tr_b16 a[30:31], v235 offset:28672
    s_waitcnt vmcnt(22)
    s_waitcnt lgkmcnt(8)
    v_mfma_f32_16x16x32_bf16 v[32:35], a[0:3], a[152:155], v[32:35]
    s_barrier
    buffer_load_dwordx4 a[144:147], v26, s[12:15], s24 offen offset:0 sc1
    v_mfma_f32_16x16x32_bf16 v[36:39], a[0:3], a[156:159], v[36:39]
    ds_read_b64_tr_b16 a[0:1], v228 offset:32768
    v_mfma_f32_16x16x32_bf16 v[44:47], a[4:7], a[156:159], v[44:47]
    ds_read_b64_tr_b16 a[2:3], v228 offset:36864
    s_add_u32 m0, s27, 81920
    v_mfma_f32_16x16x32_bf16 v[40:43], a[4:7], a[152:155], v[40:43]
    ds_read_b64_tr_b16 a[4:5], v229 offset:32768
    s_waitcnt lgkmcnt(7)
    v_mfma_f32_16x16x32_bf16 v[48:51], a[8:11], a[152:155], v[48:51]
    ds_read_b64_tr_b16 a[6:7], v229 offset:36864
    buffer_load_dwordx4 v226, s[68:71], s25 offen lds
    v_mfma_f32_16x16x32_bf16 v[52:55], a[8:11], a[156:159], v[52:55]
    ds_read_b64_tr_b16 a[8:9], v230 offset:32768
    v_mfma_f32_16x16x32_bf16 v[60:63], a[12:15], a[156:159], v[60:63]
    ds_read_b64_tr_b16 a[10:11], v230 offset:36864
    buffer_load_dwordx4 a[148:151], v26, s[12:15], s24 offen offset:1024 sc1
    v_mfma_f32_16x16x32_bf16 v[56:59], a[12:15], a[152:155], v[56:59]
    ds_read_b64_tr_b16 a[12:13], v231 offset:32768
    s_waitcnt lgkmcnt(7)
    v_mfma_f32_16x16x32_bf16 v[64:67], a[16:19], a[152:155], v[64:67]
    ds_read_b64_tr_b16 a[14:15], v231 offset:36864
    s_add_u32 m0, s27, 82944
    v_mfma_f32_16x16x32_bf16 v[68:71], a[16:19], a[156:159], v[68:71]
    ds_read_b64_tr_b16 a[16:17], v232 offset:32768
    v_mfma_f32_16x16x32_bf16 v[76:79], a[20:23], a[156:159], v[76:79]
    ds_read_b64_tr_b16 a[18:19], v232 offset:36864
    buffer_load_dwordx4 v227, s[68:71], s25 offen lds
    v_mfma_f32_16x16x32_bf16 v[72:75], a[20:23], a[152:155], v[72:75]
    ds_read_b64_tr_b16 a[20:21], v233 offset:32768
    s_waitcnt lgkmcnt(7)
    v_mfma_f32_16x16x32_bf16 v[80:83], a[24:27], a[152:155], v[80:83]
    ds_read_b64_tr_b16 a[22:23], v233 offset:36864
    s_add_u32 s25, s25, 0x10000
    v_mfma_f32_16x16x32_bf16 v[84:87], a[24:27], a[156:159], v[84:87]
    ds_read_b64_tr_b16 a[24:25], v234 offset:32768
    v_mfma_f32_16x16x32_bf16 v[92:95], a[28:31], a[156:159], v[92:95]
    ds_read_b64_tr_b16 a[26:27], v234 offset:36864
    s_add_u32 s24, s24, 0x20000
    v_mfma_f32_16x16x32_bf16 v[88:91], a[28:31], a[152:155], v[88:91]
    ds_read_b64_tr_b16 a[28:29], v235 offset:32768
    ds_read_b64_tr_b16 a[30:31], v235 offset:36864
    s_waitcnt vmcnt(24)
    s_waitcnt lgkmcnt(8)
    v_mfma_f32_16x16x32_bf16 v[32:35], a[0:3], a[160:163], v[32:35]
    s_barrier
    buffer_load_dwordx4 a[152:155], v26, s[12:15], s24 offen offset:0 sc1
    v_mfma_f32_16x16x32_bf16 v[36:39], a[0:3], a[164:167], v[36:39]
    ds_read_b64_tr_b16 a[0:1], v228 offset:40960
    v_mfma_f32_16x16x32_bf16 v[44:47], a[4:7], a[164:167], v[44:47]
    ds_read_b64_tr_b16 a[2:3], v228 offset:45056
    s_add_u32 m0, s27, 90112
    s_add_u32 s28, s25, s26
    v_mfma_f32_16x16x32_bf16 v[40:43], a[4:7], a[160:163], v[40:43]
    ds_read_b64_tr_b16 a[4:5], v229 offset:40960
    s_waitcnt lgkmcnt(7)
    v_mfma_f32_16x16x32_bf16 v[48:51], a[8:11], a[160:163], v[48:51]
    ds_read_b64_tr_b16 a[6:7], v229 offset:45056
    buffer_load_dwordx4 v226, s[68:71], s28 offen lds
    v_mfma_f32_16x16x32_bf16 v[52:55], a[8:11], a[164:167], v[52:55]
    ds_read_b64_tr_b16 a[8:9], v230 offset:40960
    v_mfma_f32_16x16x32_bf16 v[60:63], a[12:15], a[164:167], v[60:63]
    ds_read_b64_tr_b16 a[10:11], v230 offset:45056
    buffer_load_dwordx4 a[156:159], v26, s[12:15], s24 offen offset:1024 sc1
    v_mfma_f32_16x16x32_bf16 v[56:59], a[12:15], a[160:163], v[56:59]
    ds_read_b64_tr_b16 a[12:13], v231 offset:40960
    s_waitcnt lgkmcnt(7)
    v_mfma_f32_16x16x32_bf16 v[64:67], a[16:19], a[160:163], v[64:67]
    ds_read_b64_tr_b16 a[14:15], v231 offset:45056
    s_add_u32 m0, s27, 91136
    v_mfma_f32_16x16x32_bf16 v[68:71], a[16:19], a[164:167], v[68:71]
    ds_read_b64_tr_b16 a[16:17], v232 offset:40960
    v_mfma_f32_16x16x32_bf16 v[76:79], a[20:23], a[164:167], v[76:79]
    ds_read_b64_tr_b16 a[18:19], v232 offset:45056
    buffer_load_dwordx4 v227, s[68:71], s28 offen lds
    v_mfma_f32_16x16x32_bf16 v[72:75], a[20:23], a[160:163], v[72:75]
    ds_read_b64_tr_b16 a[20:21], v233 offset:40960
    s_waitcnt lgkmcnt(7)
    v_mfma_f32_16x16x32_bf16 v[80:83], a[24:27], a[160:163], v[80:83]
    ds_read_b64_tr_b16 a[22:23], v233 offset:45056
    s_add_u32 s25, s25, 0x10000
    v_mfma_f32_16x16x32_bf16 v[84:87], a[24:27], a[164:167], v[84:87]
    ds_read_b64_tr_b16 a[24:25], v234 offset:40960
    v_mfma_f32_16x16x32_bf16 v[92:95], a[28:31], a[164:167], v[92:95]
    ds_read_b64_tr_b16 a[26:27], v234 offset:45056
    s_add_u32 s24, s24, 0x20000
    v_mfma_f32_16x16x32_bf16 v[88:91], a[28:31], a[160:163], v[88:91]
    ds_read_b64_tr_b16 a[28:29], v235 offset:40960
    ds_read_b64_tr_b16 a[30:31], v235 offset:45056
    s_waitcnt vmcnt(16)
    s_waitcnt lgkmcnt(8)
    v_mfma_f32_16x16x32_bf16 v[32:35], a[0:3], a[168:171], v[32:35]
    s_barrier
    buffer_load_dwordx4 a[160:163], v26, s[12:15], s24 offen offset:0 sc1
    v_mfma_f32_16x16x32_bf16 v[36:39], a[0:3], a[172:175], v[36:39]
    ds_read_b64_tr_b16 a[0:1], v228 offset:49152
    v_mfma_f32_16x16x32_bf16 v[44:47], a[4:7], a[172:175], v[44:47]
    ds_read_b64_tr_b16 a[2:3], v228 offset:53248
    s_add_u32 m0, s27, 98304
    v_mfma_f32_16x16x32_bf16 v[40:43], a[4:7], a[168:171], v[40:43]
    ds_read_b64_tr_b16 a[4:5], v229 offset:49152
    s_waitcnt lgkmcnt(7)
    v_mfma_f32_16x16x32_bf16 v[48:51], a[8:11], a[168:171], v[48:51]
    ds_read_b64_tr_b16 a[6:7], v229 offset:53248
    buffer_load_dwordx4 v226, s[68:71], s25 offen lds
    v_mfma_f32_16x16x32_bf16 v[52:55], a[8:11], a[172:175], v[52:55]
    ds_read_b64_tr_b16 a[8:9], v230 offset:49152
    v_mfma_f32_16x16x32_bf16 v[60:63], a[12:15], a[172:175], v[60:63]
    ds_read_b64_tr_b16 a[10:11], v230 offset:53248
    buffer_load_dwordx4 a[164:167], v26, s[12:15], s24 offen offset:1024 sc1
    v_mfma_f32_16x16x32_bf16 v[56:59], a[12:15], a[168:171], v[56:59]
    ds_read_b64_tr_b16 a[12:13], v231 offset:49152
    s_waitcnt lgkmcnt(7)
    v_mfma_f32_16x16x32_bf16 v[64:67], a[16:19], a[168:171], v[64:67]
    ds_read_b64_tr_b16 a[14:15], v231 offset:53248
    s_add_u32 m0, s27, 99328
    v_mfma_f32_16x16x32_bf16 v[68:71], a[16:19], a[172:175], v[68:71]
    ds_read_b64_tr_b16 a[16:17], v232 offset:49152
    v_mfma_f32_16x16x32_bf16 v[76:79], a[20:23], a[172:175], v[76:79]
    ds_read_b64_tr_b16 a[18:19], v232 offset:53248
    buffer_load_dwordx4 v227, s[68:71], s25 offen lds
    v_mfma_f32_16x16x32_bf16 v[72:75], a[20:23], a[168:171], v[72:75]
    ds_read_b64_tr_b16 a[20:21], v233 offset:49152
    s_waitcnt lgkmcnt(7)
    v_mfma_f32_16x16x32_bf16 v[80:83], a[24:27], a[168:171], v[80:83]
    ds_read_b64_tr_b16 a[22:23], v233 offset:53248
    s_add_u32 s25, s25, 0x10000
    v_mfma_f32_16x16x32_bf16 v[84:87], a[24:27], a[172:175], v[84:87]
    ds_read_b64_tr_b16 a[24:25], v234 offset:49152
    v_mfma_f32_16x16x32_bf16 v[92:95], a[28:31], a[172:175], v[92:95]
    ds_read_b64_tr_b16 a[26:27], v234 offset:53248
    s_add_u32 s24, s24, 0x20000
    v_mfma_f32_16x16x32_bf16 v[88:91], a[28:31], a[168:171], v[88:91]
    ds_read_b64_tr_b16 a[28:29], v235 offset:49152
    ds_read_b64_tr_b16 a[30:31], v235 offset:53248
    s_waitcnt vmcnt(16)
    s_waitcnt lgkmcnt(8)
    v_mfma_f32_16x16x32_bf16 v[32:35], a[0:3], a[176:179], v[32:35]
    s_barrier
    buffer_load_dwordx4 a[168:171], v26, s[12:15], s24 offen offset:0 sc1
    v_mfma_f32_16x16x32_bf16 v[36:39], a[0:3], a[180:183], v[36:39]
    ds_read_b64_tr_b16 a[0:1], v228 offset:0
    v_mfma_f32_16x16x32_bf16 v[44:47], a[4:7], a[180:183], v[44:47]
    ds_read_b64_tr_b16 a[2:3], v228 offset:4096
    s_add_u32 m0, s27, 106496
    v_mfma_f32_16x16x32_bf16 v[40:43], a[4:7], a[176:179], v[40:43]
    ds_read_b64_tr_b16 a[4:5], v229 offset:0
    s_mov_b32 s44, s53
    v_mov_b32 v8, s60
    v_mov_b32 v9, 0
    s_mov_b64 exec, 1
    buffer_store_dword v8, v9, s[12:15], s44 offen sc0 sc1
    s_mov_b64 exec, -1
    s_waitcnt lgkmcnt(7)
    v_mfma_f32_16x16x32_bf16 v[48:51], a[8:11], a[176:179], v[48:51]
    ds_read_b64_tr_b16 a[6:7], v229 offset:4096
    buffer_load_dwordx4 v226, s[68:71], s25 offen lds
    v_mfma_f32_16x16x32_bf16 v[52:55], a[8:11], a[180:183], v[52:55]
    ds_read_b64_tr_b16 a[8:9], v230 offset:0
    v_mfma_f32_16x16x32_bf16 v[60:63], a[12:15], a[180:183], v[60:63]
    ds_read_b64_tr_b16 a[10:11], v230 offset:4096
    buffer_load_dwordx4 a[172:175], v26, s[12:15], s24 offen offset:1024 sc1
    v_mfma_f32_16x16x32_bf16 v[56:59], a[12:15], a[176:179], v[56:59]
    ds_read_b64_tr_b16 a[12:13], v231 offset:0
    s_waitcnt lgkmcnt(7)
    v_mfma_f32_16x16x32_bf16 v[64:67], a[16:19], a[176:179], v[64:67]
    ds_read_b64_tr_b16 a[14:15], v231 offset:4096
    s_add_u32 m0, s27, 107520
    v_mfma_f32_16x16x32_bf16 v[68:71], a[16:19], a[180:183], v[68:71]
    ds_read_b64_tr_b16 a[16:17], v232 offset:0
    v_mfma_f32_16x16x32_bf16 v[76:79], a[20:23], a[180:183], v[76:79]
    ds_read_b64_tr_b16 a[18:19], v232 offset:4096
    buffer_load_dwordx4 v227, s[68:71], s25 offen lds
    v_mfma_f32_16x16x32_bf16 v[72:75], a[20:23], a[176:179], v[72:75]
    ds_read_b64_tr_b16 a[20:21], v233 offset:0
    s_waitcnt lgkmcnt(7)
    v_mfma_f32_16x16x32_bf16 v[80:83], a[24:27], a[176:179], v[80:83]
    ds_read_b64_tr_b16 a[22:23], v233 offset:4096
    s_add_u32 s25, s25, 0x10000
    v_mfma_f32_16x16x32_bf16 v[84:87], a[24:27], a[180:183], v[84:87]
    ds_read_b64_tr_b16 a[24:25], v234 offset:0
    v_mfma_f32_16x16x32_bf16 v[92:95], a[28:31], a[180:183], v[92:95]
    ds_read_b64_tr_b16 a[26:27], v234 offset:4096
    s_add_u32 s24, s24, 0x20000
    v_mfma_f32_16x16x32_bf16 v[88:91], a[28:31], a[176:179], v[88:91]
    ds_read_b64_tr_b16 a[28:29], v235 offset:0
    ds_read_b64_tr_b16 a[30:31], v235 offset:4096
    s_mov_b32 s37, 1
.p2align 6
L_g2_loop:
    s_waitcnt vmcnt(16)
    s_waitcnt lgkmcnt(8)
    v_mfma_f32_16x16x32_bf16 v[32:35], a[0:3], a[128:131], v[32:35]
    s_barrier
    buffer_load_dwordx4 a[176:179], v26, s[12:15], s24 offen offset:0 sc1
    v_mfma_f32_16x16x32_bf16 v[36:39], a[0:3], a[132:135], v[36:39]
    ds_read_b64_tr_b16 a[0:1], v228 offset:8192
    v_mfma_f32_16x16x32_bf16 v[44:47], a[4:7], a[132:135], v[44:47]
    ds_read_b64_tr_b16 a[2:3], v228 offset:12288
    s_add_u32 m0, s27, 114688
    v_mfma_f32_16x16x32_bf16 v[40:43], a[4:7], a[128:131], v[40:43]
    ds_read_b64_tr_b16 a[4:5], v229 offset:8192
    s_waitcnt lgkmcnt(7)
    v_mfma_f32_16x16x32_bf16 v[48:51], a[8:11], a[128:131], v[48:51]
    ds_read_b64_tr_b16 a[6:7], v229 offset:12288
    buffer_load_dwordx4 v226, s[68:71], s25 offen lds
    v_mfma_f32_16x16x32_bf16 v[52:55], a[8:11], a[132:135], v[52:55]
    ds_read_b64_tr_b16 a[8:9], v230 offset:8192
    v_mfma_f32_16x16x32_bf16 v[60:63], a[12:15], a[132:135], v[60:63]
    ds_read_b64_tr_b16 a[10:11], v230 offset:12288
    buffer_load_dwordx4 a[180:183], v26, s[12:15], s24 offen offset:1024 sc1
    v_mfma_f32_16x16x32_bf16 v[56:59], a[12:15], a[128:131], v[56:59]
    ds_read_b64_tr_b16 a[12:13], v231 offset:8192
    s_waitcnt lgkmcnt(7)
    v_mfma_f32_16x16x32_bf16 v[64:67], a[16:19], a[128:131], v[64:67]
    ds_read_b64_tr_b16 a[14:15], v231 offset:12288
    s_add_u32 m0, s27, 115712
    v_mfma_f32_16x16x32_bf16 v[68:71], a[16:19], a[132:135], v[68:71]
    ds_read_b64_tr_b16 a[16:17], v232 offset:8192
    v_mfma_f32_16x16x32_bf16 v[76:79], a[20:23], a[132:135], v[76:79]
    ds_read_b64_tr_b16 a[18:19], v232 offset:12288
    buffer_load_dwordx4 v227, s[68:71], s25 offen lds
    v_mfma_f32_16x16x32_bf16 v[72:75], a[20:23], a[128:131], v[72:75]
    ds_read_b64_tr_b16 a[20:21], v233 offset:8192
    s_waitcnt lgkmcnt(7)
    v_mfma_f32_16x16x32_bf16 v[80:83], a[24:27], a[128:131], v[80:83]
    ds_read_b64_tr_b16 a[22:23], v233 offset:12288
    s_add_u32 s25, s25, 0x10000
    v_mfma_f32_16x16x32_bf16 v[84:87], a[24:27], a[132:135], v[84:87]
    ds_read_b64_tr_b16 a[24:25], v234 offset:8192
    v_mfma_f32_16x16x32_bf16 v[92:95], a[28:31], a[132:135], v[92:95]
    ds_read_b64_tr_b16 a[26:27], v234 offset:12288
    s_add_u32 s24, s24, 0x20000
    v_mfma_f32_16x16x32_bf16 v[88:91], a[28:31], a[128:131], v[88:91]
    ds_read_b64_tr_b16 a[28:29], v235 offset:8192
    ds_read_b64_tr_b16 a[30:31], v235 offset:12288
    s_waitcnt vmcnt(16)
    s_waitcnt lgkmcnt(8)
    v_mfma_f32_16x16x32_bf16 v[32:35], a[0:3], a[136:139], v[32:35]
    s_barrier
    buffer_load_dwordx4 a[128:131], v26, s[12:15], s24 offen offset:0 sc1
    v_mfma_f32_16x16x32_bf16 v[36:39], a[0:3], a[140:143], v[36:39]
    ds_read_b64_tr_b16 a[0:1], v228 offset:16384
    v_mfma_f32_16x16x32_bf16 v[44:47], a[4:7], a[140:143], v[44:47]
    ds_read_b64_tr_b16 a[2:3], v228 offset:20480
    s_add_u32 m0, s27, 65536
    v_mfma_f32_16x16x32_bf16 v[40:43], a[4:7], a[136:139], v[40:43]
    ds_read_b64_tr_b16 a[4:5], v229 offset:16384
    s_waitcnt lgkmcnt(7)
    v_mfma_f32_16x16x32_bf16 v[48:51], a[8:11], a[136:139], v[48:51]
    ds_read_b64_tr_b16 a[6:7], v229 offset:20480
    buffer_load_dwordx4 v226, s[68:71], s25 offen lds
    v_mfma_f32_16x16x32_bf16 v[52:55], a[8:11], a[140:143], v[52:55]
    ds_read_b64_tr_b16 a[8:9], v230 offset:16384
    v_mfma_f32_16x16x32_bf16 v[60:63], a[12:15], a[140:143], v[60:63]
    ds_read_b64_tr_b16 a[10:11], v230 offset:20480
    buffer_load_dwordx4 a[132:135], v26, s[12:15], s24 offen offset:1024 sc1
    v_mfma_f32_16x16x32_bf16 v[56:59], a[12:15], a[136:139], v[56:59]
    ds_read_b64_tr_b16 a[12:13], v231 offset:16384
    s_waitcnt lgkmcnt(7)
    v_mfma_f32_16x16x32_bf16 v[64:67], a[16:19], a[136:139], v[64:67]
    ds_read_b64_tr_b16 a[14:15], v231 offset:20480
    s_add_u32 m0, s27, 66560
    v_mfma_f32_16x16x32_bf16 v[68:71], a[16:19], a[140:143], v[68:71]
    ds_read_b64_tr_b16 a[16:17], v232 offset:16384
    v_mfma_f32_16x16x32_bf16 v[76:79], a[20:23], a[140:143], v[76:79]
    ds_read_b64_tr_b16 a[18:19], v232 offset:20480
    buffer_load_dwordx4 v227, s[68:71], s25 offen lds
    v_mfma_f32_16x16x32_bf16 v[72:75], a[20:23], a[136:139], v[72:75]
    ds_read_b64_tr_b16 a[20:21], v233 offset:16384
    s_waitcnt lgkmcnt(7)
    v_mfma_f32_16x16x32_bf16 v[80:83], a[24:27], a[136:139], v[80:83]
    ds_read_b64_tr_b16 a[22:23], v233 offset:20480
    s_add_u32 s25, s25, 0x10000
    v_mfma_f32_16x16x32_bf16 v[84:87], a[24:27], a[140:143], v[84:87]
    ds_read_b64_tr_b16 a[24:25], v234 offset:16384
    v_mfma_f32_16x16x32_bf16 v[92:95], a[28:31], a[140:143], v[92:95]
    ds_read_b64_tr_b16 a[26:27], v234 offset:20480
    s_add_u32 s24, s24, 0x20000
    v_mfma_f32_16x16x32_bf16 v[88:91], a[28:31], a[136:139], v[88:91]
    ds_read_b64_tr_b16 a[28:29], v235 offset:16384
    ds_read_b64_tr_b16 a[30:31], v235 offset:20480
    s_waitcnt vmcnt(16)
    s_waitcnt lgkmcnt(8)
    v_mfma_f32_16x16x32_bf16 v[32:35], a[0:3], a[144:147], v[32:35]
    s_barrier
    buffer_load_dwordx4 a[136:139], v26, s[12:15], s24 offen offset:0 sc1
    v_mfma_f32_16x16x32_bf16 v[36:39], a[0:3], a[148:151], v[36:39]
    ds_read_b64_tr_b16 a[0:1], v228 offset:24576
    v_mfma_f32_16x16x32_bf16 v[44:47], a[4:7], a[148:151], v[44:47]
    ds_read_b64_tr_b16 a[2:3], v228 offset:28672
    s_add_u32 m0, s27, 73728
    v_mfma_f32_16x16x32_bf16 v[40:43], a[4:7], a[144:147], v[40:43]
    ds_read_b64_tr_b16 a[4:5], v229 offset:24576
    s_waitcnt lgkmcnt(7)
    v_mfma_f32_16x16x32_bf16 v[48:51], a[8:11], a[144:147], v[48:51]
    ds_read_b64_tr_b16 a[6:7], v229 offset:28672
    buffer_load_dwordx4 v226, s[68:71], s25 offen lds
    v_mfma_f32_16x16x32_bf16 v[52:55], a[8:11], a[148:151], v[52:55]
    ds_read_b64_tr_b16 a[8:9], v230 offset:24576
    v_mfma_f32_16x16x32_bf16 v[60:63], a[12:15], a[148:151], v[60:63]
    ds_read_b64_tr_b16 a[10:11], v230 offset:28672
    buffer_load_dwordx4 a[140:143], v26, s[12:15], s24 offen offset:1024 sc1
    v_mfma_f32_16x16x32_bf16 v[56:59], a[12:15], a[144:147], v[56:59]
    ds_read_b64_tr_b16 a[12:13], v231 offset:24576
    s_waitcnt lgkmcnt(7)
    v_mfma_f32_16x16x32_bf16 v[64:67], a[16:19], a[144:147], v[64:67]
    ds_read_b64_tr_b16 a[14:15], v231 offset:28672
    s_add_u32 m0, s27, 74752
    v_mfma_f32_16x16x32_bf16 v[68:71], a[16:19], a[148:151], v[68:71]
    ds_read_b64_tr_b16 a[16:17], v232 offset:24576
    v_mfma_f32_16x16x32_bf16 v[76:79], a[20:23], a[148:151], v[76:79]
    ds_read_b64_tr_b16 a[18:19], v232 offset:28672
    buffer_load_dwordx4 v227, s[68:71], s25 offen lds
    v_mfma_f32_16x16x32_bf16 v[72:75], a[20:23], a[144:147], v[72:75]
    ds_read_b64_tr_b16 a[20:21], v233 offset:24576
    s_waitcnt lgkmcnt(7)
    v_mfma_f32_16x16x32_bf16 v[80:83], a[24:27], a[144:147], v[80:83]
    ds_read_b64_tr_b16 a[22:23], v233 offset:28672
    s_add_u32 s25, s25, 0x10000
    v_mfma_f32_16x16x32_bf16 v[84:87], a[24:27], a[148:151], v[84:87]
    ds_read_b64_tr_b16 a[24:25], v234 offset:24576
    v_mfma_f32_16x16x32_bf16 v[92:95], a[28:31], a[148:151], v[92:95]
    ds_read_b64_tr_b16 a[26:27], v234 offset:28672
    s_add_u32 s24, s24, 0x20000
    v_mfma_f32_16x16x32_bf16 v[88:91], a[28:31], a[144:147], v[88:91]
    ds_read_b64_tr_b16 a[28:29], v235 offset:24576
    ds_read_b64_tr_b16 a[30:31], v235 offset:28672
    s_waitcnt vmcnt(16)
    s_waitcnt lgkmcnt(8)
    v_mfma_f32_16x16x32_bf16 v[32:35], a[0:3], a[152:155], v[32:35]
    s_barrier
    buffer_load_dwordx4 a[144:147], v26, s[12:15], s24 offen offset:0 sc1
    v_mfma_f32_16x16x32_bf16 v[36:39], a[0:3], a[156:159], v[36:39]
    ds_read_b64_tr_b16 a[0:1], v228 offset:32768
    v_mfma_f32_16x16x32_bf16 v[44:47], a[4:7], a[156:159], v[44:47]
    ds_read_b64_tr_b16 a[2:3], v228 offset:36864
    s_add_u32 m0, s27, 81920
    v_mfma_f32_16x16x32_bf16 v[40:43], a[4:7], a[152:155], v[40:43]
    ds_read_b64_tr_b16 a[4:5], v229 offset:32768
    s_waitcnt lgkmcnt(7)
    v_mfma_f32_16x16x32_bf16 v[48:51], a[8:11], a[152:155], v[48:51]
    ds_read_b64_tr_b16 a[6:7], v229 offset:36864
    buffer_load_dwordx4 v226, s[68:71], s25 offen lds
    v_mfma_f32_16x16x32_bf16 v[52:55], a[8:11], a[156:159], v[52:55]
    ds_read_b64_tr_b16 a[8:9], v230 offset:32768
    v_mfma_f32_16x16x32_bf16 v[60:63], a[12:15], a[156:159], v[60:63]
    ds_read_b64_tr_b16 a[10:11], v230 offset:36864
    buffer_load_dwordx4 a[148:151], v26, s[12:15], s24 offen offset:1024 sc1
    v_mfma_f32_16x16x32_bf16 v[56:59], a[12:15], a[152:155], v[56:59]
    ds_read_b64_tr_b16 a[12:13], v231 offset:32768
    s_waitcnt lgkmcnt(7)
    v_mfma_f32_16x16x32_bf16 v[64:67], a[16:19], a[152:155], v[64:67]
    ds_read_b64_tr_b16 a[14:15], v231 offset:36864
    s_add_u32 m0, s27, 82944
    v_mfma_f32_16x16x32_bf16 v[68:71], a[16:19], a[156:159], v[68:71]
    ds_read_b64_tr_b16 a[16:17], v232 offset:32768
    v_mfma_f32_16x16x32_bf16 v[76:79], a[20:23], a[156:159], v[76:79]
    ds_read_b64_tr_b16 a[18:19], v232 offset:36864
    buffer_load_dwordx4 v227, s[68:71], s25 offen lds
    v_mfma_f32_16x16x32_bf16 v[72:75], a[20:23], a[152:155], v[72:75]
    ds_read_b64_tr_b16 a[20:21], v233 offset:32768
    s_waitcnt lgkmcnt(7)
    v_mfma_f32_16x16x32_bf16 v[80:83], a[24:27], a[152:155], v[80:83]
    ds_read_b64_tr_b16 a[22:23], v233 offset:36864
    s_add_u32 s25, s25, 0x10000
    v_mfma_f32_16x16x32_bf16 v[84:87], a[24:27], a[156:159], v[84:87]
    ds_read_b64_tr_b16 a[24:25], v234 offset:32768
    v_mfma_f32_16x16x32_bf16 v[92:95], a[28:31], a[156:159], v[92:95]
    ds_read_b64_tr_b16 a[26:27], v234 offset:36864
    s_add_u32 s24, s24, 0x20000
    v_mfma_f32_16x16x32_bf16 v[88:91], a[28:31], a[152:155], v[88:91]
    ds_read_b64_tr_b16 a[28:29], v235 offset:32768
    ds_read_b64_tr_b16 a[30:31], v235 offset:36864
    s_waitcnt vmcnt(16)
    s_waitcnt lgkmcnt(8)
    v_mfma_f32_16x16x32_bf16 v[32:35], a[0:3], a[160:163], v[32:35]
    s_barrier
    buffer_load_dwordx4 a[152:155], v26, s[12:15], s24 offen offset:0 sc1
    v_mfma_f32_16x16x32_bf16 v[36:39], a[0:3], a[164:167], v[36:39]
    ds_read_b64_tr_b16 a[0:1], v228 offset:40960
    v_mfma_f32_16x16x32_bf16 v[44:47], a[4:7], a[164:167], v[44:47]
    ds_read_b64_tr_b16 a[2:3], v228 offset:45056
    s_add_u32 m0, s27, 90112
    s_add_u32 s28, s25, s26
    v_mfma_f32_16x16x32_bf16 v[40:43], a[4:7], a[160:163], v[40:43]
    ds_read_b64_tr_b16 a[4:5], v229 offset:40960
    s_waitcnt lgkmcnt(7)
    v_mfma_f32_16x16x32_bf16 v[48:51], a[8:11], a[160:163], v[48:51]
    ds_read_b64_tr_b16 a[6:7], v229 offset:45056
    buffer_load_dwordx4 v226, s[68:71], s28 offen lds
    v_mfma_f32_16x16x32_bf16 v[52:55], a[8:11], a[164:167], v[52:55]
    ds_read_b64_tr_b16 a[8:9], v230 offset:40960
    v_mfma_f32_16x16x32_bf16 v[60:63], a[12:15], a[164:167], v[60:63]
    ds_read_b64_tr_b16 a[10:11], v230 offset:45056
    buffer_load_dwordx4 a[156:159], v26, s[12:15], s24 offen offset:1024 sc1
    v_mfma_f32_16x16x32_bf16 v[56:59], a[12:15], a[160:163], v[56:59]
    ds_read_b64_tr_b16 a[12:13], v231 offset:40960
    s_waitcnt lgkmcnt(7)
    v_mfma_f32_16x16x32_bf16 v[64:67], a[16:19], a[160:163], v[64:67]
    ds_read_b64_tr_b16 a[14:15], v231 offset:45056
    s_add_u32 m0, s27, 91136
    v_mfma_f32_16x16x32_bf16 v[68:71], a[16:19], a[164:167], v[68:71]
    ds_read_b64_tr_b16 a[16:17], v232 offset:40960
    v_mfma_f32_16x16x32_bf16 v[76:79], a[20:23], a[164:167], v[76:79]
    ds_read_b64_tr_b16 a[18:19], v232 offset:45056
    buffer_load_dwordx4 v227, s[68:71], s28 offen lds
    v_mfma_f32_16x16x32_bf16 v[72:75], a[20:23], a[160:163], v[72:75]
    ds_read_b64_tr_b16 a[20:21], v233 offset:40960
    s_waitcnt lgkmcnt(7)
    v_mfma_f32_16x16x32_bf16 v[80:83], a[24:27], a[160:163], v[80:83]
    ds_read_b64_tr_b16 a[22:23], v233 offset:45056
    s_add_u32 s25, s25, 0x10000
    v_mfma_f32_16x16x32_bf16 v[84:87], a[24:27], a[164:167], v[84:87]
    ds_read_b64_tr_b16 a[24:25], v234 offset:40960
    v_mfma_f32_16x16x32_bf16 v[92:95], a[28:31], a[164:167], v[92:95]
    ds_read_b64_tr_b16 a[26:27], v234 offset:45056
    s_add_u32 s24, s24, 0x20000
    v_mfma_f32_16x16x32_bf16 v[88:91], a[28:31], a[160:163], v[88:91]
    ds_read_b64_tr_b16 a[28:29], v235 offset:40960
    ds_read_b64_tr_b16 a[30:31], v235 offset:45056
    s_waitcnt vmcnt(16)
    s_waitcnt lgkmcnt(8)
    v_mfma_f32_16x16x32_bf16 v[32:35], a[0:3], a[168:171], v[32:35]
    s_barrier
    buffer_load_dwordx4 a[160:163], v26, s[12:15], s24 offen offset:0 sc1
    v_mfma_f32_16x16x32_bf16 v[36:39], a[0:3], a[172:175], v[36:39]
    ds_read_b64_tr_b16 a[0:1], v228 offset:49152
    v_mfma_f32_16x16x32_bf16 v[44:47], a[4:7], a[172:175], v[44:47]
    ds_read_b64_tr_b16 a[2:3], v228 offset:53248
    s_add_u32 m0, s27, 98304
    v_mfma_f32_16x16x32_bf16 v[40:43], a[4:7], a[168:171], v[40:43]
    ds_read_b64_tr_b16 a[4:5], v229 offset:49152
    s_waitcnt lgkmcnt(7)
    v_mfma_f32_16x16x32_bf16 v[48:51], a[8:11], a[168:171], v[48:51]
    ds_read_b64_tr_b16 a[6:7], v229 offset:53248
    buffer_load_dwordx4 v226, s[68:71], s25 offen lds
    v_mfma_f32_16x16x32_bf16 v[52:55], a[8:11], a[172:175], v[52:55]
    ds_read_b64_tr_b16 a[8:9], v230 offset:49152
    v_mfma_f32_16x16x32_bf16 v[60:63], a[12:15], a[172:175], v[60:63]
    ds_read_b64_tr_b16 a[10:11], v230 offset:53248
    buffer_load_dwordx4 a[164:167], v26, s[12:15], s24 offen offset:1024 sc1
    v_mfma_f32_16x16x32_bf16 v[56:59], a[12:15], a[168:171], v[56:59]
    ds_read_b64_tr_b16 a[12:13], v231 offset:49152
    s_waitcnt lgkmcnt(7)
    v_mfma_f32_16x16x32_bf16 v[64:67], a[16:19], a[168:171], v[64:67]
    ds_read_b64_tr_b16 a[14:15], v231 offset:53248
    s_add_u32 m0, s27, 99328
    v_mfma_f32_16x16x32_bf16 v[68:71], a[16:19], a[172:175], v[68:71]
    ds_read_b64_tr_b16 a[16:17], v232 offset:49152
    v_mfma_f32_16x16x32_bf16 v[76:79], a[20:23], a[172:175], v[76:79]
    ds_read_b64_tr_b16 a[18:19], v232 offset:53248
    buffer_load_dwordx4 v227, s[68:71], s25 offen lds
    v_mfma_f32_16x16x32_bf16 v[72:75], a[20:23], a[168:171], v[72:75]
    ds_read_b64_tr_b16 a[20:21], v233 offset:49152
    s_waitcnt lgkmcnt(7)
    v_mfma_f32_16x16x32_bf16 v[80:83], a[24:27], a[168:171], v[80:83]
    ds_read_b64_tr_b16 a[22:23], v233 offset:53248
    s_add_u32 s25, s25, 0x10000
    v_mfma_f32_16x16x32_bf16 v[84:87], a[24:27], a[172:175], v[84:87]
    ds_read_b64_tr_b16 a[24:25], v234 offset:49152
    v_mfma_f32_16x16x32_bf16 v[92:95], a[28:31], a[172:175], v[92:95]
    ds_read_b64_tr_b16 a[26:27], v234 offset:53248
    s_add_u32 s24, s24, 0x20000
    v_mfma_f32_16x16x32_bf16 v[88:91], a[28:31], a[168:171], v[88:91]
    ds_read_b64_tr_b16 a[28:29], v235 offset:49152
    ds_read_b64_tr_b16 a[30:31], v235 offset:53248
    s_waitcnt vmcnt(16)
    s_waitcnt lgkmcnt(8)
    v_mfma_f32_16x16x32_bf16 v[32:35], a[0:3], a[176:179], v[32:35]
    s_barrier
    buffer_load_dwordx4 a[168:171], v26, s[12:15], s24 offen offset:0 sc1
    v_mfma_f32_16x16x32_bf16 v[36:39], a[0:3], a[180:183], v[36:39]
    ds_read_b64_tr_b16 a[0:1], v228 offset:0
    v_mfma_f32_16x16x32_bf16 v[44:47], a[4:7], a[180:183], v[44:47]
    ds_read_b64_tr_b16 a[2:3], v228 offset:4096
    s_add_u32 m0, s27, 106496
    v_mfma_f32_16x16x32_bf16 v[40:43], a[4:7], a[176:179], v[40:43]
    ds_read_b64_tr_b16 a[4:5], v229 offset:0
    s_waitcnt lgkmcnt(7)
    v_mfma_f32_16x16x32_bf16 v[48:51], a[8:11], a[176:179], v[48:51]
    ds_read_b64_tr_b16 a[6:7], v229 offset:4096
    buffer_load_dwordx4 v226, s[68:71], s25 offen lds
    v_mfma_f32_16x16x32_bf16 v[52:55], a[8:11], a[180:183], v[52:55]
    ds_read_b64_tr_b16 a[8:9], v230 offset:0
    v_mfma_f32_16x16x32_bf16 v[60:63], a[12:15], a[180:183], v[60:63]
    ds_read_b64_tr_b16 a[10:11], v230 offset:4096
    buffer_load_dwordx4 a[172:175], v26, s[12:15], s24 offen offset:1024 sc1
    v_mfma_f32_16x16x32_bf16 v[56:59], a[12:15], a[176:179], v[56:59]
    ds_read_b64_tr_b16 a[12:13], v231 offset:0
    s_waitcnt lgkmcnt(7)
    v_mfma_f32_16x16x32_bf16 v[64:67], a[16:19], a[176:179], v[64:67]
    ds_read_b64_tr_b16 a[14:15], v231 offset:4096
    s_add_u32 m0, s27, 107520
    v_mfma_f32_16x16x32_bf16 v[68:71], a[16:19], a[180:183], v[68:71]
    ds_read_b64_tr_b16 a[16:17], v232 offset:0
    v_mfma_f32_16x16x32_bf16 v[76:79], a[20:23], a[180:183], v[76:79]
    ds_read_b64_tr_b16 a[18:19], v232 offset:4096
    buffer_load_dwordx4 v227, s[68:71], s25 offen lds
    v_mfma_f32_16x16x32_bf16 v[72:75], a[20:23], a[176:179], v[72:75]
    ds_read_b64_tr_b16 a[20:21], v233 offset:0
    s_waitcnt lgkmcnt(7)
    v_mfma_f32_16x16x32_bf16 v[80:83], a[24:27], a[176:179], v[80:83]
    ds_read_b64_tr_b16 a[22:23], v233 offset:4096
    s_add_u32 s25, s25, 0x10000
    v_mfma_f32_16x16x32_bf16 v[84:87], a[24:27], a[180:183], v[84:87]
    ds_read_b64_tr_b16 a[24:25], v234 offset:0
    v_mfma_f32_16x16x32_bf16 v[92:95], a[28:31], a[180:183], v[92:95]
    ds_read_b64_tr_b16 a[26:27], v234 offset:4096
    s_add_u32 s24, s24, 0x20000
    v_mfma_f32_16x16x32_bf16 v[88:91], a[28:31], a[176:179], v[88:91]
    ds_read_b64_tr_b16 a[28:29], v235 offset:0
    ds_read_b64_tr_b16 a[30:31], v235 offset:4096
    s_add_u32 s37, s37, 1
    s_cmp_lt_u32 s37, 6
    s_cbranch_scc1 L_g2_loop
    s_waitcnt vmcnt(16)
    s_waitcnt lgkmcnt(8)
    v_mfma_f32_16x16x32_bf16 v[32:35], a[0:3], a[128:131], v[32:35]
    s_barrier
    buffer_load_dwordx4 a[176:179], v26, s[12:15], s24 offen offset:0 sc1
    v_mfma_f32_16x16x32_bf16 v[36:39], a[0:3], a[132:135], v[36:39]
    ds_read_b64_tr_b16 a[0:1], v228 offset:8192
    v_mfma_f32_16x16x32_bf16 v[44:47], a[4:7], a[132:135], v[44:47]
    ds_read_b64_tr_b16 a[2:3], v228 offset:12288
    s_add_u32 m0, s27, 114688
    v_mfma_f32_16x16x32_bf16 v[40:43], a[4:7], a[128:131], v[40:43]
    ds_read_b64_tr_b16 a[4:5], v229 offset:8192
    s_lshl_b32 s54, s57, 11
    s_add_u32 s54, s54, 0x1860000
    buffer_load_dword v251, v224, s[12:15], s54 offen sc1
    s_waitcnt lgkmcnt(7)
    v_mfma_f32_16x16x32_bf16 v[48:51], a[8:11], a[128:131], v[48:51]
    ds_read_b64_tr_b16 a[6:7], v229 offset:12288
    buffer_load_dwordx4 v226, s[68:71], s25 offen lds
    v_mfma_f32_16x16x32_bf16 v[52:55], a[8:11], a[132:135], v[52:55]
    ds_read_b64_tr_b16 a[8:9], v230 offset:8192
    v_mfma_f32_16x16x32_bf16 v[60:63], a[12:15], a[132:135], v[60:63]
    ds_read_b64_tr_b16 a[10:11], v230 offset:12288
    buffer_load_dwordx4 a[180:183], v26, s[12:15], s24 offen offset:1024 sc1
    v_mfma_f32_16x16x32_bf16 v[56:59], a[12:15], a[128:131], v[56:59]
    ds_read_b64_tr_b16 a[12:13], v231 offset:8192
    s_waitcnt lgkmcnt(7)
    v_mfma_f32_16x16x32_bf16 v[64:67], a[16:19], a[128:131], v[64:67]
    ds_read_b64_tr_b16 a[14:15], v231 offset:12288
    s_add_u32 m0, s27, 115712
    v_mfma_f32_16x16x32_bf16 v[68:71], a[16:19], a[132:135], v[68:71]
    ds_read_b64_tr_b16 a[16:17], v232 offset:8192
    v_mfma_f32_16x16x32_bf16 v[76:79], a[20:23], a[132:135], v[76:79]
    ds_read_b64_tr_b16 a[18:19], v232 offset:12288
    buffer_load_dwordx4 v227, s[68:71], s25 offen lds
    v_mfma_f32_16x16x32_bf16 v[72:75], a[20:23], a[128:131], v[72:75]
    ds_read_b64_tr_b16 a[20:21], v233 offset:8192
    s_waitcnt lgkmcnt(7)
    v_mfma_f32_16x16x32_bf16 v[80:83], a[24:27], a[128:131], v[80:83]
    ds_read_b64_tr_b16 a[22:23], v233 offset:12288
    s_add_u32 s25, s25, 0x10000
    v_mfma_f32_16x16x32_bf16 v[84:87], a[24:27], a[132:135], v[84:87]
    ds_read_b64_tr_b16 a[24:25], v234 offset:8192
    v_mfma_f32_16x16x32_bf16 v[92:95], a[28:31], a[132:135], v[92:95]
    ds_read_b64_tr_b16 a[26:27], v234 offset:12288
    s_add_u32 s24, s24, 0x20000
    v_mfma_f32_16x16x32_bf16 v[88:91], a[28:31], a[128:131], v[88:91]
    ds_read_b64_tr_b16 a[28:29], v235 offset:8192
    ds_read_b64_tr_b16 a[30:31], v235 offset:12288
    s_waitcnt vmcnt(17)
    s_waitcnt lgkmcnt(8)
    v_mfma_f32_16x16x32_bf16 v[32:35], a[0:3], a[136:139], v[32:35]
    s_barrier
    s_sub_u32 s24, s24, s29
    buffer_load_dwordx4 a[128:131], v26, s[12:15], s24 offen offset:0 sc1
    v_mfma_f32_16x16x32_bf16 v[36:39], a[0:3], a[140:143], v[36:39]
    ds_read_b64_tr_b16 a[0:1], v228 offset:16384
    v_mfma_f32_16x16x32_bf16 v[44:47], a[4:7], a[140:143], v[44:47]
    ds_read_b64_tr_b16 a[2:3], v228 offset:20480
    s_sub_u32 s25, s25, s30
    s_lshr_b32 s27, s27, 1
    s_add_u32 m0, s27, 65536
    v_mfma_f32_16x16x32_bf16 v[40:43], a[4:7], a[136:139], v[40:43]
    ds_read_b64_tr_b16 a[4:5], v229 offset:16384
    s_waitcnt lgkmcnt(7)
    v_mfma_f32_16x16x32_bf16 v[48:51], a[8:11], a[136:139], v[48:51]
    ds_read_b64_tr_b16 a[6:7], v229 offset:20480
    buffer_load_dwordx4 v225, s[68:71], s25 offen lds
    v_mfma_f32_16x16x32_bf16 v[52:55], a[8:11], a[140:143], v[52:55]
    ds_read_b64_tr_b16 a[8:9], v230 offset:16384
    v_mfma_f32_16x16x32_bf16 v[60:63], a[12:15], a[140:143], v[60:63]
    ds_read_b64_tr_b16 a[10:11], v230 offset:20480
    s_add_u32 s25, s25, 0x10000
    buffer_load_dwordx4 a[132:135], v26, s[12:15], s24 offen offset:1024 sc1
    v_mfma_f32_16x16x32_bf16 v[56:59], a[12:15], a[136:139], v[56:59]
    ds_read_b64_tr_b16 a[12:13], v231 offset:16384
    s_waitcnt lgkmcnt(7)
    v_mfma_f32_16x16x32_bf16 v[64:67], a[16:19], a[136:139], v[64:67]
    ds_read_b64_tr_b16 a[14:15], v231 offset:20480
    s_add_u32 m0, s27, 69632
    v_mfma_f32_16x16x32_bf16 v[68:71], a[16:19], a[140:143], v[68:71]
    ds_read_b64_tr_b16 a[16:17], v232 offset:16384
    v_mfma_f32_16x16x32_bf16 v[76:79], a[20:23], a[140:143], v[76:79]
    ds_read_b64_tr_b16 a[18:19], v232 offset:20480
    buffer_load_dwordx4 v225, s[68:71], s25 offen lds
    v_mfma_f32_16x16x32_bf16 v[72:75], a[20:23], a[136:139], v[72:75]
    ds_read_b64_tr_b16 a[20:21], v233 offset:16384
    s_waitcnt lgkmcnt(7)
    v_mfma_f32_16x16x32_bf16 v[80:83], a[24:27], a[136:139], v[80:83]
    ds_read_b64_tr_b16 a[22:23], v233 offset:20480
    s_add_u32 s25, s25, 0x10000
    v_mfma_f32_16x16x32_bf16 v[84:87], a[24:27], a[140:143], v[84:87]
    ds_read_b64_tr_b16 a[24:25], v234 offset:16384
    v_mfma_f32_16x16x32_bf16 v[92:95], a[28:31], a[140:143], v[92:95]
    ds_read_b64_tr_b16 a[26:27], v234 offset:20480
    s_add_u32 s24, s24, 0x20000
    v_mfma_f32_16x16x32_bf16 v[88:91], a[28:31], a[136:139], v[88:91]
    ds_read_b64_tr_b16 a[28:29], v235 offset:16384
    ds_read_b64_tr_b16 a[30:31], v235 offset:20480
    s_waitcnt vmcnt(17)
    s_waitcnt lgkmcnt(8)
    v_mfma_f32_16x16x32_bf16 v[32:35], a[0:3], a[144:147], v[32:35]
    s_barrier
    buffer_load_dwordx4 a[136:139], v26, s[12:15], s24 offen offset:0 sc1
    v_mfma_f32_16x16x32_bf16 v[36:39], a[0:3], a[148:151], v[36:39]
    ds_read_b64_tr_b16 a[0:1], v228 offset:24576
    v_mfma_f32_16x16x32_bf16 v[44:47], a[4:7], a[148:151], v[44:47]
    ds_read_b64_tr_b16 a[2:3], v228 offset:28672
    s_add_u32 m0, s27, 73728
    v_mfma_f32_16x16x32_bf16 v[40:43], a[4:7], a[144:147], v[40:43]
    ds_read_b64_tr_b16 a[4:5], v229 offset:24576
    s_waitcnt lgkmcnt(7)
    v_mfma_f32_16x16x32_bf16 v[48:51], a[8:11], a[144:147], v[48:51]
    ds_read_b64_tr_b16 a[6:7], v229 offset:28672
    buffer_load_dwordx4 v225, s[68:71], s25 offen lds
    v_mfma_f32_16x16x32_bf16 v[52:55], a[8:11], a[148:151], v[52:55]
    ds_read_b64_tr_b16 a[8:9], v230 offset:24576
    v_mfma_f32_16x16x32_bf16 v[60:63], a[12:15], a[148:151], v[60:63]
    ds_read_b64_tr_b16 a[10:11], v230 offset:28672
    s_add_u32 s25, s25, 0x10000
    buffer_load_dwordx4 a[140:143], v26, s[12:15], s24 offen offset:1024 sc1
    v_mfma_f32_16x16x32_bf16 v[56:59], a[12:15], a[144:147], v[56:59]
    ds_read_b64_tr_b16 a[12:13], v231 offset:24576
    s_waitcnt lgkmcnt(7)
    v_mfma_f32_16x16x32_bf16 v[64:67], a[16:19], a[144:147], v[64:67]
    ds_read_b64_tr_b16 a[14:15], v231 offset:28672
    s_add_u32 m0, s27, 77824
    s_add_u32 s28, s25, s26
    v_mfma_f32_16x16x32_bf16 v[68:71], a[16:19], a[148:151], v[68:71]
    ds_read_b64_tr_b16 a[16:17], v232 offset:24576
    v_mfma_f32_16x16x32_bf16 v[76:79], a[20:23], a[148:151], v[76:79]
    ds_read_b64_tr_b16 a[18:19], v232 offset:28672
    buffer_load_dwordx4 v225, s[68:71], s28 offen lds
    v_mfma_f32_16x16x32_bf16 v[72:75], a[20:23], a[144:147], v[72:75]
    ds_read_b64_tr_b16 a[20:21], v233 offset:24576
    s_waitcnt lgkmcnt(7)
    v_mfma_f32_16x16x32_bf16 v[80:83], a[24:27], a[144:147], v[80:83]
    ds_read_b64_tr_b16 a[22:23], v233 offset:28672
    s_add_u32 s25, s25, 0x10000
    v_mfma_f32_16x16x32_bf16 v[84:87], a[24:27], a[148:151], v[84:87]
    ds_read_b64_tr_b16 a[24:25], v234 offset:24576
    v_mfma_f32_16x16x32_bf16 v[92:95], a[28:31], a[148:151], v[92:95]
    ds_read_b64_tr_b16 a[26:27], v234 offset:28672
    s_add_u32 s24, s24, 0x20000
    v_mfma_f32_16x16x32_bf16 v[88:91], a[28:31], a[144:147], v[88:91]
    ds_read_b64_tr_b16 a[28:29], v235 offset:24576
    ds_read_b64_tr_b16 a[30:31], v235 offset:28672
    s_waitcnt vmcnt(17)
    s_waitcnt lgkmcnt(8)
    v_mfma_f32_16x16x32_bf16 v[32:35], a[0:3], a[152:155], v[32:35]
    s_barrier
    buffer_load_dwordx4 a[144:147], v26, s[12:15], s24 offen offset:0 sc1
    v_mfma_f32_16x16x32_bf16 v[36:39], a[0:3], a[156:159], v[36:39]
    ds_read_b64_tr_b16 a[0:1], v228 offset:32768
    v_mfma_f32_16x16x32_bf16 v[44:47], a[4:7], a[156:159], v[44:47]
    ds_read_b64_tr_b16 a[2:3], v228 offset:36864
    s_add_u32 m0, s27, 81920
    v_mfma_f32_16x16x32_bf16 v[40:43], a[4:7], a[152:155], v[40:43]
    ds_read_b64_tr_b16 a[4:5], v229 offset:32768
    s_waitcnt lgkmcnt(7)
    v_mfma_f32_16x16x32_bf16 v[48:51], a[8:11], a[152:155], v[48:51]
    ds_read_b64_tr_b16 a[6:7], v229 offset:36864
    buffer_load_dwordx4 v225, s[68:71], s25 offen lds
    v_mfma_f32_16x16x32_bf16 v[52:55], a[8:11], a[156:159], v[52:55]
    ds_read_b64_tr_b16 a[8:9], v230 offset:32768
    v_mfma_f32_16x16x32_bf16 v[60:63], a[12:15], a[156:159], v[60:63]
    ds_read_b64_tr_b16 a[10:11], v230 offset:36864
    s_add_u32 s25, s25, 0x10000
    buffer_load_dwordx4 a[148:151], v26, s[12:15], s24 offen offset:1024 sc1
    v_mfma_f32_16x16x32_bf16 v[56:59], a[12:15], a[152:155], v[56:59]
    ds_read_b64_tr_b16 a[12:13], v231 offset:32768
    s_waitcnt lgkmcnt(7)
    v_mfma_f32_16x16x32_bf16 v[64:67], a[16:19], a[152:155], v[64:67]
    ds_read_b64_tr_b16 a[14:15], v231 offset:36864
    s_add_u32 m0, s27, 86016
    v_mfma_f32_16x16x32_bf16 v[68:71], a[16:19], a[156:159], v[68:71]
    ds_read_b64_tr_b16 a[16:17], v232 offset:32768
    v_mfma_f32_16x16x32_bf16 v[76:79], a[20:23], a[156:159], v[76:79]
    ds_read_b64_tr_b16 a[18:19], v232 offset:36864
    buffer_load_dwordx4 v225, s[68:71], s25 offen lds
    v_mfma_f32_16x16x32_bf16 v[72:75], a[20:23], a[152:155], v[72:75]
    ds_read_b64_tr_b16 a[20:21], v233 offset:32768
    s_waitcnt lgkmcnt(7)
    v_mfma_f32_16x16x32_bf16 v[80:83], a[24:27], a[152:155], v[80:83]
    ds_read_b64_tr_b16 a[22:23], v233 offset:36864
    s_add_u32 s25, s25, 0x10000
    v_mfma_f32_16x16x32_bf16 v[84:87], a[24:27], a[156:159], v[84:87]
    ds_read_b64_tr_b16 a[24:25], v234 offset:32768
    v_mfma_f32_16x16x32_bf16 v[92:95], a[28:31], a[156:159], v[92:95]
    ds_read_b64_tr_b16 a[26:27], v234 offset:36864
    s_add_u32 s24, s24, 0x20000
    v_mfma_f32_16x16x32_bf16 v[88:91], a[28:31], a[152:155], v[88:91]
    ds_read_b64_tr_b16 a[28:29], v235 offset:32768
    ds_read_b64_tr_b16 a[30:31], v235 offset:36864
    s_waitcnt vmcnt(17)
    s_waitcnt lgkmcnt(8)
    v_mfma_f32_16x16x32_bf16 v[32:35], a[0:3], a[160:163], v[32:35]
    s_barrier
    buffer_load_dwordx4 a[152:155], v26, s[12:15], s24 offen offset:0 sc1
    v_mfma_f32_16x16x32_bf16 v[36:39], a[0:3], a[164:167], v[36:39]
    ds_read_b64_tr_b16 a[0:1], v228 offset:40960
    v_mfma_f32_16x16x32_bf16 v[44:47], a[4:7], a[164:167], v[44:47]
    ds_read_b64_tr_b16 a[2:3], v228 offset:45056
    s_add_u32 m0, s27, 90112
    v_mfma_f32_16x16x32_bf16 v[40:43], a[4:7], a[160:163], v[40:43]
    ds_read_b64_tr_b16 a[4:5], v229 offset:40960
    s_waitcnt lgkmcnt(7)
    v_mfma_f32_16x16x32_bf16 v[48:51], a[8:11], a[160:163], v[48:51]
    ds_read_b64_tr_b16 a[6:7], v229 offset:45056
    buffer_load_dwordx4 v225, s[68:71], s25 offen lds
    v_mfma_f32_16x16x32_bf16 v[52:55], a[8:11], a[164:167], v[52:55]
    ds_read_b64_tr_b16 a[8:9], v230 offset:40960
    v_mfma_f32_16x16x32_bf16 v[60:63], a[12:15], a[164:167], v[60:63]
    ds_read_b64_tr_b16 a[10:11], v230 offset:45056
    s_add_u32 s25, s25, 0x10000
    buffer_load_dwordx4 a[156:159], v26, s[12:15], s24 offen offset:1024 sc1
    v_mfma_f32_16x16x32_bf16 v[56:59], a[12:15], a[160:163], v[56:59]
    ds_read_b64_tr_b16 a[12:13], v231 offset:40960
    s_waitcnt lgkmcnt(7)
    v_mfma_f32_16x16x32_bf16 v[64:67], a[16:19], a[160:163], v[64:67]
    ds_read_b64_tr_b16 a[14:15], v231 offset:45056
    s_add_u32 m0, s27, 94208
    v_mfma_f32_16x16x32_bf16 v[68:71], a[16:19], a[164:167], v[68:71]
    ds_read_b64_tr_b16 a[16:17], v232 offset:40960
    v_mfma_f32_16x16x32_bf16 v[76:79], a[20:23], a[164:167], v[76:79]
    ds_read_b64_tr_b16 a[18:19], v232 offset:45056
    buffer_load_dwordx4 v225, s[68:71], s25 offen lds
    v_mfma_f32_16x16x32_bf16 v[72:75], a[20:23], a[160:163], v[72:75]
    ds_read_b64_tr_b16 a[20:21], v233 offset:40960
    s_waitcnt lgkmcnt(7)
    v_mfma_f32_16x16x32_bf16 v[80:83], a[24:27], a[160:163], v[80:83]
    ds_read_b64_tr_b16 a[22:23], v233 offset:45056
    s_add_u32 s25, s25, 0x10000
    v_mfma_f32_16x16x32_bf16 v[84:87], a[24:27], a[164:167], v[84:87]
    ds_read_b64_tr_b16 a[24:25], v234 offset:40960
    v_mfma_f32_16x16x32_bf16 v[92:95], a[28:31], a[164:167], v[92:95]
    ds_read_b64_tr_b16 a[26:27], v234 offset:45056
    s_add_u32 s24, s24, 0x20000
    v_mfma_f32_16x16x32_bf16 v[88:91], a[28:31], a[160:163], v[88:91]
    ds_read_b64_tr_b16 a[28:29], v235 offset:40960
    ds_read_b64_tr_b16 a[30:31], v235 offset:45056
    s_waitcnt vmcnt(16)
    s_waitcnt lgkmcnt(8)
    v_mfma_f32_16x16x32_bf16 v[32:35], a[0:3], a[168:171], v[32:35]
    s_barrier
    buffer_load_dwordx4 a[160:163], v26, s[12:15], s24 offen offset:0 sc1
    v_mfma_f32_16x16x32_bf16 v[36:39], a[0:3], a[172:175], v[36:39]
    ds_read_b64_tr_b16 a[0:1], v228 offset:49152
    v_mfma_f32_16x16x32_bf16 v[44:47], a[4:7], a[172:175], v[44:47]
    ds_read_b64_tr_b16 a[2:3], v228 offset:53248
    s_add_u32 m0, s27, 98304
    v_mfma_f32_16x16x32_bf16 v[40:43], a[4:7], a[168:171], v[40:43]
    ds_read_b64_tr_b16 a[4:5], v229 offset:49152
    v_cmp_ne_u32 vcc, s60, v251
    s_cbranch_vccnz L_ypoll_spin
L_ypoll_ok:
    s_add_u32 s44, s50, 0
    buffer_load_dwordx4 v[168:171], v241, s[12:15], s44 offen sc1
    s_add_u32 s44, s50, 65536
    buffer_load_dwordx4 v[172:175], v241, s[12:15], s44 offen sc1
    s_waitcnt lgkmcnt(7)
    v_mfma_f32_16x16x32_bf16 v[48:51], a[8:11], a[168:171], v[48:51]
    ds_read_b64_tr_b16 a[6:7], v229 offset:53248
    buffer_load_dwordx4 v225, s[68:71], s25 offen lds
    v_mfma_f32_16x16x32_bf16 v[52:55], a[8:11], a[172:175], v[52:55]
    ds_read_b64_tr_b16 a[8:9], v230 offset:49152
    s_add_u32 s44, s50, 131072
    buffer_load_dwordx4 v[176:179], v241, s[12:15], s44 offen sc1
    s_add_u32 s44, s50, 196608
    buffer_load_dwordx4 v[180:183], v241, s[12:15], s44 offen sc1
    v_mfma_f32_16x16x32_bf16 v[60:63], a[12:15], a[172:175], v[60:63]
    ds_read_b64_tr_b16 a[10:11], v230 offset:53248
    s_add_u32 s25, s25, 0x10000
    buffer_load_dwordx4 a[164:167], v26, s[12:15], s24 offen offset:1024 sc1
    v_mfma_f32_16x16x32_bf16 v[56:59], a[12:15], a[168:171], v[56:59]
    ds_read_b64_tr_b16 a[12:13], v231 offset:49152
    s_waitcnt lgkmcnt(7)
    v_mfma_f32_16x16x32_bf16 v[64:67], a[16:19], a[168:171], v[64:67]
    ds_read_b64_tr_b16 a[14:15], v231 offset:53248
    s_add_u32 m0, s27, 102400
    v_mfma_f32_16x16x32_bf16 v[68:71], a[16:19], a[172:175], v[68:71]
    ds_read_b64_tr_b16 a[16:17], v232 offset:49152
    v_mfma_f32_16x16x32_bf16 v[76:79], a[20:23], a[172:175], v[76:79]
    ds_read_b64_tr_b16 a[18:19], v232 offset:53248
    buffer_load_dwordx4 v225, s[68:71], s25 offen lds
    v_mfma_f32_16x16x32_bf16 v[72:75], a[20:23], a[168:171], v[72:75]
    ds_read_b64_tr_b16 a[20:21], v233 offset:49152
    s_waitcnt lgkmcnt(7)
    v_mfma_f32_16x16x32_bf16 v[80:83], a[24:27], a[168:171], v[80:83]
    ds_read_b64_tr_b16 a[22:23], v233 offset:53248
    s_add_u32 s25, s25, 0x10000
    v_mfma_f32_16x16x32_bf16 v[84:87], a[24:27], a[172:175], v[84:87]
    ds_read_b64_tr_b16 a[24:25], v234 offset:49152
    v_mfma_f32_16x16x32_bf16 v[92:95], a[28:31], a[172:175], v[92:95]
    ds_read_b64_tr_b16 a[26:27], v234 offset:53248
    s_add_u32 s24, s24, 0x20000
    v_mfma_f32_16x16x32_bf16 v[88:91], a[28:31], a[168:171], v[88:91]
    ds_read_b64_tr_b16 a[28:29], v235 offset:49152
    ds_read_b64_tr_b16 a[30:31], v235 offset:53248
    s_waitcnt vmcnt(20)
    s_waitcnt lgkmcnt(8)
    v_mfma_f32_16x16x32_bf16 v[32:35], a[0:3], a[176:179], v[32:35]
    s_barrier
    buffer_load_dwordx4 a[168:171], v26, s[12:15], s24 offen offset:0 sc1
    v_mfma_f32_16x16x32_bf16 v[36:39], a[0:3], a[180:183], v[36:39]
    ds_read_b64_tr_b16 a[0:1], v236 offset:0
    v_mfma_f32_16x16x32_bf16 v[44:47], a[4:7], a[180:183], v[44:47]
    ds_read_b64_tr_b16 a[2:3], v236 offset:2048
    s_add_u32 m0, s27, 106496
    s_add_u32 s28, s25, s26
    v_mfma_f32_16x16x32_bf16 v[40:43], a[4:7], a[176:179], v[40:43]
    ds_read_b64_tr_b16 a[4:5], v237 offset:0
    s_waitcnt lgkmcnt(7)
    v_mfma_f32_16x16x32_bf16 v[48:51], a[8:11], a[176:179], v[48:51]
    ds_read_b64_tr_b16 a[6:7], v237 offset:2048
    buffer_load_dwordx4 v225, s[68:71], s28 offen lds
    v_mfma_f32_16x16x32_bf16 v[52:55], a[8:11], a[180:183], v[52:55]
    ds_read_b64_tr_b16 a[8:9], v238 offset:0
    v_mfma_f32_16x16x32_bf16 v[60:63], a[12:15], a[180:183], v[60:63]
    ds_read_b64_tr_b16 a[10:11], v238 offset:2048
    s_add_u32 s25, s25, 0x10000
    buffer_load_dwordx4 a[172:175], v26, s[12:15], s24 offen offset:1024 sc1
    v_mfma_f32_16x16x32_bf16 v[56:59], a[12:15], a[176:179], v[56:59]
    ds_read_b64_tr_b16 a[12:13], v239 offset:0
    s_waitcnt lgkmcnt(7)
    v_mfma_f32_16x16x32_bf16 v[64:67], a[16:19], a[176:179], v[64:67]
    ds_read_b64_tr_b16 a[14:15], v239 offset:2048
    s_add_u32 m0, s27, 110592
    v_mfma_f32_16x16x32_bf16 v[68:71], a[16:19], a[180:183], v[68:71]
    ds_read_b64_tr_b16 a[16:17], v236 offset:4096
    v_mfma_f32_16x16x32_bf16 v[76:79], a[20:23], a[180:183], v[76:79]
    ds_read_b64_tr_b16 a[18:19], v236 offset:6144
    buffer_load_dwordx4 v225, s[68:71], s25 offen lds
    v_mfma_f32_16x16x32_bf16 v[72:75], a[20:23], a[176:179], v[72:75]
    ds_read_b64_tr_b16 a[20:21], v237 offset:4096
    s_waitcnt lgkmcnt(7)
    v_mfma_f32_16x16x32_bf16 v[80:83], a[24:27], a[176:179], v[80:83]
    ds_read_b64_tr_b16 a[22:23], v237 offset:6144
    s_add_u32 s25, s25, 0x10000
    v_mfma_f32_16x16x32_bf16 v[84:87], a[24:27], a[180:183], v[84:87]
    ds_read_b64_tr_b16 a[24:25], v238 offset:4096
    v_mfma_f32_16x16x32_bf16 v[92:95], a[28:31], a[180:183], v[92:95]
    ds_read_b64_tr_b16 a[26:27], v238 offset:6144
    s_add_u32 s24, s24, 0x20000
    v_mfma_f32_16x16x32_bf16 v[88:91], a[28:31], a[176:179], v[88:91]
    ds_read_b64_tr_b16 a[28:29], v239 offset:4096
    ds_read_b64_tr_b16 a[30:31], v239 offset:6144
    s_waitcnt vmcnt(20)
    s_waitcnt lgkmcnt(8)
    v_mfma_f32_16x16x32_bf16 v[32:35], a[0:3], a[128:131], v[32:35]
    s_barrier
    buffer_load_dwordx4 a[176:179], v26, s[12:15], s24 offen offset:0 sc1
    v_mfma_f32_16x16x32_bf16 v[36:39], a[0:3], a[132:135], v[36:39]
    ds_read_b64_tr_b16 a[0:1], v236 offset:8192
    v_mfma_f32_16x16x32_bf16 v[44:47], a[4:7], a[132:135], v[44:47]
    ds_read_b64_tr_b16 a[2:3], v236 offset:10240
    s_add_u32 m0, s27, 114688
    v_cvt_pk_bf16_f32 v184, v64, v65
    v_cvt_pk_bf16_f32 v185, v66, v67
    v_cvt_pk_bf16_f32 v186, v68, v69
    v_cvt_pk_bf16_f32 v187, v70, v71
    v_min_u32 v184, -2, v184
    v_min_u32 v185, -2, v185
    v_min_u32 v186, -2, v186
    v_min_u32 v187, -2, v187
    buffer_store_dwordx4 v[184:187], v26, s[12:15], s51 offen offset:0 sc0 sc1
    v_mfma_f32_16x16x32_bf16 v[40:43], a[4:7], a[128:131], v[40:43]
    ds_read_b64_tr_b16 a[4:5], v237 offset:8192
    s_waitcnt lgkmcnt(7)
    v_mfma_f32_16x16x32_bf16 v[48:51], a[8:11], a[128:131], v[48:51]
    ds_read_b64_tr_b16 a[6:7], v237 offset:10240
    buffer_load_dwordx4 v225, s[68:71], s25 offen lds
    v_mfma_f32_16x16x32_bf16 v[52:55], a[8:11], a[132:135], v[52:55]
    ds_read_b64_tr_b16 a[8:9], v238 offset:8192
    buffer_load_dwordx4 a[180:183], v26, s[12:15], s24 offen offset:1024 sc1
    v_cvt_pk_bf16_f32 v188, v72, v73
    v_cvt_pk_bf16_f32 v189, v74, v75
    v_cvt_pk_bf16_f32 v190, v76, v77
    v_cvt_pk_bf16_f32 v191, v78, v79
    v_min_u32 v188, -2, v188
    v_min_u32 v189, -2, v189
    v_min_u32 v190, -2, v190
    v_min_u32 v191, -2, v191
    buffer_store_dwordx4 v[188:191], v26, s[12:15], s51 offen offset:1024 sc0 sc1
    v_mfma_f32_16x16x32_bf16 v[60:63], a[12:15], a[132:135], v[60:63]
    ds_read_b64_tr_b16 a[10:11], v238 offset:10240
    s_add_u32 s25, s25, 0x10000
    v_mfma_f32_16x16x32_bf16 v[56:59], a[12:15], a[128:131], v[56:59]
    ds_read_b64_tr_b16 a[12:13], v239 offset:8192
    s_add_u32 s24, s24, 0x20000
    s_waitcnt lgkmcnt(7)
    v_mfma_f32_16x16x32_bf16 v[32:35], a[16:19], a[136:139], v[32:35]
    ds_read_b64_tr_b16 a[14:15], v239 offset:10240
    s_add_u32 m0, s27, 118784
    v_cvt_pk_bf16_f32 v192, v80, v81
    v_cvt_pk_bf16_f32 v193, v82, v83
    v_cvt_pk_bf16_f32 v194, v84, v85
    v_cvt_pk_bf16_f32 v195, v86, v87
    v_min_u32 v192, -2, v192
    v_min_u32 v193, -2, v193
    v_min_u32 v194, -2, v194
    v_min_u32 v195, -2, v195
    buffer_store_dwordx4 v[192:195], v26, s[12:15], s51 offen offset:2048 sc0 sc1
    v_mfma_f32_16x16x32_bf16 v[36:39], a[16:19], a[140:143], v[36:39]
    ds_read_b64_tr_b16 a[16:17], v236 offset:12288
    buffer_load_dwordx4 a[128:131], v26, s[12:15], s24 offen offset:0 sc1
    v_mfma_f32_16x16x32_bf16 v[44:47], a[20:23], a[140:143], v[44:47]
    ds_read_b64_tr_b16 a[18:19], v236 offset:14336
    buffer_load_dwordx4 v225, s[68:71], s25 offen lds
    v_mfma_f32_16x16x32_bf16 v[40:43], a[20:23], a[136:139], v[40:43]
    ds_read_b64_tr_b16 a[20:21], v237 offset:12288
    v_cvt_pk_bf16_f32 v196, v88, v89
    v_cvt_pk_bf16_f32 v197, v90, v91
    v_cvt_pk_bf16_f32 v198, v92, v93
    v_cvt_pk_bf16_f32 v199, v94, v95
    v_min_u32 v196, -2, v196
    v_min_u32 v197, -2, v197
    v_min_u32 v198, -2, v198
    v_min_u32 v199, -2, v199
    buffer_store_dwordx4 v[196:199], v26, s[12:15], s51 offen offset:3072 sc0 sc1
    s_waitcnt lgkmcnt(7)
    v_mfma_f32_16x16x32_bf16 v[48:51], a[24:27], a[136:139], v[48:51]
    ds_read_b64_tr_b16 a[22:23], v237 offset:14336
    s_add_u32 s25, s25, 0x10000
    v_mfma_f32_16x16x32_bf16 v[52:55], a[24:27], a[140:143], v[52:55]
    ds_read_b64_tr_b16 a[24:25], v238 offset:12288
    buffer_load_dwordx4 a[132:135], v26, s[12:15], s24 offen offset:1024 sc1
    v_mfma_f32_16x16x32_bf16 v[60:63], a[28:31], a[140:143], v[60:63]
    ds_read_b64_tr_b16 a[26:27], v238 offset:14336
    s_add_u32 s24, s24, 0x20000
    v_mfma_f32_16x16x32_bf16 v[56:59], a[28:31], a[136:139], v[56:59]
    ds_read_b64_tr_b16 a[28:29], v239 offset:12288
    ds_read_b64_tr_b16 a[30:31], v239 offset:14336
    s_waitcnt vmcnt(26)
    s_waitcnt lgkmcnt(8)
    v_mfma_f32_16x16x32_bf16 v[32:35], a[0:3], a[144:147], v[32:35]
    s_barrier
    buffer_load_dwordx4 a[136:139], v26, s[12:15], s24 offen offset:0 sc1
    v_mfma_f32_16x16x32_bf16 v[36:39], a[0:3], a[148:151], v[36:39]
    ds_read_b64_tr_b16 a[0:1], v236 offset:16384
    v_mfma_f32_16x16x32_bf16 v[44:47], a[4:7], a[148:151], v[44:47]
    ds_read_b64_tr_b16 a[2:3], v236 offset:18432
    v_mfma_f32_16x16x32_bf16 v[40:43], a[4:7], a[144:147], v[40:43]
    ds_read_b64_tr_b16 a[4:5], v237 offset:16384
    s_waitcnt lgkmcnt(7)
    v_mfma_f32_16x16x32_bf16 v[48:51], a[8:11], a[144:147], v[48:51]
    ds_read_b64_tr_b16 a[6:7], v237 offset:18432
    v_mfma_f32_16x16x32_bf16 v[52:55], a[8:11], a[148:151], v[52:55]
    ds_read_b64_tr_b16 a[8:9], v238 offset:16384
    buffer_load_dwordx4 a[140:143], v26, s[12:15], s24 offen offset:1024 sc1
    v_mfma_f32_16x16x32_bf16 v[60:63], a[12:15], a[148:151], v[60:63]
    ds_read_b64_tr_b16 a[10:11], v238 offset:18432
    v_mfma_f32_16x16x32_bf16 v[56:59], a[12:15], a[144:147], v[56:59]
    ds_read_b64_tr_b16 a[12:13], v239 offset:16384
    s_add_u32 s24, s24, 0x20000
    s_waitcnt lgkmcnt(7)
    s_waitcnt vmcnt(25)
    v_mfma_f32_16x16x32_bf16 v[32:35], a[16:19], a[152:155], v[32:35]
    ds_read_b64_tr_b16 a[14:15], v239 offset:18432
    v_mfma_f32_16x16x32_bf16 v[36:39], a[16:19], a[156:159], v[36:39]
    ds_read_b64_tr_b16 a[16:17], v236 offset:20480
    buffer_load_dwordx4 a[144:147], v26, s[12:15], s24 offen offset:0 sc1
    v_mfma_f32_16x16x32_bf16 v[44:47], a[20:23], a[156:159], v[44:47]
    ds_read_b64_tr_b16 a[18:19], v236 offset:22528
    v_mfma_f32_16x16x32_bf16 v[40:43], a[20:23], a[152:155], v[40:43]
    ds_read_b64_tr_b16 a[20:21], v237 offset:20480
    s_waitcnt lgkmcnt(7)
    v_mfma_f32_16x16x32_bf16 v[48:51], a[24:27], a[152:155], v[48:51]
    ds_read_b64_tr_b16 a[22:23], v237 offset:22528
    v_mfma_f32_16x16x32_bf16 v[52:55], a[24:27], a[156:159], v[52:55]
    ds_read_b64_tr_b16 a[24:25], v238 offset:20480
    buffer_load_dwordx4 a[148:151], v26, s[12:15], s24 offen offset:1024 sc1
    v_mfma_f32_16x16x32_bf16 v[60:63], a[28:31], a[156:159], v[60:63]
    ds_read_b64_tr_b16 a[26:27], v238 offset:22528
    s_add_u32 s24, s24, 0x20000
    v_mfma_f32_16x16x32_bf16 v[56:59], a[28:31], a[152:155], v[56:59]
    ds_read_b64_tr_b16 a[28:29], v239 offset:20480
    ds_read_b64_tr_b16 a[30:31], v239 offset:22528
    s_waitcnt vmcnt(19)
    s_waitcnt lgkmcnt(8)
    v_mfma_f32_16x16x32_bf16 v[32:35], a[0:3], a[160:163], v[32:35]
    s_barrier
    buffer_load_dwordx4 a[152:155], v26, s[12:15], s24 offen offset:0 sc1
    v_mfma_f32_16x16x32_bf16 v[36:39], a[0:3], a[164:167], v[36:39]
    ds_read_b64_tr_b16 a[0:1], v236 offset:24576
    v_mfma_f32_16x16x32_bf16 v[44:47], a[4:7], a[164:167], v[44:47]
    ds_read_b64_tr_b16 a[2:3], v236 offset:26624
    v_mfma_f32_16x16x32_bf16 v[40:43], a[4:7], a[160:163], v[40:43]
    ds_read_b64_tr_b16 a[4:5], v237 offset:24576
    s_waitcnt lgkmcnt(7)
    v_mfma_f32_16x16x32_bf16 v[48:51], a[8:11], a[160:163], v[48:51]
    ds_read_b64_tr_b16 a[6:7], v237 offset:26624
    v_mfma_f32_16x16x32_bf16 v[52:55], a[8:11], a[164:167], v[52:55]
    ds_read_b64_tr_b16 a[8:9], v238 offset:24576
    buffer_load_dwordx4 a[156:159], v26, s[12:15], s24 offen offset:1024 sc1
    v_mfma_f32_16x16x32_bf16 v[60:63], a[12:15], a[164:167], v[60:63]
    ds_read_b64_tr_b16 a[10:11], v238 offset:26624
    v_mfma_f32_16x16x32_bf16 v[56:59], a[12:15], a[160:163], v[56:59]
    ds_read_b64_tr_b16 a[12:13], v239 offset:24576
    s_add_u32 s24, s24, 0x20000
    s_waitcnt lgkmcnt(7)
    s_waitcnt vmcnt(17)
    v_mfma_f32_16x16x32_bf16 v[32:35], a[16:19], a[168:171], v[32:35]
    ds_read_b64_tr_b16 a[14:15], v239 offset:26624
    v_mfma_f32_16x16x32_bf16 v[36:39], a[16:19], a[172:175], v[36:39]
    ds_read_b64_tr_b16 a[16:17], v236 offset:28672
    buffer_load_dwordx4 a[160:163], v26, s[12:15], s24 offen offset:0 sc1
    v_mfma_f32_16x16x32_bf16 v[44:47], a[20:23], a[172:175], v[44:47]
    ds_read_b64_tr_b16 a[18:19], v236 offset:30720
    v_mfma_f32_16x16x32_bf16 v[40:43], a[20:23], a[168:171], v[40:43]
    ds_read_b64_tr_b16 a[20:21], v237 offset:28672
    s_waitcnt lgkmcnt(7)
    v_mfma_f32_16x16x32_bf16 v[48:51], a[24:27], a[168:171], v[48:51]
    ds_read_b64_tr_b16 a[22:23], v237 offset:30720
    v_mfma_f32_16x16x32_bf16 v[52:55], a[24:27], a[172:175], v[52:55]
    ds_read_b64_tr_b16 a[24:25], v238 offset:28672
    buffer_load_dwordx4 a[164:167], v26, s[12:15], s24 offen offset:1024 sc1
    v_mfma_f32_16x16x32_bf16 v[60:63], a[28:31], a[172:175], v[60:63]
    ds_read_b64_tr_b16 a[26:27], v238 offset:30720
    s_add_u32 s24, s24, 0x20000
    v_mfma_f32_16x16x32_bf16 v[56:59], a[28:31], a[168:171], v[56:59]
    ds_read_b64_tr_b16 a[28:29], v239 offset:28672
    ds_read_b64_tr_b16 a[30:31], v239 offset:30720
    s_waitcnt vmcnt(14)
    s_waitcnt lgkmcnt(8)
    v_mfma_f32_16x16x32_bf16 v[32:35], a[0:3], a[176:179], v[32:35]
    s_barrier
    buffer_load_dwordx4 a[168:171], v26, s[12:15], s24 offen offset:0 sc1
    v_mfma_f32_16x16x32_bf16 v[36:39], a[0:3], a[180:183], v[36:39]
    ds_read_b64_tr_b16 a[0:1], v236 offset:32768
    v_mfma_f32_16x16x32_bf16 v[44:47], a[4:7], a[180:183], v[44:47]
    ds_read_b64_tr_b16 a[2:3], v236 offset:34816
    v_mfma_f32_16x16x32_bf16 v[40:43], a[4:7], a[176:179], v[40:43]
    ds_read_b64_tr_b16 a[4:5], v237 offset:32768
    s_waitcnt lgkmcnt(7)
    v_mfma_f32_16x16x32_bf16 v[48:51], a[8:11], a[176:179], v[48:51]
    ds_read_b64_tr_b16 a[6:7], v237 offset:34816
    v_mfma_f32_16x16x32_bf16 v[52:55], a[8:11], a[180:183], v[52:55]
    ds_read_b64_tr_b16 a[8:9], v238 offset:32768
    buffer_load_dwordx4 a[172:175], v26, s[12:15], s24 offen offset:1024 sc1
    v_mfma_f32_16x16x32_bf16 v[60:63], a[12:15], a[180:183], v[60:63]
    ds_read_b64_tr_b16 a[10:11], v238 offset:34816
    v_mfma_f32_16x16x32_bf16 v[56:59], a[12:15], a[176:179], v[56:59]
    ds_read_b64_tr_b16 a[12:13], v239 offset:32768
    s_add_u32 s24, s24, 0x20000
    s_waitcnt lgkmcnt(7)
    s_waitcnt vmcnt(10)
    v_mfma_f32_16x16x32_bf16 v[32:35], a[16:19], a[128:131], v[32:35]
    ds_read_b64_tr_b16 a[14:15], v239 offset:34816
    v_mfma_f32_16x16x32_bf16 v[36:39], a[16:19], a[132:135], v[36:39]
    ds_read_b64_tr_b16 a[16:17], v236 offset:36864
    buffer_load_dwordx4 a[176:179], v26, s[12:15], s24 offen offset:0 sc1
    v_mfma_f32_16x16x32_bf16 v[44:47], a[20:23], a[132:135], v[44:47]
    ds_read_b64_tr_b16 a[18:19], v236 offset:38912
    v_mfma_f32_16x16x32_bf16 v[40:43], a[20:23], a[128:131], v[40:43]
    ds_read_b64_tr_b16 a[20:21], v237 offset:36864
    s_waitcnt lgkmcnt(7)
    v_mfma_f32_16x16x32_bf16 v[48:51], a[24:27], a[128:131], v[48:51]
    ds_read_b64_tr_b16 a[22:23], v237 offset:38912
    v_mfma_f32_16x16x32_bf16 v[52:55], a[24:27], a[132:135], v[52:55]
    ds_read_b64_tr_b16 a[24:25], v238 offset:36864
    buffer_load_dwordx4 a[180:183], v26, s[12:15], s24 offen offset:1024 sc1
    v_mfma_f32_16x16x32_bf16 v[60:63], a[28:31], a[132:135], v[60:63]
    ds_read_b64_tr_b16 a[26:27], v238 offset:38912
    s_add_u32 s24, s24, 0x20000
    v_mfma_f32_16x16x32_bf16 v[56:59], a[28:31], a[128:131], v[56:59]
    ds_read_b64_tr_b16 a[28:29], v239 offset:36864
    ds_read_b64_tr_b16 a[30:31], v239 offset:38912
    s_waitcnt vmcnt(10)
    s_waitcnt lgkmcnt(8)
    v_mfma_f32_16x16x32_bf16 v[32:35], a[0:3], a[136:139], v[32:35]
    s_barrier
    v_mfma_f32_16x16x32_bf16 v[36:39], a[0:3], a[140:143], v[36:39]
    ds_read_b64_tr_b16 a[0:1], v236 offset:40960
    v_mfma_f32_16x16x32_bf16 v[44:47], a[4:7], a[140:143], v[44:47]
    ds_read_b64_tr_b16 a[2:3], v236 offset:43008
    v_mfma_f32_16x16x32_bf16 v[40:43], a[4:7], a[136:139], v[40:43]
    ds_read_b64_tr_b16 a[4:5], v237 offset:40960
    s_mul_i32 s44, s32, 4352
    s_add_u32 s44, s44, 122880
    v_add_u32 v4, s44, v26
    ds_write_b128 v4, v[168:171] offset:0
    ds_write_b128 v4, v[172:175] offset:1024
    ds_write_b128 v4, v[176:179] offset:2048
    ds_write_b128 v4, v[180:183] offset:3072
    s_waitcnt lgkmcnt(8)
    v_mfma_f32_16x16x32_bf16 v[48:51], a[8:11], a[136:139], v[48:51]
    ds_read_b64_tr_b16 a[6:7], v237 offset:43008
    v_mfma_f32_16x16x32_bf16 v[52:55], a[8:11], a[140:143], v[52:55]
    ds_read_b64_tr_b16 a[8:9], v238 offset:40960
    v_mfma_f32_16x16x32_bf16 v[60:63], a[12:15], a[140:143], v[60:63]
    ds_read_b64_tr_b16 a[10:11], v238 offset:43008
    v_mfma_f32_16x16x32_bf16 v[56:59], a[12:15], a[136:139], v[56:59]
    ds_read_b64_tr_b16 a[12:13], v239 offset:40960
    s_waitcnt lgkmcnt(11)
    s_waitcnt vmcnt(8)
    v_mfma_f32_16x16x32_bf16 v[32:35], a[16:19], a[144:147], v[32:35]
    ds_read_b64_tr_b16 a[14:15], v239 offset:43008
    v_mfma_f32_16x16x32_bf16 v[36:39], a[16:19], a[148:151], v[36:39]
    ds_read_b64_tr_b16 a[16:17], v236 offset:45056
    v_mfma_f32_16x16x32_bf16 v[44:47], a[20:23], a[148:151], v[44:47]
    ds_read_b64_tr_b16 a[18:19], v236 offset:47104
    v_mfma_f32_16x16x32_bf16 v[40:43], a[20:23], a[144:147], v[40:43]
    ds_read_b64_tr_b16 a[20:21], v237 offset:45056
    s_waitcnt lgkmcnt(8)
    s_waitcnt lgkmcnt(7)
    v_mfma_f32_16x16x32_bf16 v[48:51], a[24:27], a[144:147], v[48:51]
    ds_read_b64_tr_b16 a[22:23], v237 offset:47104
    v_mfma_f32_16x16x32_bf16 v[52:55], a[24:27], a[148:151], v[52:55]
    ds_read_b64_tr_b16 a[24:25], v238 offset:45056
    v_mfma_f32_16x16x32_bf16 v[60:63], a[28:31], a[148:151], v[60:63]
    ds_read_b64_tr_b16 a[26:27], v238 offset:47104
    v_mfma_f32_16x16x32_bf16 v[56:59], a[28:31], a[144:147], v[56:59]
    ds_read_b64_tr_b16 a[28:29], v239 offset:45056
    ds_read_b64_tr_b16 a[30:31], v239 offset:47104
    s_waitcnt vmcnt(6)
    s_waitcnt lgkmcnt(8)
    v_mfma_f32_16x16x32_bf16 v[32:35], a[0:3], a[152:155], v[32:35]
    s_barrier
    v_mfma_f32_16x16x32_bf16 v[36:39], a[0:3], a[156:159], v[36:39]
    ds_read_b64_tr_b16 a[0:1], v236 offset:49152
    buffer_load_dwordx4 v[184:187], v26, s[12:15], s52 offen offset:0 sc1
    buffer_load_dwordx4 v[188:191], v26, s[12:15], s52 offen offset:1024 sc1
    buffer_load_dwordx4 v[192:195], v26, s[12:15], s52 offen offset:2048 sc1
    buffer_load_dwordx4 v[196:199], v26, s[12:15], s52 offen offset:3072 sc1
    v_mfma_f32_16x16x32_bf16 v[44:47], a[4:7], a[156:159], v[44:47]
    ds_read_b64_tr_b16 a[2:3], v236 offset:51200
    ds_read_b64_tr_b16 v[96:97], v242 offset:0
    ds_read_b64_tr_b16 v[98:99], v242 offset:32
    v_mfma_f32_16x16x32_bf16 v[40:43], a[4:7], a[152:155], v[40:43]
    ds_read_b64_tr_b16 a[4:5], v237 offset:49152
    s_waitcnt lgkmcnt(9)
    v_mfma_f32_16x16x32_bf16 v[48:51], a[8:11], a[152:155], v[48:51]
    ds_read_b64_tr_b16 a[6:7], v237 offset:51200
    v_mfma_f32_16x16x32_bf16 v[52:55], a[8:11], a[156:159], v[52:55]
    ds_read_b64_tr_b16 a[8:9], v238 offset:49152
    ds_read_b64_tr_b16 v[100:101], v242 offset:1024
    ds_read_b64_tr_b16 v[102:103], v242 offset:1056
    v_mfma_f32_16x16x32_bf16 v[60:63], a[12:15], a[156:159], v[60:63]
    ds_read_b64_tr_b16 a[10:11], v238 offset:51200
    v_mfma_f32_16x16x32_bf16 v[56:59], a[12:15], a[152:155], v[56:59]
    ds_read_b64_tr_b16 a[12:13], v239 offset:49152
    s_waitcnt lgkmcnt(8)
    s_waitcnt vmcnt(8)
    v_mfma_f32_16x16x32_bf16 v[32:35], a[16:19], a[160:163], v[32:35]
    ds_read_b64_tr_b16 a[14:15], v239 offset:51200
    ds_read_b64_tr_b16 v[104:105], v242 offset:2048
    ds_read_b64_tr_b16 v[106:107], v242 offset:2080
    v_mfma_f32_16x16x32_bf16 v[36:39], a[16:19], a[164:167], v[36:39]
    ds_read_b64_tr_b16 a[16:17], v236 offset:53248
    v_mfma_f32_16x16x32_bf16 v[44:47], a[20:23], a[164:167], v[44:47]
    ds_read_b64_tr_b16 a[18:19], v236 offset:55296
    v_mfma_f32_16x16x32_bf16 v[40:43], a[20:23], a[160:163], v[40:43]
    ds_read_b64_tr_b16 a[20:21], v237 offset:53248
    ds_read_b64_tr_b16 v[108:109], v242 offset:3072
    s_waitcnt lgkmcnt(8)
    ds_read_b64_tr_b16 v[110:111], v242 offset:3104
    v_mfma_f32_16x16x32_bf16 v[48:51], a[24:27], a[160:163], v[48:51]
    ds_read_b64_tr_b16 a[22:23], v237 offset:55296
    v_mfma_f32_16x16x32_bf16 v[52:55], a[24:27], a[164:167], v[52:55]
    ds_read_b64_tr_b16 a[24:25], v238 offset:53248
    v_mfma_f32_16x16x32_bf16 v[60:63], a[28:31], a[164:167], v[60:63]
    ds_read_b64_tr_b16 a[26:27], v238 offset:55296
    v_mfma_f32_16x16x32_bf16 v[56:59], a[28:31], a[160:163], v[56:59]
    ds_read_b64_tr_b16 a[28:29], v239 offset:53248
    ds_read_b64_tr_b16 a[30:31], v239 offset:55296
    s_waitcnt vmcnt(6)
    s_waitcnt lgkmcnt(12)
    v_mfma_f32_16x16x32_bf16 v[32:35], a[0:3], a[168:171], v[32:35]
    v_mfma_f32_16x16x32_bf16 v[36:39], a[0:3], a[172:175], v[36:39]
    v_mfma_f32_16x16x32_bf16 v[44:47], a[4:7], a[172:175], v[44:47]
    v_mfma_f32_16x16x32_bf16 v[40:43], a[4:7], a[168:171], v[40:43]
    s_waitcnt lgkmcnt(4)
    v_mfma_f32_16x16x32_bf16 v[48:51], a[8:11], a[168:171], v[48:51]
    v_mfma_f32_16x16x32_bf16 v[52:55], a[8:11], a[172:175], v[52:55]
    v_mfma_f32_16x16x32_bf16 v[60:63], a[12:15], a[172:175], v[60:63]
    v_mfma_f32_16x16x32_bf16 v[56:59], a[12:15], a[168:171], v[56:59]
    s_waitcnt lgkmcnt(0)
    s_waitcnt vmcnt(4)
    v_mfma_f32_16x16x32_bf16 v[32:35], a[16:19], a[176:179], v[32:35]
    v_mfma_f32_16x16x32_bf16 v[36:39], a[16:19], a[180:183], v[36:39]
    v_mfma_f32_16x16x32_bf16 v[44:47], a[20:23], a[180:183], v[44:47]
    v_mfma_f32_16x16x32_bf16 v[40:43], a[20:23], a[176:179], v[40:43]
    v_mfma_f32_16x16x32_bf16 v[48:51], a[24:27], a[176:179], v[48:51]
    v_mfma_f32_16x16x32_bf16 v[52:55], a[24:27], a[180:183], v[52:55]
    v_mfma_f32_16x16x32_bf16 v[60:63], a[28:31], a[180:183], v[60:63]
    v_mfma_f32_16x16x32_bf16 v[56:59], a[28:31], a[176:179], v[56:59]
    v_accvgpr_read_b32 v152, a192
    v_accvgpr_read_b32 v153, a193
    v_accvgpr_read_b32 v154, a194
    v_accvgpr_read_b32 v155, a195
    v_accvgpr_read_b32 v156, a196
    v_accvgpr_read_b32 v157, a197
    v_accvgpr_read_b32 v158, a198
    v_accvgpr_read_b32 v159, a199
    v_accvgpr_read_b32 v160, a200
    v_accvgpr_read_b32 v161, a201
    v_accvgpr_read_b32 v162, a202
    v_accvgpr_read_b32 v163, a203
    v_accvgpr_read_b32 v164, a204
    v_accvgpr_read_b32 v165, a205
    v_accvgpr_read_b32 v166, a206
    v_accvgpr_read_b32 v167, a207
    s_waitcnt lgkmcnt(0)
    v_lshlrev_b32 v64, 16, v96
    v_and_b32 v65, 0xffff0000, v96
    v_lshlrev_b32 v66, 16, v97
    v_and_b32 v67, 0xffff0000, v97
    v_lshlrev_b32 v112, 16, v152
    v_and_b32 v113, 0xffff0000, v152
    v_lshlrev_b32 v114, 16, v153
    v_and_b32 v115, 0xffff0000, v153
    v_pk_mul_f32 v[64:65], v[64:65], v[112:113]
    v_pk_mul_f32 v[66:67], v[66:67], v[114:115]
    v_pk_mul_f32 v[64:65], v[64:65], v[16:17] op_sel_hi:[1,0]
    v_pk_mul_f32 v[66:67], v[66:67], v[16:17] op_sel_hi:[1,0]
    v_lshlrev_b32 v68, 16, v98
    v_and_b32 v69, 0xffff0000, v98
    v_lshlrev_b32 v70, 16, v99
    v_and_b32 v71, 0xffff0000, v99
    v_lshlrev_b32 v112, 16, v154
    v_and_b32 v113, 0xffff0000, v154
    v_lshlrev_b32 v114, 16, v155
    v_and_b32 v115, 0xffff0000, v155
    v_pk_mul_f32 v[68:69], v[68:69], v[112:113]
    v_pk_mul_f32 v[70:71], v[70:71], v[114:115]
    v_pk_mul_f32 v[68:69], v[68:69], v[18:19] op_sel_hi:[1,0]
    v_pk_mul_f32 v[70:71], v[70:71], v[18:19] op_sel_hi:[1,0]
    v_lshlrev_b32 v72, 16, v100
    v_and_b32 v73, 0xffff0000, v100
    v_lshlrev_b32 v74, 16, v101
    v_and_b32 v75, 0xffff0000, v101
    v_lshlrev_b32 v112, 16, v156
    v_and_b32 v113, 0xffff0000, v156
    v_lshlrev_b32 v114, 16, v157
    v_and_b32 v115, 0xffff0000, v157
    v_pk_mul_f32 v[72:73], v[72:73], v[112:113]
    v_pk_mul_f32 v[74:75], v[74:75], v[114:115]
    v_pk_mul_f32 v[72:73], v[72:73], v[16:17] op_sel_hi:[1,0]
    v_pk_mul_f32 v[74:75], v[74:75], v[16:17] op_sel_hi:[1,0]
    v_lshlrev_b32 v76, 16, v102
    v_and_b32 v77, 0xffff0000, v102
    v_lshlrev_b32 v78, 16, v103
    v_and_b32 v79, 0xffff0000, v103
    v_lshlrev_b32 v112, 16, v158
    v_and_b32 v113, 0xffff0000, v158
    v_lshlrev_b32 v114, 16, v159
    v_and_b32 v115, 0xffff0000, v159
    v_pk_mul_f32 v[76:77], v[76:77], v[112:113]
    v_pk_mul_f32 v[78:79], v[78:79], v[114:115]
    v_pk_mul_f32 v[76:77], v[76:77], v[18:19] op_sel_hi:[1,0]
    v_pk_mul_f32 v[78:79], v[78:79], v[18:19] op_sel_hi:[1,0]
    v_lshlrev_b32 v80, 16, v104
    v_and_b32 v81, 0xffff0000, v104
    v_lshlrev_b32 v82, 16, v105
    v_and_b32 v83, 0xffff0000, v105
    v_lshlrev_b32 v112, 16, v160
    v_and_b32 v113, 0xffff0000, v160
    v_lshlrev_b32 v114, 16, v161
    v_and_b32 v115, 0xffff0000, v161
    v_pk_mul_f32 v[80:81], v[80:81], v[112:113]
    v_pk_mul_f32 v[82:83], v[82:83], v[114:115]
    v_pk_mul_f32 v[80:81], v[80:81], v[16:17] op_sel_hi:[1,0]
    v_pk_mul_f32 v[82:83], v[82:83], v[16:17] op_sel_hi:[1,0]
    v_lshlrev_b32 v84, 16, v106
    v_and_b32 v85, 0xffff0000, v106
    v_lshlrev_b32 v86, 16, v107
    v_and_b32 v87, 0xffff0000, v107
    v_lshlrev_b32 v112, 16, v162
    v_and_b32 v113, 0xffff0000, v162
    v_lshlrev_b32 v114, 16, v163
    v_and_b32 v115, 0xffff0000, v163
    v_pk_mul_f32 v[84:85], v[84:85], v[112:113]
    v_pk_mul_f32 v[86:87], v[86:87], v[114:115]
    v_pk_mul_f32 v[84:85], v[84:85], v[18:19] op_sel_hi:[1,0]
    v_pk_mul_f32 v[86:87], v[86:87], v[18:19] op_sel_hi:[1,0]
    v_lshlrev_b32 v88, 16, v108
    v_and_b32 v89, 0xffff0000, v108
    v_lshlrev_b32 v90, 16, v109
    v_and_b32 v91, 0xffff0000, v109
    v_lshlrev_b32 v112, 16, v164
    v_and_b32 v113, 0xffff0000, v164
    v_lshlrev_b32 v114, 16, v165
    v_and_b32 v115, 0xffff0000, v165
    v_pk_mul_f32 v[88:89], v[88:89], v[112:113]
    v_pk_mul_f32 v[90:91], v[90:91], v[114:115]
    v_pk_mul_f32 v[88:89], v[88:89], v[16:17] op_sel_hi:[1,0]
    v_pk_mul_f32 v[90:91], v[90:91], v[16:17] op_sel_hi:[1,0]
    v_lshlrev_b32 v92, 16, v110
    v_and_b32 v93, 0xffff0000, v110
    v_lshlrev_b32 v94, 16, v111
    v_and_b32 v95, 0xffff0000, v111
    v_lshlrev_b32 v112, 16, v166
    v_and_b32 v113, 0xffff0000, v166
    v_lshlrev_b32 v114, 16, v167
    v_and_b32 v115, 0xffff0000, v167
    v_pk_mul_f32 v[92:93], v[92:93], v[112:113]
    v_pk_mul_f32 v[94:95], v[94:95], v[114:115]
    v_pk_mul_f32 v[92:93], v[92:93], v[18:19] op_sel_hi:[1,0]
    v_pk_mul_f32 v[94:95], v[94:95], v[18:19] op_sel_hi:[1,0]
    s_waitcnt vmcnt(0)
    v_max3_u32 v4, v184, v185, v186
    v_max3_u32 v4, v4, v187, v188
    v_max3_u32 v4, v4, v189, v190
    v_max3_u32 v4, v4, v191, v192
    v_max3_u32 v4, v4, v193, v194
    v_max3_u32 v4, v4, v195, v196
    v_max3_u32 v4, v4, v197, v198
    v_max_u32 v4, v4, v199
    v_cmp_eq_u32 vcc, -1, v4
    s_cbranch_vccnz L_x_spin
L_x_ok:
    v_lshlrev_b32 v112, 16, v184
    v_and_b32 v113, 0xffff0000, v184
    v_lshlrev_b32 v114, 16, v185
    v_and_b32 v115, 0xffff0000, v185
    v_pk_add_f32 v[32:33], v[32:33], v[112:113]
    v_pk_add_f32 v[34:35], v[34:35], v[114:115]
    v_pk_fma_f32 v[32:33], v[32:33], v[16:17], v[64:65] op_sel:[0,1,0] op_sel_hi:[1,1,1]
    v_pk_fma_f32 v[34:35], v[34:35], v[16:17], v[66:67] op_sel:[0,1,0] op_sel_hi:[1,1,1]
    v_cvt_pk_bf16_f32 v96, v32, v33
    v_cvt_pk_bf16_f32 v97, v34, v35
    v_lshlrev_b32 v112, 16, v188
    v_and_b32 v113, 0xffff0000, v188
    v_lshlrev_b32 v114, 16, v189
    v_and_b32 v115, 0xffff0000, v189
    v_pk_add_f32 v[40:41], v[40:41], v[112:113]
    v_pk_add_f32 v[42:43], v[42:43], v[114:115]
    v_pk_fma_f32 v[40:41], v[40:41], v[16:17], v[72:73] op_sel:[0,1,0] op_sel_hi:[1,1,1]
    v_pk_fma_f32 v[42:43], v[42:43], v[16:17], v[74:75] op_sel:[0,1,0] op_sel_hi:[1,1,1]
    v_cvt_pk_bf16_f32 v98, v40, v41
    v_cvt_pk_bf16_f32 v99, v42, v43
    s_nop 0
    v_permlane16_swap_b32 v96, v98
    v_permlane16_swap_b32 v97, v99
    buffer_store_dwordx4 v[96:99], v240, s[16:19], s48 offen offset:0
    v_lshlrev_b32 v112, 16, v186
    v_and_b32 v113, 0xffff0000, v186
    v_lshlrev_b32 v114, 16, v187
    v_and_b32 v115, 0xffff0000, v187
    v_pk_add_f32 v[36:37], v[36:37], v[112:113]
    v_pk_add_f32 v[38:39], v[38:39], v[114:115]
    v_pk_fma_f32 v[36:37], v[36:37], v[18:19], v[68:69] op_sel:[0,1,0] op_sel_hi:[1,1,1]
    v_pk_fma_f32 v[38:39], v[38:39], v[18:19], v[70:71] op_sel:[0,1,0] op_sel_hi:[1,1,1]
    v_cvt_pk_bf16_f32 v100, v36, v37
    v_cvt_pk_bf16_f32 v101, v38, v39
    v_lshlrev_b32 v112, 16, v190
    v_and_b32 v113, 0xffff0000, v190
    v_lshlrev_b32 v114, 16, v191
    v_and_b32 v115, 0xffff0000, v191
    v_pk_add_f32 v[44:45], v[44:45], v[112:113]
    v_pk_add_f32 v[46:47], v[46:47], v[114:115]
    v_pk_fma_f32 v[44:45], v[44:45], v[18:19], v[76:77] op_sel:[0,1,0] op_sel_hi:[1,1,1]
    v_pk_fma_f32 v[46:47], v[46:47], v[18:19], v[78:79] op_sel:[0,1,0] op_sel_hi:[1,1,1]
    v_cvt_pk_bf16_f32 v102, v44, v45
    v_cvt_pk_bf16_f32 v103, v46, v47
    s_nop 0
    v_permlane16_swap_b32 v100, v102
    v_permlane16_swap_b32 v101, v103
    buffer_store_dwordx4 v[100:103], v240, s[16:19], s49 offen offset:0
    v_lshlrev_b32 v112, 16, v192
    v_and_b32 v113, 0xffff0000, v192
    v_lshlrev_b32 v114, 16, v193
    v_and_b32 v115, 0xffff0000, v193
    v_pk_add_f32 v[48:49], v[48:49], v[112:113]
    v_pk_add_f32 v[50:51], v[50:51], v[114:115]
    v_pk_fma_f32 v[48:49], v[48:49], v[16:17], v[80:81] op_sel:[0,1,0] op_sel_hi:[1,1,1]
    v_pk_fma_f32 v[50:51], v[50:51], v[16:17], v[82:83] op_sel:[0,1,0] op_sel_hi:[1,1,1]
    v_cvt_pk_bf16_f32 v104, v48, v49
    v_cvt_pk_bf16_f32 v105, v50, v51
    v_lshlrev_b32 v112, 16, v196
    v_and_b32 v113, 0xffff0000, v196
    v_lshlrev_b32 v114, 16, v197
    v_and_b32 v115, 0xffff0000, v197
    v_pk_add_f32 v[56:57], v[56:57], v[112:113]
    v_pk_add_f32 v[58:59], v[58:59], v[114:115]
    v_pk_fma_f32 v[56:57], v[56:57], v[16:17], v[88:89] op_sel:[0,1,0] op_sel_hi:[1,1,1]
    v_pk_fma_f32 v[58:59], v[58:59], v[16:17], v[90:91] op_sel:[0,1,0] op_sel_hi:[1,1,1]
    v_cvt_pk_bf16_f32 v106, v56, v57
    v_cvt_pk_bf16_f32 v107, v58, v59
    s_nop 0
    v_permlane16_swap_b32 v104, v106
    v_permlane16_swap_b32 v105, v107
    buffer_store_dwordx4 v[104:107], v240, s[16:19], s48 offen offset:64
    v_lshlrev_b32 v112, 16, v194
    v_and_b32 v113, 0xffff0000, v194
    v_lshlrev_b32 v114, 16, v195
    v_and_b32 v115, 0xffff0000, v195
    v_pk_add_f32 v[52:53], v[52:53], v[112:113]
    v_pk_add_f32 v[54:55], v[54:55], v[114:115]
    v_pk_fma_f32 v[52:53], v[52:53], v[18:19], v[84:85] op_sel:[0,1,0] op_sel_hi:[1,1,1]
    v_pk_fma_f32 v[54:55], v[54:55], v[18:19], v[86:87] op_sel:[0,1,0] op_sel_hi:[1,1,1]
    v_cvt_pk_bf16_f32 v108, v52, v53
    v_cvt_pk_bf16_f32 v109, v54, v55
    v_lshlrev_b32 v112, 16, v198
    v_and_b32 v113, 0xffff0000, v198
    v_lshlrev_b32 v114, 16, v199
    v_and_b32 v115, 0xffff0000, v199
    v_pk_add_f32 v[60:61], v[60:61], v[112:113]
    v_pk_add_f32 v[62:63], v[62:63], v[114:115]
    v_pk_fma_f32 v[60:61], v[60:61], v[18:19], v[92:93] op_sel:[0,1,0] op_sel_hi:[1,1,1]
    v_pk_fma_f32 v[62:63], v[62:63], v[18:19], v[94:95] op_sel:[0,1,0] op_sel_hi:[1,1,1]
    v_cvt_pk_bf16_f32 v110, v60, v61
    v_cvt_pk_bf16_f32 v111, v62, v63
    s_nop 0
    v_permlane16_swap_b32 v108, v110
    v_permlane16_swap_b32 v109, v111
    buffer_store_dwordx4 v[108:111], v240, s[16:19], s49 offen offset:64
    s_endpgm
L_x_spin:
    s_mov_b32 s47, 0
L_x_spin2:
    buffer_load_dwordx4 v[184:187], v26, s[12:15], s52 offen offset:0 sc1
    buffer_load_dwordx4 v[188:191], v26, s[12:15], s52 offen offset:1024 sc1
    buffer_load_dwordx4 v[192:195], v26, s[12:15], s52 offen offset:2048 sc1
    buffer_load_dwordx4 v[196:199], v26, s[12:15], s52 offen offset:3072 sc1
    s_add_u32 s47, s47, 1
    s_cmp_ge_u32 s47, 0x40000
    s_waitcnt vmcnt(0)
    s_cbranch_scc1 L_x_ok
    v_max3_u32 v4, v184, v185, v186
    v_max3_u32 v4, v4, v187, v188
    v_max3_u32 v4, v4, v189, v190
    v_max3_u32 v4, v4, v191, v192
    v_max3_u32 v4, v4, v193, v194
    v_max3_u32 v4, v4, v195, v196
    v_max3_u32 v4, v4, v197, v198
    v_max_u32 v4, v4, v199
    v_cmp_eq_u32 vcc, -1, v4
    s_cbranch_vccnz L_x_spin2
    s_branch L_x_ok
L_upoll_spin:
    s_mov_b32 s47, 0
L_upoll_spin2:
    s_sleep 2
    buffer_load_dword v23, v224, s[12:15], s54 offen sc1
    s_add_u32 s47, s47, 1
    s_cmp_ge_u32 s47, 0x100000
    s_waitcnt vmcnt(0)
    s_cbranch_scc1 L_upoll_ok
    v_cmp_ne_u32 vcc, s60, v23
    s_cbranch_vccnz L_upoll_spin2
    s_branch L_upoll_ok
L_hpoll_spin:
    s_mov_b32 s47, 0
L_hpoll_spin2:
    s_sleep 2
    buffer_load_dword v251, v250, s[12:15], s55 offen sc1
    s_add_u32 s47, s47, 1
    s_cmp_ge_u32 s47, 0x100000
    s_waitcnt vmcnt(0)
    s_cbranch_scc1 L_hpoll_ok
    v_cmp_ne_u32 vcc, s60, v251
    s_cbranch_vccnz L_hpoll_spin2
    s_branch L_hpoll_ok
L_ypoll_spin:
    s_mov_b32 s47, 0
L_ypoll_spin2:
    s_sleep 2
    buffer_load_dword v251, v224, s[12:15], s54 offen sc1
    s_add_u32 s47, s47, 1
    s_cmp_ge_u32 s47, 0x100000
    s_waitcnt vmcnt(0)
    s_cbranch_scc1 L_ypoll_ok
    v_cmp_ne_u32 vcc, s60, v251
    s_cbranch_vccnz L_ypoll_spin2
    s_branch L_ypoll_ok
L_tok_spin:
    s_mov_b32 s47, 0
L_tok_spin2:
    s_load_dword s60, s[78:79], 0 glc
    s_add_u32 s47, s47, 1
    s_cmp_ge_u32 s47, 0x100000
    s_waitcnt lgkmcnt(0)
    s_cbranch_scc1 L_tok_ok
    s_cmp_eq_u32 s60, 0
    s_cbranch_scc1 L_tok_spin2
    s_branch L_tok_ok
L_end:
    s_endpgm
.section .rodata,"a"

.p2align 6
.amdhsa_kernel gated_mix__ssm_conv_h3__swiglu_ffn__prompt_kernel
  .amdhsa_next_free_vgpr 512
  .amdhsa_next_free_sgpr 102
  .amdhsa_accum_offset 256
  .amdhsa_group_segment_fixed_size 0
  .amdhsa_kernarg_size 112
  .amdhsa_user_sgpr_count 2
  .amdhsa_user_sgpr_kernarg_segment_ptr 1
  .amdhsa_system_sgpr_workgroup_id_x 1
.end_amdhsa_kernel
```
